```python
import torch

def _softmax(x, axis=-1):
    return torch.softmax(x, dim=axis)
def _gelu(x):
    return torch.nn.functional.gelu(x, approximate="tanh")
def _silu(x):
    return torch.nn.functional.silu(x)
def _sigmoid(x):
    return torch.sigmoid(x)
def _layernorm(x, axis=-1, eps=1e-5):
    m = x.mean(dim=axis, keepdim=True)
    v = x.var(dim=axis, keepdim=True, unbiased=False)
    return (x - m) / torch.sqrt(v + eps)
def _scatter_add(tgt, idx, src, axis=0):
    return tgt.clone().index_add_(axis, idx, src)
def _segment_sum(src, seg, n):
    out = torch.zeros((n,) + src.shape[1:], dtype=src.dtype)
    return out.index_add_(0, seg, src)
def _pad(x, pw):
    flat = tuple(v for pair in reversed(pw) for v in pair)
    return torch.nn.functional.pad(x, flat)

kernel_name = 'concat_heads__sliding_local_dilated__ssm_conv_h3__prompt'

def setup_inputs():

    _w = (lambda a: (lambda t: t.to(torch.bfloat16) if t.is_floating_point() else t)(torch.as_tensor(a)))
    def _A_setup():
        B, S, D = 1, 2048, 640
        return {
            "x": _w((lambda *s: torch.randn(*s, dtype=torch.bfloat16) * 0.2)(B, S, D)),
            "wqkv": _w((lambda *s: torch.randn(*s, dtype=torch.bfloat16) * 0.2)(D, 3 * D)),
            "wo": _w((lambda *s: torch.randn(*s, dtype=torch.bfloat16) * 0.05)(D, D)),
        }
    _A_in = _A_setup()

    def _B_setup():
        B, S, D = 1, 2048, 640
        ks = 4
        return {
            "q": _w((lambda *s: torch.randn(*s, dtype=torch.bfloat16) * 0.05)(B, S, D)),
            "k": _w((lambda *s: torch.randn(*s, dtype=torch.bfloat16) * 0.8)(B, S, D)),
            "v": _w((lambda *s: torch.randn(*s, dtype=torch.bfloat16) * 0.8)(B, S, D)),
            "shift_k": _w((lambda *s: torch.randn(*s, dtype=torch.bfloat16) * 0.8)(D, ks) * 0.5),
            "ssm_k": _w((lambda *s: torch.randn(*s, dtype=torch.bfloat16) * 3.2)(D, S) * (1.0 / S ** 0.5)),
            "ssm_D": _w((lambda *s: torch.randn(*s, dtype=torch.bfloat16) * 0.8)(D)),
        }
    _B_in = _B_setup()

    return {
        "A_x": _A_in["x"],
        "A_wqkv": _A_in["wqkv"],
        "A_wo": _A_in["wo"],
        "B_q": _B_in["q"],
        "B_k": _B_in["k"],
        "B_v": _B_in["v"],
        "B_shift_k": _B_in["shift_k"],
        "B_ssm_k": _B_in["ssm_k"],
        "B_ssm_D": _B_in["ssm_D"],
    }

def reference(A_x, A_wqkv, A_wo, B_q, B_k, B_v, B_shift_k, B_ssm_k, B_ssm_D):
    def _A_ref(x, wqkv, wo):
        B, S, D = x.shape
        H = 32; Dh = D // H
        W, dil = 8, 2
        qkv = (lambda x, *d: x.permute(*d))((x @ wqkv).reshape(B, S, 3, H, Dh), 2, 0, 3, 1, 4)
        q, k, v = qkv[0], qkv[1], qkv[2]
        scale = Dh ** -0.5
        pos = torch.arange(S)
        off = torch.arange(W) * dil
        idx = pos[:, None] - off[None, :]
        mask = idx >= 0
        idx_c = torch.where(mask, idx, 0).reshape(-1)
        kg = k[:, :, idx_c, :].reshape(B, H, S, W, Dh)
        vg = v[:, :, idx_c, :].reshape(B, H, S, W, Dh)
        logits = torch.einsum("bhsd,bhswd->bhsw", q, kg) * scale
        logits = torch.where(mask[None, None, :, :], logits, -1e9)
        attn = _softmax(logits, axis=-1)
        o = torch.einsum("bhsw,bhswd->bhsd", attn, vg)
        return (lambda x, *d: x.permute(*d))(o, 0, 2, 1, 3).reshape(B, S, D) @ wo

    def _B_ref(q, k, v, shift_k, ssm_k, ssm_D):
        B, S, D = q.shape
        ks = shift_k.shape[-1]
        k_pad = _pad(k, ((0, 0), (ks - 1, 0), (0, 0)))
        k_shift = torch.zeros_like(k)
        for t in range(ks):
            k_shift = k_shift + k_pad[:, t:t + S, :] * shift_k[:, ks - 1 - t][None, None, :]
        kv = k_shift * v
        L = 2 * S
        kv_pad = _pad(kv, ((0, 0), (0, S), (0, 0)))
        kf_pad = _pad(ssm_k, ((0, 0), (0, S)))
        kv_f = (lambda x, axes=(-2,-1): torch.fft.rfft2(x.float(), dim=axes))(kv_pad[:, None, :, :], axes=(1, 2))
        kf_f = (lambda x, axes=(-2,-1): torch.fft.rfft2(x.float(), dim=axes))(kf_pad[:, None, :], axes=(1, 2))
        kf_f = (lambda x, *d: x.permute(*d))(kf_f, 1, 2, 0)
        y_f = kv_f * kf_f[None, :, :, :]
        y = (lambda x, s, axes=(-2,-1): torch.fft.irfft2(x, s=s, dim=axes).to(torch.bfloat16))(y_f, (1, L), axes=(1, 2))[:, 0, :S, :]
        y = y + kv * ssm_D[None, None, :]
        return q * y

    a = _A_ref(A_x, A_wqkv, A_wo)
    b = _B_ref(B_q, B_k, B_v, B_shift_k, B_ssm_k, B_ssm_D)
    return torch.concatenate([a, b], axis=-1)
```

```asm
; @launch grid=(256,1,1) block=(512,1,1) lds=138240
.amdgcn_target "amdgcn-amd-amdhsa--gfx950"
.text
.globl concat_heads__sliding_local_dilated__ssm_conv_h3__prompt_kernel
.p2align 8
.type concat_heads__sliding_local_dilated__ssm_conv_h3__prompt_kernel,@function
concat_heads__sliding_local_dilated__ssm_conv_h3__prompt_kernel:
    s_cmp_ge_u32 s2, 256
    s_cbranch_scc1 END_1
    s_load_dwordx16 s[4:19], s[0:1], 0
    s_load_dwordx8 s[20:27], s[0:1], 64
    v_lshrrev_b32 v11, 6, v0
    v_and_b32 v10, 63, v0
    s_and_b32 s52, s2, 7
    s_lshr_b32 s53, s2, 3
    v_readfirstlane_b32 s28, v11
    s_cmp_ge_u32 s53, 22
    s_cbranch_scc0 ROLE_A_1
ROLE_B_1:
    s_mul_i32 s52, s52, 10
    s_add_u32 s29, s52, s53
    s_sub_u32 s29, s29, 22
    s_lshr_b32 s63, s29, 3
    s_cmp_ge_u32 s28, 4
    s_cbranch_scc1 B_HELP
    v_and_b32 v11, 127, v0
    v_lshrrev_b32 v12, 3, v11
    v_and_b32 v13, 7, v11
    s_and_b32 s52, s29, 7
    s_lshl_b32 s52, s52, 1
    s_lshr_b32 s53, s28, 1
    s_add_u32 s30, s52, s53
    s_lshl_b32 s52, s30, 7
    v_lshl_add_u32 v14, v12, 3, s52
    v_mul_u32_u24 v14, 1280, v14
    s_lshl_b32 s52, s63, 7
    v_lshl_add_u32 v14, v13, 4, v14
    v_add_u32 v1, s52, v14
    v_subrev_u32 v2, 1280, v1
    v_subrev_u32 v3, 2560, v1
    v_subrev_u32 v4, 3840, v1
    v_add_u32 v6, 5120, v1
    s_lshl_b32 s52, s63, 9
    v_lshl_add_u32 v5, v13, 6, s52
    s_waitcnt lgkmcnt(0)
    s_mov_b32 s32, s12
    s_mov_b32 s33, s13
    s_and_b32 s33, s33, 0xffff
    s_mov_b32 s34, 0x280000
    s_mov_b32 s35, 0x20000
    s_mov_b32 s36, s14
    s_mov_b32 s37, s15
    s_and_b32 s37, s37, 0xffff
    s_mov_b32 s38, 0x280000
    s_mov_b32 s39, 0x20000
    s_mov_b32 s40, s16
    s_mov_b32 s41, s17
    s_and_b32 s41, s41, 0xffff
    s_mov_b32 s42, 0x1400
    s_mov_b32 s43, 0x20000
    buffer_load_dwordx4 v[16:19], v4, s[32:35], 0 offen nt
    buffer_load_dwordx4 v[20:23], v3, s[32:35], 0 offen nt
    buffer_load_dwordx4 v[24:27], v2, s[32:35], 0 offen nt
    buffer_load_dwordx4 v[28:31], v1, s[32:35], 0 offen offset:0 nt
    buffer_load_dwordx4 v[32:35], v1, s[32:35], 0 offen offset:1280 nt
    buffer_load_dwordx4 v[36:39], v1, s[32:35], 0 offen offset:2560 nt
    buffer_load_dwordx4 v[40:43], v1, s[32:35], 0 offen offset:3840 nt
    buffer_load_dwordx4 v[92:95], v5, s[40:43], 0 offen offset:0
    buffer_load_dwordx4 v[96:99], v5, s[40:43], 0 offen offset:16
    buffer_load_dwordx4 v[100:103], v5, s[40:43], 0 offen offset:32
    buffer_load_dwordx4 v[104:107], v5, s[40:43], 0 offen offset:48
    buffer_load_dwordx4 v[60:63], v1, s[36:39], 0 offen offset:0 nt
    buffer_load_dwordx4 v[64:67], v1, s[36:39], 0 offen offset:1280 nt
    buffer_load_dwordx4 v[68:71], v1, s[36:39], 0 offen offset:2560 nt
    buffer_load_dwordx4 v[72:75], v1, s[36:39], 0 offen offset:3840 nt
    buffer_load_dwordx4 v[44:47], v6, s[32:35], 0 offen offset:0 nt
    buffer_load_dwordx4 v[48:51], v6, s[32:35], 0 offen offset:1280 nt
    buffer_load_dwordx4 v[52:55], v6, s[32:35], 0 offen offset:2560 nt
    buffer_load_dwordx4 v[56:59], v6, s[32:35], 0 offen offset:3840 nt
    buffer_load_dwordx4 v[76:79], v6, s[36:39], 0 offen offset:0 nt
    buffer_load_dwordx4 v[80:83], v6, s[36:39], 0 offen offset:1280 nt
    buffer_load_dwordx4 v[84:87], v6, s[36:39], 0 offen offset:2560 nt
    buffer_load_dwordx4 v[88:91], v6, s[36:39], 0 offen offset:3840 nt
    s_barrier
    s_branch B1_REST
END_1:
    s_endpgm
ROLE_A_1:
    s_mul_i32 s52, s52, 22
    s_add_u32 s29, s52, s53
    s_cmp_ge_u32 s29, 88
    s_cselect_b32 s54, 88, 0
    s_cselect_b32 s55, 4, 0
    s_sub_u32 s54, s29, s54
    s_lshr_b32 s30, s54, 2
    s_and_b32 s54, s54, 3
    s_add_u32 s31, s54, s55
    s_mul_i32 s54, s29, 6554
    s_lshr_b32 s63, s54, 16
    s_mul_i32 s54, s63, 10
    s_sub_u32 s64, s29, s54
    s_cmp_ge_u32 s29, 160
    s_cselect_b32 s64, 99, s64
    s_cmp_lt_u32 s28, 4
    s_cbranch_scc1 A_COMPUTE
    s_cmp_ge_u32 s28, 6
    s_cbranch_scc1 PF_W_1
    s_and_b32 s52, s2, 3
    s_mul_i32 s52, s52, 22
    s_add_u32 s53, s52, 21
    s_lshr_b32 s52, s52, 2
    s_lshr_b32 s53, s53, 2
    s_add_u32 s53, s53, 1
    s_mul_i32 s53, s53, 96
    s_mul_i32 s52, s52, 96
    s_sub_i32 s52, s52, 16
    s_lshr_b32 s54, s2, 3
    s_lshl_b32 s54, s54, 5
    s_add_i32 s52, s52, s54
    v_add_u32 v11, s52, v10
    v_cmp_gt_i32 s[58:59], s53, v11
    v_max_i32 v11, 0, v11
    v_mul_u32_u24 v255, 1280, v11
    v_cmp_gt_u32 vcc, 32, v10
    s_and_b64 vcc, vcc, s[58:59]
    s_mov_b32 s101, 128
    v_mov_b32 v11, 0x7ffffff0
    s_and_b32 s52, s28, 1
    s_mul_i32 s100, s52, s101
    s_lshl_b32 s101, s101, 1
    v_cndmask_b32 v255, v11, v255, vcc
    s_waitcnt lgkmcnt(0)
    s_mov_b32 s44, s4
    s_mov_b32 s45, s5
    s_and_b32 s45, s45, 0xffff
    s_mov_b32 s46, 0x280000
    s_mov_b32 s47, 0x20000
    s_branch PF_D_1
PF_W_1:
    s_lshr_b32 s52, s2, 3
    s_mul_i32 s52, s52, 44
    v_add_u32 v11, s52, v10
    v_mul_u32_u24 v12, 4370, v11
    v_lshrrev_b32 v12, 16, v12
    v_mul_u32_u24 v13, 15, v12
    v_sub_u32 v13, v11, v13
    v_mul_u32_u24 v14, 52, v13
    v_lshrrev_b32 v14, 8, v14
    v_mul_u32_u24 v11, 5, v14
    v_sub_u32 v13, v13, v11
    v_mul_u32_u24 v12, 3840, v12
    v_mul_u32_u24 v14, 1280, v14
    v_add_u32 v12, v12, v14
    v_lshl_add_u32 v12, v13, 7, v12
    s_lshr_b32 s52, s31, 2
    s_mul_i32 s52, s52, 640
    v_add_u32 v255, s52, v12
    v_cmp_gt_u32 vcc, 44, v10
    s_mov_b32 s101, 245760
    v_mov_b32 v11, 0x7ffffff0
    s_and_b32 s52, s28, 1
    s_mul_i32 s100, s52, s101
    s_lshl_b32 s101, s101, 1
    v_cndmask_b32 v255, v11, v255, vcc
    s_waitcnt lgkmcnt(0)
    s_mov_b32 s44, s6
    s_mov_b32 s45, s7
    s_and_b32 s45, s45, 0xffff
    s_mov_b32 s46, 0x258000
    s_mov_b32 s47, 0x20000
PF_D_1:
    buffer_load_dword v0, v255, s[44:47], s100 offen
    s_add_u32 s100, s100, s101
    buffer_load_dword v0, v255, s[44:47], s100 offen
    s_add_u32 s100, s100, s101
    s_sub_u32 s57, s28, 4
    v_lshrrev_b32 v1, 3, v10
    v_and_b32 v2, 7, v10
    v_xor_b32 v2, v2, v1
    v_lshlrev_b32 v2, 4, v2
    s_mul_i32 s52, s30, 96
    s_lshl_b32 s53, s57, 3
    s_add_u32 s52, s52, s53
    s_sub_i32 s52, s52, 16
    v_add_u32 v1, s52, v1
    s_movk_i32 s53, 1280
    v_add_u32 v3, 0, v1
    v_max_i32 v3, 0, v3
    v_mul_lo_u32 v3, v3, s53
    v_add_u32 v16, v3, v2
    v_add_u32 v3, 32, v1
    v_max_i32 v3, 0, v3
    v_mul_lo_u32 v3, v3, s53
    v_add_u32 v17, v3, v2
    v_add_u32 v3, 64, v1
    v_max_i32 v3, 0, v3
    v_mul_lo_u32 v3, v3, s53
    v_add_u32 v18, v3, v2
    v_add_u32 v3, 96, v1
    v_max_i32 v3, 0, v3
    v_mul_lo_u32 v3, v3, s53
    v_add_u32 v19, v3, v2
    s_lshl_b32 s52, s57, 10
    s_add_u32 s65, s52, 0
    s_add_u32 s66, s52, 4096
    s_add_u32 s67, s52, 8192
    s_add_u32 s68, s52, 12288
    s_waitcnt lgkmcnt(0)
    s_mov_b32 s32, s4
    s_mov_b32 s33, s5
    s_and_b32 s33, s33, 0xffff
    s_mov_b32 s34, 0x280000
    s_mov_b32 s35, 0x20000
    s_mov_b32 s36, s6
    s_mov_b32 s37, s7
    s_and_b32 s37, s37, 0xffff
    s_mov_b32 s38, 0x258000
    s_mov_b32 s39, 0x20000
    s_mov_b32 s77, 0
    s_mov_b32 s78, 0
    s_mov_b32 s3, 0
    s_add_u32 m0, s77, s65
    s_nop 0
    buffer_load_dwordx4 v16, s[32:35], s78 offen lds
    s_add_u32 m0, s77, s66
    s_nop 0
    buffer_load_dwordx4 v17, s[32:35], s78 offen lds
    s_add_u32 m0, s77, s67
    s_nop 0
    buffer_load_dwordx4 v18, s[32:35], s78 offen lds
    s_mul_i32 s52, s31, 160
    s_movk_i32 s53, 2185
    s_movk_i32 s54, 3840
    s_lshl_b32 s55, s57, 6
    v_add_u32 v1, s55, v10
    v_mul_lo_u32 v2, v1, s53
    v_lshrrev_b32 v2, 16, v2
    v_mul_u32_u24 v3, 30, v2
    v_sub_u32 v1, v1, v3
    v_and_b32 v3, 0xfffffff3, v2
    v_bfe_u32 v4, v2, 3, 1
    v_lshl_add_u32 v3, v4, 2, v3
    v_bfe_u32 v4, v2, 2, 1
    v_lshl_add_u32 v3, v4, 3, v3
    v_mul_lo_u32 v3, v3, s54
    v_mul_u32_u24 v4, 26, v1
    v_lshrrev_b32 v4, 8, v4
    v_mul_u32_u24 v5, 10, v4
    v_sub_u32 v1, v1, v5
    v_mul_u32_u24 v4, 1280, v4
    v_add_u32 v3, v3, v4
    v_lshl_add_u32 v3, v1, 4, v3
    v_add_u32 v24, s52, v3
    v_add_u32 v1, s55, v10
    v_add_u32 v1, 256, v1
    v_mul_lo_u32 v2, v1, s53
    v_lshrrev_b32 v2, 16, v2
    v_mul_u32_u24 v3, 30, v2
    v_sub_u32 v1, v1, v3
    v_and_b32 v3, 0xfffffff3, v2
    v_bfe_u32 v4, v2, 3, 1
    v_lshl_add_u32 v3, v4, 2, v3
    v_bfe_u32 v4, v2, 2, 1
    v_lshl_add_u32 v3, v4, 3, v3
    v_mul_lo_u32 v3, v3, s54
    v_mul_u32_u24 v4, 26, v1
    v_lshrrev_b32 v4, 8, v4
    v_mul_u32_u24 v5, 10, v4
    v_sub_u32 v1, v1, v5
    v_mul_u32_u24 v4, 1280, v4
    v_add_u32 v3, v3, v4
    v_lshl_add_u32 v3, v1, 4, v3
    v_add_u32 v25, s52, v3
    v_add_u32 v1, s55, v10
    v_add_u32 v1, 512, v1
    v_mul_lo_u32 v2, v1, s53
    v_lshrrev_b32 v2, 16, v2
    v_mul_u32_u24 v3, 30, v2
    v_sub_u32 v1, v1, v3
    v_and_b32 v3, 0xfffffff3, v2
    v_bfe_u32 v4, v2, 3, 1
    v_lshl_add_u32 v3, v4, 2, v3
    v_bfe_u32 v4, v2, 2, 1
    v_lshl_add_u32 v3, v4, 3, v3
    v_mul_lo_u32 v3, v3, s54
    v_mul_u32_u24 v4, 26, v1
    v_lshrrev_b32 v4, 8, v4
    v_mul_u32_u24 v5, 10, v4
    v_sub_u32 v1, v1, v5
    v_mul_u32_u24 v4, 1280, v4
    v_add_u32 v3, v3, v4
    v_lshl_add_u32 v3, v1, 4, v3
    v_add_u32 v26, s52, v3
    v_add_u32 v1, s55, v10
    v_add_u32 v1, 768, v1
    v_mul_lo_u32 v2, v1, s53
    v_lshrrev_b32 v2, 16, v2
    v_mul_u32_u24 v3, 30, v2
    v_sub_u32 v1, v1, v3
    v_and_b32 v3, 0xfffffff3, v2
    v_bfe_u32 v4, v2, 3, 1
    v_lshl_add_u32 v3, v4, 2, v3
    v_bfe_u32 v4, v2, 2, 1
    v_lshl_add_u32 v3, v4, 3, v3
    v_mul_lo_u32 v3, v3, s54
    v_mul_u32_u24 v4, 26, v1
    v_lshrrev_b32 v4, 8, v4
    v_mul_u32_u24 v5, 10, v4
    v_sub_u32 v1, v1, v5
    v_mul_u32_u24 v4, 1280, v4
    v_add_u32 v3, v3, v4
    v_lshl_add_u32 v3, v1, 4, v3
    v_add_u32 v27, s52, v3
    v_add_u32 v1, s55, v10
    v_add_u32 v1, 1024, v1
    v_mul_lo_u32 v2, v1, s53
    v_lshrrev_b32 v2, 16, v2
    v_mul_u32_u24 v3, 30, v2
    v_sub_u32 v1, v1, v3
    v_and_b32 v3, 0xfffffff3, v2
    v_bfe_u32 v4, v2, 3, 1
    v_lshl_add_u32 v3, v4, 2, v3
    v_bfe_u32 v4, v2, 2, 1
    v_lshl_add_u32 v3, v4, 3, v3
    v_mul_lo_u32 v3, v3, s54
    v_mul_u32_u24 v4, 26, v1
    v_lshrrev_b32 v4, 8, v4
    v_mul_u32_u24 v5, 10, v4
    v_sub_u32 v1, v1, v5
    v_mul_u32_u24 v4, 1280, v4
    v_add_u32 v3, v3, v4
    v_lshl_add_u32 v3, v1, 4, v3
    v_add_u32 v28, s52, v3
    v_add_u32 v1, s55, v10
    v_add_u32 v1, 1280, v1
    v_mul_lo_u32 v2, v1, s53
    v_lshrrev_b32 v2, 16, v2
    v_mul_u32_u24 v3, 30, v2
    v_sub_u32 v1, v1, v3
    v_and_b32 v3, 0xfffffff3, v2
    v_bfe_u32 v4, v2, 3, 1
    v_lshl_add_u32 v3, v4, 2, v3
    v_bfe_u32 v4, v2, 2, 1
    v_lshl_add_u32 v3, v4, 3, v3
    v_mul_lo_u32 v3, v3, s54
    v_mul_u32_u24 v4, 26, v1
    v_lshrrev_b32 v4, 8, v4
    v_mul_u32_u24 v5, 10, v4
    v_sub_u32 v1, v1, v5
    v_mul_u32_u24 v4, 1280, v4
    v_add_u32 v3, v3, v4
    v_lshl_add_u32 v3, v1, 4, v3
    v_add_u32 v29, s52, v3
    v_add_u32 v1, s55, v10
    v_add_u32 v1, 1536, v1
    v_mul_lo_u32 v2, v1, s53
    v_lshrrev_b32 v2, 16, v2
    v_mul_u32_u24 v3, 30, v2
    v_sub_u32 v1, v1, v3
    v_and_b32 v3, 0xfffffff3, v2
    v_bfe_u32 v4, v2, 3, 1
    v_lshl_add_u32 v3, v4, 2, v3
    v_bfe_u32 v4, v2, 2, 1
    v_lshl_add_u32 v3, v4, 3, v3
    v_mul_lo_u32 v3, v3, s54
    v_mul_u32_u24 v4, 26, v1
    v_lshrrev_b32 v4, 8, v4
    v_mul_u32_u24 v5, 10, v4
    v_sub_u32 v1, v1, v5
    v_mul_u32_u24 v4, 1280, v4
    v_add_u32 v3, v3, v4
    v_lshl_add_u32 v3, v1, 4, v3
    v_add_u32 v30, s52, v3
    v_add_u32 v1, s55, v10
    v_add_u32 v1, 1664, v1
    v_mul_lo_u32 v2, v1, s53
    v_lshrrev_b32 v2, 16, v2
    v_mul_u32_u24 v3, 30, v2
    v_sub_u32 v1, v1, v3
    v_and_b32 v3, 0xfffffff3, v2
    v_bfe_u32 v4, v2, 3, 1
    v_lshl_add_u32 v3, v4, 2, v3
    v_bfe_u32 v4, v2, 2, 1
    v_lshl_add_u32 v3, v4, 3, v3
    v_mul_lo_u32 v3, v3, s54
    v_mul_u32_u24 v4, 26, v1
    v_lshrrev_b32 v4, 8, v4
    v_mul_u32_u24 v5, 10, v4
    v_sub_u32 v1, v1, v5
    v_mul_u32_u24 v4, 1280, v4
    v_add_u32 v3, v3, v4
    v_lshl_add_u32 v3, v1, 4, v3
    v_add_u32 v31, s52, v3
    s_lshl_b32 s52, s57, 10
    s_add_u32 s69, s52, 14336
    s_add_u32 s70, s52, 18432
    s_add_u32 s71, s52, 22528
    s_add_u32 s72, s52, 26624
    s_add_u32 s73, s52, 30720
    s_add_u32 s74, s52, 34816
    s_add_u32 s75, s52, 38912
    s_cmp_ge_u32 s57, 2
    s_cbranch_scc1 AL_GW_1
    s_mov_b32 s40, s32
    s_mov_b32 s41, s33
    s_mov_b32 s42, s34
    s_mov_b32 s43, s35
    s_mov_b32 s99, 128
    s_branch AL_GD_1
AL_GW_1:
    s_mov_b32 s40, s36
    s_mov_b32 s41, s37
    s_mov_b32 s42, s38
    s_mov_b32 s43, s39
    s_mov_b32 s99, 245760
    v_mov_b32 v19, v31
    s_add_u32 s68, s52, 40960
AL_GD_1:
    s_mov_b32 s98, 0
    s_add_u32 m0, s77, s68
    s_nop 0
    buffer_load_dwordx4 v19, s[40:43], s98 offen lds
    s_add_u32 m0, s77, s69
    s_nop 0
    buffer_load_dwordx4 v24, s[36:39], s3 offen lds
    s_add_u32 m0, s77, s70
    s_nop 0
    buffer_load_dwordx4 v25, s[36:39], s3 offen lds
    s_add_u32 m0, s77, s71
    s_nop 0
    buffer_load_dwordx4 v26, s[36:39], s3 offen lds
    s_add_u32 m0, s77, s72
    s_nop 0
    buffer_load_dwordx4 v27, s[36:39], s3 offen lds
    s_add_u32 m0, s77, s73
    s_nop 0
    buffer_load_dwordx4 v28, s[36:39], s3 offen lds
    s_add_u32 m0, s77, s74
    s_nop 0
    buffer_load_dwordx4 v29, s[36:39], s3 offen lds
    s_add_u32 m0, s77, s75
    s_nop 0
    buffer_load_dwordx4 v30, s[36:39], s3 offen lds
    s_add_u32 s78, s78, 128
    s_add_u32 s3, s3, 245760
    s_add_u32 s98, s98, s99
    s_add_u32 s77, s77, 46080
    s_cmp_eq_u32 s77, 138240
    s_cselect_b32 s77, 0, s77
    s_add_u32 m0, s77, s65
    s_nop 0
    buffer_load_dwordx4 v16, s[32:35], s78 offen lds
    s_add_u32 m0, s77, s66
    s_nop 0
    buffer_load_dwordx4 v17, s[32:35], s78 offen lds
    s_add_u32 m0, s77, s67
    s_nop 0
    buffer_load_dwordx4 v18, s[32:35], s78 offen lds
    s_add_u32 m0, s77, s68
    s_nop 0
    buffer_load_dwordx4 v19, s[40:43], s98 offen lds
    s_add_u32 m0, s77, s69
    s_nop 0
    buffer_load_dwordx4 v24, s[36:39], s3 offen lds
    s_add_u32 m0, s77, s70
    s_nop 0
    buffer_load_dwordx4 v25, s[36:39], s3 offen lds
    s_add_u32 m0, s77, s71
    s_nop 0
    buffer_load_dwordx4 v26, s[36:39], s3 offen lds
    s_add_u32 m0, s77, s72
    s_nop 0
    buffer_load_dwordx4 v27, s[36:39], s3 offen lds
    s_add_u32 m0, s77, s73
    s_nop 0
    buffer_load_dwordx4 v28, s[36:39], s3 offen lds
    s_add_u32 m0, s77, s74
    s_nop 0
    buffer_load_dwordx4 v29, s[36:39], s3 offen lds
    s_add_u32 m0, s77, s75
    s_nop 0
    buffer_load_dwordx4 v30, s[36:39], s3 offen lds
    s_add_u32 s78, s78, 128
    s_add_u32 s3, s3, 245760
    s_add_u32 s98, s98, s99
    s_add_u32 s77, s77, 46080
    s_cmp_eq_u32 s77, 138240
    s_cselect_b32 s77, 0, s77
    s_waitcnt vmcnt(11)
    s_barrier
    s_add_u32 m0, s77, s65
    s_nop 0
    buffer_load_dwordx4 v16, s[32:35], s78 offen lds
    s_add_u32 m0, s77, s66
    s_nop 0
    buffer_load_dwordx4 v17, s[32:35], s78 offen lds
    s_add_u32 m0, s77, s67
    s_nop 0
    buffer_load_dwordx4 v18, s[32:35], s78 offen lds
    s_add_u32 m0, s77, s68
    s_nop 0
    buffer_load_dwordx4 v19, s[40:43], s98 offen lds
    s_add_u32 m0, s77, s69
    s_nop 0
    buffer_load_dwordx4 v24, s[36:39], s3 offen lds
    s_add_u32 m0, s77, s70
    s_nop 0
    buffer_load_dwordx4 v25, s[36:39], s3 offen lds
    s_add_u32 m0, s77, s71
    s_nop 0
    buffer_load_dwordx4 v26, s[36:39], s3 offen lds
    s_add_u32 m0, s77, s72
    s_nop 0
    buffer_load_dwordx4 v27, s[36:39], s3 offen lds
    s_add_u32 m0, s77, s73
    s_nop 0
    buffer_load_dwordx4 v28, s[36:39], s3 offen lds
    s_add_u32 m0, s77, s74
    s_nop 0
    buffer_load_dwordx4 v29, s[36:39], s3 offen lds
    s_add_u32 m0, s77, s75
    s_nop 0
    buffer_load_dwordx4 v30, s[36:39], s3 offen lds
    s_add_u32 s78, s78, 128
    s_add_u32 s3, s3, 245760
    s_add_u32 s98, s98, s99
    s_add_u32 s77, s77, 46080
    s_cmp_eq_u32 s77, 138240
    s_cselect_b32 s77, 0, s77
    s_waitcnt vmcnt(11)
    s_barrier
    buffer_load_dword v0, v255, s[44:47], s100 offen
    s_add_u32 s100, s100, s101
    s_add_u32 m0, s77, s65
    s_nop 0
    buffer_load_dwordx4 v16, s[32:35], s78 offen lds
    s_add_u32 m0, s77, s66
    s_nop 0
    buffer_load_dwordx4 v17, s[32:35], s78 offen lds
    s_add_u32 m0, s77, s67
    s_nop 0
    buffer_load_dwordx4 v18, s[32:35], s78 offen lds
    s_add_u32 m0, s77, s68
    s_nop 0
    buffer_load_dwordx4 v19, s[40:43], s98 offen lds
    s_add_u32 m0, s77, s69
    s_nop 0
    buffer_load_dwordx4 v24, s[36:39], s3 offen lds
    s_add_u32 m0, s77, s70
    s_nop 0
    buffer_load_dwordx4 v25, s[36:39], s3 offen lds
    s_add_u32 m0, s77, s71
    s_nop 0
    buffer_load_dwordx4 v26, s[36:39], s3 offen lds
    s_add_u32 m0, s77, s72
    s_nop 0
    buffer_load_dwordx4 v27, s[36:39], s3 offen lds
    s_add_u32 m0, s77, s73
    s_nop 0
    buffer_load_dwordx4 v28, s[36:39], s3 offen lds
    s_add_u32 m0, s77, s74
    s_nop 0
    buffer_load_dwordx4 v29, s[36:39], s3 offen lds
    s_add_u32 m0, s77, s75
    s_nop 0
    buffer_load_dwordx4 v30, s[36:39], s3 offen lds
    s_add_u32 s78, s78, 128
    s_add_u32 s3, s3, 245760
    s_add_u32 s98, s98, s99
    s_add_u32 s77, s77, 46080
    s_cmp_eq_u32 s77, 138240
    s_cselect_b32 s77, 0, s77
    s_waitcnt vmcnt(12)
    s_barrier
    s_add_u32 m0, s77, s65
    s_nop 0
    buffer_load_dwordx4 v16, s[32:35], s78 offen lds
    s_add_u32 m0, s77, s66
    s_nop 0
    buffer_load_dwordx4 v17, s[32:35], s78 offen lds
    s_add_u32 m0, s77, s67
    s_nop 0
    buffer_load_dwordx4 v18, s[32:35], s78 offen lds
    s_add_u32 m0, s77, s68
    s_nop 0
    buffer_load_dwordx4 v19, s[40:43], s98 offen lds
    s_add_u32 m0, s77, s69
    s_nop 0
    buffer_load_dwordx4 v24, s[36:39], s3 offen lds
    s_add_u32 m0, s77, s70
    s_nop 0
    buffer_load_dwordx4 v25, s[36:39], s3 offen lds
    s_add_u32 m0, s77, s71
    s_nop 0
    buffer_load_dwordx4 v26, s[36:39], s3 offen lds
    s_add_u32 m0, s77, s72
    s_nop 0
    buffer_load_dwordx4 v27, s[36:39], s3 offen lds
    s_add_u32 m0, s77, s73
    s_nop 0
    buffer_load_dwordx4 v28, s[36:39], s3 offen lds
    s_add_u32 m0, s77, s74
    s_nop 0
    buffer_load_dwordx4 v29, s[36:39], s3 offen lds
    s_add_u32 m0, s77, s75
    s_nop 0
    buffer_load_dwordx4 v30, s[36:39], s3 offen lds
    s_add_u32 s78, s78, 128
    s_add_u32 s3, s3, 245760
    s_add_u32 s98, s98, s99
    s_add_u32 s77, s77, 46080
    s_cmp_eq_u32 s77, 138240
    s_cselect_b32 s77, 0, s77
    s_waitcnt vmcnt(11)
    s_barrier
    buffer_load_dword v0, v255, s[44:47], s100 offen
    s_add_u32 s100, s100, s101
    s_add_u32 m0, s77, s65
    s_nop 0
    buffer_load_dwordx4 v16, s[32:35], s78 offen lds
    s_add_u32 m0, s77, s66
    s_nop 0
    buffer_load_dwordx4 v17, s[32:35], s78 offen lds
    s_add_u32 m0, s77, s67
    s_nop 0
    buffer_load_dwordx4 v18, s[32:35], s78 offen lds
    s_add_u32 m0, s77, s68
    s_nop 0
    buffer_load_dwordx4 v19, s[40:43], s98 offen lds
    s_add_u32 m0, s77, s69
    s_nop 0
    buffer_load_dwordx4 v24, s[36:39], s3 offen lds
    s_add_u32 m0, s77, s70
    s_nop 0
    buffer_load_dwordx4 v25, s[36:39], s3 offen lds
    s_add_u32 m0, s77, s71
    s_nop 0
    buffer_load_dwordx4 v26, s[36:39], s3 offen lds
    s_add_u32 m0, s77, s72
    s_nop 0
    buffer_load_dwordx4 v27, s[36:39], s3 offen lds
    s_add_u32 m0, s77, s73
    s_nop 0
    buffer_load_dwordx4 v28, s[36:39], s3 offen lds
    s_add_u32 m0, s77, s74
    s_nop 0
    buffer_load_dwordx4 v29, s[36:39], s3 offen lds
    s_add_u32 m0, s77, s75
    s_nop 0
    buffer_load_dwordx4 v30, s[36:39], s3 offen lds
    s_add_u32 s78, s78, 128
    s_add_u32 s3, s3, 245760
    s_add_u32 s98, s98, s99
    s_add_u32 s77, s77, 46080
    s_cmp_eq_u32 s77, 138240
    s_cselect_b32 s77, 0, s77
    s_waitcnt vmcnt(12)
    s_barrier
    s_add_u32 m0, s77, s65
    s_nop 0
    buffer_load_dwordx4 v16, s[32:35], s78 offen lds
    s_add_u32 m0, s77, s66
    s_nop 0
    buffer_load_dwordx4 v17, s[32:35], s78 offen lds
    s_add_u32 m0, s77, s67
    s_nop 0
    buffer_load_dwordx4 v18, s[32:35], s78 offen lds
    s_add_u32 m0, s77, s68
    s_nop 0
    buffer_load_dwordx4 v19, s[40:43], s98 offen lds
    s_add_u32 m0, s77, s69
    s_nop 0
    buffer_load_dwordx4 v24, s[36:39], s3 offen lds
    s_add_u32 m0, s77, s70
    s_nop 0
    buffer_load_dwordx4 v25, s[36:39], s3 offen lds
    s_add_u32 m0, s77, s71
    s_nop 0
    buffer_load_dwordx4 v26, s[36:39], s3 offen lds
    s_add_u32 m0, s77, s72
    s_nop 0
    buffer_load_dwordx4 v27, s[36:39], s3 offen lds
    s_add_u32 m0, s77, s73
    s_nop 0
    buffer_load_dwordx4 v28, s[36:39], s3 offen lds
    s_add_u32 m0, s77, s74
    s_nop 0
    buffer_load_dwordx4 v29, s[36:39], s3 offen lds
    s_add_u32 m0, s77, s75
    s_nop 0
    buffer_load_dwordx4 v30, s[36:39], s3 offen lds
    s_add_u32 s78, s78, 128
    s_add_u32 s3, s3, 245760
    s_add_u32 s98, s98, s99
    s_add_u32 s77, s77, 46080
    s_cmp_eq_u32 s77, 138240
    s_cselect_b32 s77, 0, s77
    s_waitcnt vmcnt(11)
    s_barrier
    buffer_load_dword v0, v255, s[44:47], s100 offen
    s_add_u32 s100, s100, s101
    s_add_u32 m0, s77, s65
    s_nop 0
    buffer_load_dwordx4 v16, s[32:35], s78 offen lds
    s_add_u32 m0, s77, s66
    s_nop 0
    buffer_load_dwordx4 v17, s[32:35], s78 offen lds
    s_add_u32 m0, s77, s67
    s_nop 0
    buffer_load_dwordx4 v18, s[32:35], s78 offen lds
    s_add_u32 m0, s77, s68
    s_nop 0
    buffer_load_dwordx4 v19, s[40:43], s98 offen lds
    s_add_u32 m0, s77, s69
    s_nop 0
    buffer_load_dwordx4 v24, s[36:39], s3 offen lds
    s_add_u32 m0, s77, s70
    s_nop 0
    buffer_load_dwordx4 v25, s[36:39], s3 offen lds
    s_add_u32 m0, s77, s71
    s_nop 0
    buffer_load_dwordx4 v26, s[36:39], s3 offen lds
    s_add_u32 m0, s77, s72
    s_nop 0
    buffer_load_dwordx4 v27, s[36:39], s3 offen lds
    s_add_u32 m0, s77, s73
    s_nop 0
    buffer_load_dwordx4 v28, s[36:39], s3 offen lds
    s_add_u32 m0, s77, s74
    s_nop 0
    buffer_load_dwordx4 v29, s[36:39], s3 offen lds
    s_add_u32 m0, s77, s75
    s_nop 0
    buffer_load_dwordx4 v30, s[36:39], s3 offen lds
    s_add_u32 s78, s78, 128
    s_add_u32 s3, s3, 245760
    s_add_u32 s98, s98, s99
    s_add_u32 s77, s77, 46080
    s_cmp_eq_u32 s77, 138240
    s_cselect_b32 s77, 0, s77
    s_waitcnt vmcnt(12)
    s_barrier
    s_add_u32 m0, s77, s65
    s_nop 0
    buffer_load_dwordx4 v16, s[32:35], s78 offen lds
    s_add_u32 m0, s77, s66
    s_nop 0
    buffer_load_dwordx4 v17, s[32:35], s78 offen lds
    s_add_u32 m0, s77, s67
    s_nop 0
    buffer_load_dwordx4 v18, s[32:35], s78 offen lds
    s_add_u32 m0, s77, s68
    s_nop 0
    buffer_load_dwordx4 v19, s[40:43], s98 offen lds
    s_add_u32 m0, s77, s69
    s_nop 0
    buffer_load_dwordx4 v24, s[36:39], s3 offen lds
    s_add_u32 m0, s77, s70
    s_nop 0
    buffer_load_dwordx4 v25, s[36:39], s3 offen lds
    s_add_u32 m0, s77, s71
    s_nop 0
    buffer_load_dwordx4 v26, s[36:39], s3 offen lds
    s_add_u32 m0, s77, s72
    s_nop 0
    buffer_load_dwordx4 v27, s[36:39], s3 offen lds
    s_add_u32 m0, s77, s73
    s_nop 0
    buffer_load_dwordx4 v28, s[36:39], s3 offen lds
    s_add_u32 m0, s77, s74
    s_nop 0
    buffer_load_dwordx4 v29, s[36:39], s3 offen lds
    s_add_u32 m0, s77, s75
    s_nop 0
    buffer_load_dwordx4 v30, s[36:39], s3 offen lds
    s_add_u32 s78, s78, 128
    s_add_u32 s3, s3, 245760
    s_add_u32 s98, s98, s99
    s_add_u32 s77, s77, 46080
    s_cmp_eq_u32 s77, 138240
    s_cselect_b32 s77, 0, s77
    s_waitcnt vmcnt(11)
    s_barrier
    s_add_u32 m0, s77, s65
    s_nop 0
    buffer_load_dwordx4 v16, s[32:35], s78 offen lds
    s_add_u32 m0, s77, s66
    s_nop 0
    buffer_load_dwordx4 v17, s[32:35], s78 offen lds
    s_add_u32 m0, s77, s67
    s_nop 0
    buffer_load_dwordx4 v18, s[32:35], s78 offen lds
    s_add_u32 m0, s77, s68
    s_nop 0
    buffer_load_dwordx4 v19, s[40:43], s98 offen lds
    s_add_u32 m0, s77, s69
    s_nop 0
    buffer_load_dwordx4 v24, s[36:39], s3 offen lds
    s_add_u32 m0, s77, s70
    s_nop 0
    buffer_load_dwordx4 v25, s[36:39], s3 offen lds
    s_add_u32 m0, s77, s71
    s_nop 0
    buffer_load_dwordx4 v26, s[36:39], s3 offen lds
    s_add_u32 m0, s77, s72
    s_nop 0
    buffer_load_dwordx4 v27, s[36:39], s3 offen lds
    s_add_u32 m0, s77, s73
    s_nop 0
    buffer_load_dwordx4 v28, s[36:39], s3 offen lds
    s_add_u32 m0, s77, s74
    s_nop 0
    buffer_load_dwordx4 v29, s[36:39], s3 offen lds
    s_add_u32 m0, s77, s75
    s_nop 0
    buffer_load_dwordx4 v30, s[36:39], s3 offen lds
    s_add_u32 s78, s78, 128
    s_add_u32 s3, s3, 245760
    s_add_u32 s98, s98, s99
    s_add_u32 s77, s77, 46080
    s_cmp_eq_u32 s77, 138240
    s_cselect_b32 s77, 0, s77
    s_waitcnt vmcnt(11)
    s_barrier
    s_waitcnt vmcnt(0)
    s_barrier
    s_barrier
    s_cmp_ge_u32 s64, 10
    s_cbranch_scc1 AL_NOWO
    s_sub_u32 s57, s28, 4
    s_mov_b32 s32, s8
    s_mov_b32 s33, s9
    s_and_b32 s33, s33, 0xffff
    s_mov_b32 s34, 0xc8000
    s_mov_b32 s35, 0x20000
    v_lshrrev_b32 v1, 3, v10
    v_bfe_u32 v2, v1, 1, 1
    s_and_b32 s52, s57, 1
    s_lshl_b32 s52, s52, 1
    v_or_b32 v2, s52, v2
    v_lshlrev_b32 v2, 1, v2
    v_and_b32 v3, 7, v10
    v_xor_b32 v2, v2, v3
    s_lshl_b32 s52, s57, 3
    v_add_u32 v1, s52, v1
    v_mul_u32_u24 v1, 1280, v1
    v_lshl_add_u32 v1, v2, 4, v1
    s_lshl_b32 s52, s64, 7
    v_add_u32 v1, s52, v1
    s_lshl_b32 s56, s57, 10
    s_mov_b32 s55, 0
    s_add_u32 m0, s56, 0
    s_nop 0
    buffer_load_dwordx4 v1, s[32:35], s55 offen lds
    s_add_u32 s55, s55, 40960
    s_add_u32 m0, s56, 4096
    s_nop 0
    buffer_load_dwordx4 v1, s[32:35], s55 offen lds
    s_add_u32 s55, s55, 40960
    s_add_u32 m0, s56, 8192
    s_nop 0
    buffer_load_dwordx4 v1, s[32:35], s55 offen lds
    s_add_u32 s55, s55, 40960
    s_add_u32 m0, s56, 12288
    s_nop 0
    buffer_load_dwordx4 v1, s[32:35], s55 offen lds
    s_add_u32 s55, s55, 40960
    s_add_u32 m0, s56, 16384
    s_nop 0
    buffer_load_dwordx4 v1, s[32:35], s55 offen lds
    s_add_u32 s55, s55, 40960
    s_add_u32 m0, s56, 20480
    s_nop 0
    buffer_load_dwordx4 v1, s[32:35], s55 offen lds
    s_add_u32 s55, s55, 40960
    s_add_u32 m0, s56, 24576
    s_nop 0
    buffer_load_dwordx4 v1, s[32:35], s55 offen lds
    s_add_u32 s55, s55, 40960
    s_add_u32 m0, s56, 28672
    s_nop 0
    buffer_load_dwordx4 v1, s[32:35], s55 offen lds
    s_add_u32 s55, s55, 40960
AL_NOWO:
    s_barrier
    s_cmp_ge_u32 s64, 10
    s_cbranch_scc1 AL_NOWO2
    s_add_u32 m0, s56, 32768
    s_nop 0
    buffer_load_dwordx4 v1, s[32:35], s55 offen lds
    s_add_u32 s55, s55, 40960
    s_add_u32 m0, s56, 36864
    s_nop 0
    buffer_load_dwordx4 v1, s[32:35], s55 offen lds
    s_add_u32 s55, s55, 40960
    s_add_u32 m0, s56, 40960
    s_nop 0
    buffer_load_dwordx4 v1, s[32:35], s55 offen lds
    s_add_u32 s55, s55, 40960
    s_add_u32 m0, s56, 45056
    s_nop 0
    buffer_load_dwordx4 v1, s[32:35], s55 offen lds
    s_add_u32 s55, s55, 40960
    s_add_u32 m0, s56, 49152
    s_nop 0
    buffer_load_dwordx4 v1, s[32:35], s55 offen lds
    s_add_u32 s55, s55, 40960
    s_add_u32 m0, s56, 53248
    s_nop 0
    buffer_load_dwordx4 v1, s[32:35], s55 offen lds
    s_add_u32 s55, s55, 40960
    s_add_u32 m0, s56, 57344
    s_nop 0
    buffer_load_dwordx4 v1, s[32:35], s55 offen lds
    s_add_u32 s55, s55, 40960
    s_add_u32 m0, s56, 61440
    s_nop 0
    buffer_load_dwordx4 v1, s[32:35], s55 offen lds
    s_add_u32 s55, s55, 40960
    s_add_u32 m0, s56, 65536
    s_nop 0
    buffer_load_dwordx4 v1, s[32:35], s55 offen lds
    s_add_u32 s55, s55, 40960
    s_add_u32 m0, s56, 69632
    s_nop 0
    buffer_load_dwordx4 v1, s[32:35], s55 offen lds
    s_add_u32 s55, s55, 40960
    s_add_u32 m0, s56, 73728
    s_nop 0
    buffer_load_dwordx4 v1, s[32:35], s55 offen lds
    s_add_u32 s55, s55, 40960
    s_add_u32 m0, s56, 77824
    s_nop 0
    buffer_load_dwordx4 v1, s[32:35], s55 offen lds
AL_NOWO2:
    s_add_u32 s48, s26, 0x500000
    s_addc_u32 s49, s27, 0
    s_and_b32 s49, s49, 0xffff
    s_mov_b32 s50, 0x8000
    s_mov_b32 s51, 0x20000
    s_cmp_eq_u32 s28, 4
    s_cbranch_scc0 AL_NF0
    s_add_u32 s54, s26, 0x510000
    s_addc_u32 s55, s27, 0
    s_load_dword s62, s[54:55], 0
    v_lshrrev_b32 v1, 3, v10
    v_mul_u32_u24 v1, 127, v1
    s_lshl_b32 s52, s63, 7
    v_add_u32 v1, s52, v1
    v_mul_u32_u24 v1, 43691, v1
    v_lshrrev_b32 v1, 22, v1
    v_and_b32 v2, 7, v10
    v_lshl_add_u32 v1, v1, 3, v2
    v_lshlrev_b32 v3, 7, v1
    s_lshl_b32 s53, s30, 3
    s_add_u32 s53, s53, s31
    s_waitcnt lgkmcnt(0)
    s_mov_b32 s79, s62
    s_mul_i32 s62, s62, 0x9e3779b1
    s_add_u32 s62, s62, 0x85ebca6b
AL_NF0:
    s_barrier
    s_cmp_eq_u32 s28, 4
    s_cbranch_scc0 AL_NF1
    s_lshl_b32 s52, s53, 7
    s_mov_b64 exec, 1
    v_mov_b32 v1, s52
    v_mov_b32 v2, s62
    buffer_store_dword v2, v1, s[48:51], 0 offen sc1
    s_mov_b64 exec, -1
    s_cmp_eq_u32 s29, 175
    s_cbranch_scc1 AL_SEED
    s_cmp_ge_u32 s64, 10
    s_cbranch_scc1 AL_END
    v_mov_b32 v1, v3
    s_mov_b64 exec, 0xffff
    s_mov_b32 s52, 0
    buffer_load_dword v2, v1, s[48:51], 0 offen sc1
    s_sleep 2
    buffer_load_dword v3, v1, s[48:51], 0 offen sc1
    s_sleep 2
POLL_A:
    buffer_load_dword v4, v1, s[48:51], 0 offen sc1
    s_waitcnt vmcnt(2)
    v_cmp_ne_u32 vcc, s62, v2
    s_add_u32 s52, s52, 1
    s_nop 0
    s_cmp_eq_u64 vcc, 0
    s_cbranch_scc1 POLLED_A
    s_sleep 2
    buffer_load_dword v2, v1, s[48:51], 0 offen sc1
    s_waitcnt vmcnt(2)
    v_cmp_ne_u32 vcc, s62, v3
    s_add_u32 s52, s52, 1
    s_nop 0
    s_cmp_eq_u64 vcc, 0
    s_cbranch_scc1 POLLED_A
    s_sleep 2
    buffer_load_dword v3, v1, s[48:51], 0 offen sc1
    s_waitcnt vmcnt(2)
    v_cmp_ne_u32 vcc, s62, v4
    s_add_u32 s52, s52, 1
    s_nop 0
    s_cmp_eq_u64 vcc, 0
    s_cbranch_scc1 POLLED_A
    s_sleep 2
    s_cmp_gt_u32 s52, 400000
    s_cbranch_scc0 POLL_A
POLLED_A:
    s_mov_b64 exec, -1
    s_barrier
    s_branch AL_END
AL_NF1:
    s_cmp_ge_u32 s64, 10
    s_cbranch_scc1 AL_END
    s_waitcnt vmcnt(0)
    s_barrier
    s_branch AL_END
AL_SEED:
    v_add_u32 v1, 0, v10
    v_lshlrev_b32 v1, 7, v1
    s_mov_b64 exec, -1
    s_mov_b32 s52, 0
    buffer_load_dword v2, v1, s[48:51], 0 offen sc1
    s_sleep 2
    buffer_load_dword v3, v1, s[48:51], 0 offen sc1
    s_sleep 2
POLL_S0:
    buffer_load_dword v4, v1, s[48:51], 0 offen sc1
    s_waitcnt vmcnt(2)
    v_cmp_ne_u32 vcc, s62, v2
    s_add_u32 s52, s52, 1
    s_nop 0
    s_cmp_eq_u64 vcc, 0
    s_cbranch_scc1 POLLED_S0
    s_sleep 2
    buffer_load_dword v2, v1, s[48:51], 0 offen sc1
    s_waitcnt vmcnt(2)
    v_cmp_ne_u32 vcc, s62, v3
    s_add_u32 s52, s52, 1
    s_nop 0
    s_cmp_eq_u64 vcc, 0
    s_cbranch_scc1 POLLED_S0
    s_sleep 2
    buffer_load_dword v3, v1, s[48:51], 0 offen sc1
    s_waitcnt vmcnt(2)
    v_cmp_ne_u32 vcc, s62, v4
    s_add_u32 s52, s52, 1
    s_nop 0
    s_cmp_eq_u64 vcc, 0
    s_cbranch_scc1 POLLED_S0
    s_sleep 2
    s_cmp_gt_u32 s52, 400000
    s_cbranch_scc0 POLL_S0
POLLED_S0:
    s_mov_b64 exec, -1
    s_waitcnt vmcnt(0)
    v_add_u32 v1, 64, v10
    v_lshlrev_b32 v1, 7, v1
    s_mov_b64 exec, -1
    s_mov_b32 s52, 0
    buffer_load_dword v2, v1, s[48:51], 0 offen sc1
    s_sleep 2
    buffer_load_dword v3, v1, s[48:51], 0 offen sc1
    s_sleep 2
POLL_S1:
    buffer_load_dword v4, v1, s[48:51], 0 offen sc1
    s_waitcnt vmcnt(2)
    v_cmp_ne_u32 vcc, s62, v2
    s_add_u32 s52, s52, 1
    s_nop 0
    s_cmp_eq_u64 vcc, 0
    s_cbranch_scc1 POLLED_S1
    s_sleep 2
    buffer_load_dword v2, v1, s[48:51], 0 offen sc1
    s_waitcnt vmcnt(2)
    v_cmp_ne_u32 vcc, s62, v3
    s_add_u32 s52, s52, 1
    s_nop 0
    s_cmp_eq_u64 vcc, 0
    s_cbranch_scc1 POLLED_S1
    s_sleep 2
    buffer_load_dword v3, v1, s[48:51], 0 offen sc1
    s_waitcnt vmcnt(2)
    v_cmp_ne_u32 vcc, s62, v4
    s_add_u32 s52, s52, 1
    s_nop 0
    s_cmp_eq_u64 vcc, 0
    s_cbranch_scc1 POLLED_S1
    s_sleep 2
    s_cmp_gt_u32 s52, 400000
    s_cbranch_scc0 POLL_S1
POLLED_S1:
    s_mov_b64 exec, -1
    s_waitcnt vmcnt(0)
    v_add_u32 v1, 128, v10
    v_lshlrev_b32 v1, 7, v1
    s_mov_b64 exec, -1
    s_mov_b32 s52, 0
    buffer_load_dword v2, v1, s[48:51], 0 offen sc1
    s_sleep 2
    buffer_load_dword v3, v1, s[48:51], 0 offen sc1
    s_sleep 2
POLL_S2:
    buffer_load_dword v4, v1, s[48:51], 0 offen sc1
    s_waitcnt vmcnt(2)
    v_cmp_ne_u32 vcc, s62, v2
    s_add_u32 s52, s52, 1
    s_nop 0
    s_cmp_eq_u64 vcc, 0
    s_cbranch_scc1 POLLED_S2
    s_sleep 2
    buffer_load_dword v2, v1, s[48:51], 0 offen sc1
    s_waitcnt vmcnt(2)
    v_cmp_ne_u32 vcc, s62, v3
    s_add_u32 s52, s52, 1
    s_nop 0
    s_cmp_eq_u64 vcc, 0
    s_cbranch_scc1 POLLED_S2
    s_sleep 2
    buffer_load_dword v3, v1, s[48:51], 0 offen sc1
    s_waitcnt vmcnt(2)
    v_cmp_ne_u32 vcc, s62, v4
    s_add_u32 s52, s52, 1
    s_nop 0
    s_cmp_eq_u64 vcc, 0
    s_cbranch_scc1 POLLED_S2
    s_sleep 2
    s_cmp_gt_u32 s52, 400000
    s_cbranch_scc0 POLL_S2
POLLED_S2:
    s_mov_b64 exec, -1
    s_waitcnt vmcnt(0)
    v_add_u32 v1, 192, v10
    v_lshlrev_b32 v1, 7, v1
    s_mov_b64 exec, -1
    s_mov_b32 s52, 0
    buffer_load_dword v2, v1, s[48:51], 0 offen sc1
    s_sleep 2
    buffer_load_dword v3, v1, s[48:51], 0 offen sc1
    s_sleep 2
POLL_S3:
    buffer_load_dword v4, v1, s[48:51], 0 offen sc1
    s_waitcnt vmcnt(2)
    v_cmp_ne_u32 vcc, s62, v2
    s_add_u32 s52, s52, 1
    s_nop 0
    s_cmp_eq_u64 vcc, 0
    s_cbranch_scc1 POLLED_S3
    s_sleep 2
    buffer_load_dword v2, v1, s[48:51], 0 offen sc1
    s_waitcnt vmcnt(2)
    v_cmp_ne_u32 vcc, s62, v3
    s_add_u32 s52, s52, 1
    s_nop 0
    s_cmp_eq_u64 vcc, 0
    s_cbranch_scc1 POLLED_S3
    s_sleep 2
    buffer_load_dword v3, v1, s[48:51], 0 offen sc1
    s_waitcnt vmcnt(2)
    v_cmp_ne_u32 vcc, s62, v4
    s_add_u32 s52, s52, 1
    s_nop 0
    s_cmp_eq_u64 vcc, 0
    s_cbranch_scc1 POLLED_S3
    s_sleep 2
    s_cmp_gt_u32 s52, 400000
    s_cbranch_scc0 POLL_S3
POLLED_S3:
    s_mov_b64 exec, -1
    s_waitcnt vmcnt(0)
    s_add_u32 s44, s26, 0x510000
    s_addc_u32 s45, s27, 0
    s_and_b32 s45, s45, 0xffff
    s_mov_b32 s46, 0x40
    s_mov_b32 s47, 0x20000
    s_add_u32 s79, s79, 1
    s_mov_b64 exec, 1
    v_mov_b32 v1, 0
    v_mov_b32 v2, s79
    buffer_store_dword v2, v1, s[44:47], 0 offen sc1
    s_mov_b64 exec, -1
AL_END:
    s_endpgm
B1_REST:
    s_lshl_b32 s52, s29, 3
    s_add_u32 s52, s52, s28
    s_and_b32 s53, s52, 0xfffffffe
    s_lshl_b32 s53, s53, 1
    s_add_u32 s54, s20, s53
    s_addc_u32 s55, s21, 0
    s_load_dword s64, s[54:55], 0
    s_add_u32 s40, s26, 0x280000
    s_addc_u32 s41, s27, 0
    s_and_b32 s41, s41, 0xffff
    s_mov_b32 s42, 0x280000
    s_mov_b32 s43, 0x20000
    s_lshl_b32 s52, s63, 18
    s_lshl_b32 s53, s30, 8
    s_sub_u32 s52, s52, s53
    s_add_u32 s52, s52, 4080
    v_lshlrev_b32 v5, 15, v13
    v_lshlrev_b32 v14, 4, v12
    v_sub_u32 v5, v5, v14
    v_add_u32 v5, s52, v5
    s_mov_b32 s52, 0x05040100
    s_mov_b32 s53, 0x07060302
    s_mov_b32 s54, 0
    s_waitcnt vmcnt(0)
    v_perm_b32 v108, v16, v20, s52
    v_perm_b32 v109, v20, v24, s52
    v_perm_b32 v110, v24, v28, s52
    v_perm_b32 v111, v28, v32, s52
    v_perm_b32 v112, v32, v36, s52
    v_perm_b32 v113, v36, v40, s52
    v_perm_b32 v114, v40, v44, s52
    v_perm_b32 v115, v44, v48, s52
    v_perm_b32 v116, v48, v52, s52
    v_perm_b32 v117, v52, v56, s52
    v_dot2_f32_bf16 v120, v108, v93, 0
    v_dot2_f32_bf16 v121, v109, v93, 0
    v_dot2_f32_bf16 v122, v110, v93, 0
    v_dot2_f32_bf16 v123, v111, v93, 0
    v_dot2_f32_bf16 v124, v112, v93, 0
    v_dot2_f32_bf16 v125, v113, v93, 0
    v_dot2_f32_bf16 v126, v114, v93, 0
    v_dot2_f32_bf16 v127, v115, v93, 0
    v_lshlrev_b32 v128, 16, v60
    v_lshlrev_b32 v129, 16, v64
    v_lshlrev_b32 v130, 16, v68
    v_lshlrev_b32 v131, 16, v72
    v_lshlrev_b32 v132, 16, v76
    v_lshlrev_b32 v133, 16, v80
    v_lshlrev_b32 v134, 16, v84
    v_lshlrev_b32 v135, 16, v88
    v_dot2_f32_bf16 v120, v110, v92, v120
    v_dot2_f32_bf16 v121, v111, v92, v121
    v_dot2_f32_bf16 v122, v112, v92, v122
    v_dot2_f32_bf16 v123, v113, v92, v123
    v_dot2_f32_bf16 v124, v114, v92, v124
    v_dot2_f32_bf16 v125, v115, v92, v125
    v_dot2_f32_bf16 v126, v116, v92, v126
    v_dot2_f32_bf16 v127, v117, v92, v127
    v_mul_f32 v120, v120, v128
    v_mul_f32 v121, v121, v129
    v_mul_f32 v122, v122, v130
    v_mul_f32 v123, v123, v131
    v_mul_f32 v124, v124, v132
    v_mul_f32 v125, v125, v133
    v_mul_f32 v126, v126, v134
    v_mul_f32 v127, v127, v135
    v_cvt_pk_bf16_f32 v136, v127, v126
    v_cvt_pk_bf16_f32 v137, v125, v124
    v_cvt_pk_bf16_f32 v138, v123, v122
    v_cvt_pk_bf16_f32 v139, v121, v120
    buffer_store_dwordx4 v[136:139], v5, s[40:43], s54 offen sc1
    s_add_u32 s54, s54, 4096
    v_perm_b32 v108, v16, v20, s53
    v_perm_b32 v109, v20, v24, s53
    v_perm_b32 v110, v24, v28, s53
    v_perm_b32 v111, v28, v32, s53
    v_perm_b32 v112, v32, v36, s53
    v_perm_b32 v113, v36, v40, s53
    v_perm_b32 v114, v40, v44, s53
    v_perm_b32 v115, v44, v48, s53
    v_perm_b32 v116, v48, v52, s53
    v_perm_b32 v117, v52, v56, s53
    v_dot2_f32_bf16 v120, v108, v95, 0
    v_dot2_f32_bf16 v121, v109, v95, 0
    v_dot2_f32_bf16 v122, v110, v95, 0
    v_dot2_f32_bf16 v123, v111, v95, 0
    v_dot2_f32_bf16 v124, v112, v95, 0
    v_dot2_f32_bf16 v125, v113, v95, 0
    v_dot2_f32_bf16 v126, v114, v95, 0
    v_dot2_f32_bf16 v127, v115, v95, 0
    v_and_b32 v128, 0xffff0000, v60
    v_and_b32 v129, 0xffff0000, v64
    v_and_b32 v130, 0xffff0000, v68
    v_and_b32 v131, 0xffff0000, v72
    v_and_b32 v132, 0xffff0000, v76
    v_and_b32 v133, 0xffff0000, v80
    v_and_b32 v134, 0xffff0000, v84
    v_and_b32 v135, 0xffff0000, v88
    v_dot2_f32_bf16 v120, v110, v94, v120
    v_dot2_f32_bf16 v121, v111, v94, v121
    v_dot2_f32_bf16 v122, v112, v94, v122
    v_dot2_f32_bf16 v123, v113, v94, v123
    v_dot2_f32_bf16 v124, v114, v94, v124
    v_dot2_f32_bf16 v125, v115, v94, v125
    v_dot2_f32_bf16 v126, v116, v94, v126
    v_dot2_f32_bf16 v127, v117, v94, v127
    v_mul_f32 v120, v120, v128
    v_mul_f32 v121, v121, v129
    v_mul_f32 v122, v122, v130
    v_mul_f32 v123, v123, v131
    v_mul_f32 v124, v124, v132
    v_mul_f32 v125, v125, v133
    v_mul_f32 v126, v126, v134
    v_mul_f32 v127, v127, v135
    v_cvt_pk_bf16_f32 v140, v127, v126
    v_cvt_pk_bf16_f32 v141, v125, v124
    v_cvt_pk_bf16_f32 v142, v123, v122
    v_cvt_pk_bf16_f32 v143, v121, v120
    buffer_store_dwordx4 v[140:143], v5, s[40:43], s54 offen sc1
    s_add_u32 s54, s54, 4096
    v_perm_b32 v108, v17, v21, s52
    v_perm_b32 v109, v21, v25, s52
    v_perm_b32 v110, v25, v29, s52
    v_perm_b32 v111, v29, v33, s52
    v_perm_b32 v112, v33, v37, s52
    v_perm_b32 v113, v37, v41, s52
    v_perm_b32 v114, v41, v45, s52
    v_perm_b32 v115, v45, v49, s52
    v_perm_b32 v116, v49, v53, s52
    v_perm_b32 v117, v53, v57, s52
    v_dot2_f32_bf16 v120, v108, v97, 0
    v_dot2_f32_bf16 v121, v109, v97, 0
    v_dot2_f32_bf16 v122, v110, v97, 0
    v_dot2_f32_bf16 v123, v111, v97, 0
    v_dot2_f32_bf16 v124, v112, v97, 0
    v_dot2_f32_bf16 v125, v113, v97, 0
    v_dot2_f32_bf16 v126, v114, v97, 0
    v_dot2_f32_bf16 v127, v115, v97, 0
    v_lshlrev_b32 v128, 16, v61
    v_lshlrev_b32 v129, 16, v65
    v_lshlrev_b32 v130, 16, v69
    v_lshlrev_b32 v131, 16, v73
    v_lshlrev_b32 v132, 16, v77
    v_lshlrev_b32 v133, 16, v81
    v_lshlrev_b32 v134, 16, v85
    v_lshlrev_b32 v135, 16, v89
    v_dot2_f32_bf16 v120, v110, v96, v120
    v_dot2_f32_bf16 v121, v111, v96, v121
    v_dot2_f32_bf16 v122, v112, v96, v122
    v_dot2_f32_bf16 v123, v113, v96, v123
    v_dot2_f32_bf16 v124, v114, v96, v124
    v_dot2_f32_bf16 v125, v115, v96, v125
    v_dot2_f32_bf16 v126, v116, v96, v126
    v_dot2_f32_bf16 v127, v117, v96, v127
    v_mul_f32 v120, v120, v128
    v_mul_f32 v121, v121, v129
    v_mul_f32 v122, v122, v130
    v_mul_f32 v123, v123, v131
    v_mul_f32 v124, v124, v132
    v_mul_f32 v125, v125, v133
    v_mul_f32 v126, v126, v134
    v_mul_f32 v127, v127, v135
    v_cvt_pk_bf16_f32 v136, v127, v126
    v_cvt_pk_bf16_f32 v137, v125, v124
    v_cvt_pk_bf16_f32 v138, v123, v122
    v_cvt_pk_bf16_f32 v139, v121, v120
    buffer_store_dwordx4 v[136:139], v5, s[40:43], s54 offen sc1
    s_add_u32 s54, s54, 4096
    v_perm_b32 v108, v17, v21, s53
    v_perm_b32 v109, v21, v25, s53
    v_perm_b32 v110, v25, v29, s53
    v_perm_b32 v111, v29, v33, s53
    v_perm_b32 v112, v33, v37, s53
    v_perm_b32 v113, v37, v41, s53
    v_perm_b32 v114, v41, v45, s53
    v_perm_b32 v115, v45, v49, s53
    v_perm_b32 v116, v49, v53, s53
    v_perm_b32 v117, v53, v57, s53
    v_dot2_f32_bf16 v120, v108, v99, 0
    v_dot2_f32_bf16 v121, v109, v99, 0
    v_dot2_f32_bf16 v122, v110, v99, 0
    v_dot2_f32_bf16 v123, v111, v99, 0
    v_dot2_f32_bf16 v124, v112, v99, 0
    v_dot2_f32_bf16 v125, v113, v99, 0
    v_dot2_f32_bf16 v126, v114, v99, 0
    v_dot2_f32_bf16 v127, v115, v99, 0
    v_and_b32 v128, 0xffff0000, v61
    v_and_b32 v129, 0xffff0000, v65
    v_and_b32 v130, 0xffff0000, v69
    v_and_b32 v131, 0xffff0000, v73
    v_and_b32 v132, 0xffff0000, v77
    v_and_b32 v133, 0xffff0000, v81
    v_and_b32 v134, 0xffff0000, v85
    v_and_b32 v135, 0xffff0000, v89
    v_dot2_f32_bf16 v120, v110, v98, v120
    v_dot2_f32_bf16 v121, v111, v98, v121
    v_dot2_f32_bf16 v122, v112, v98, v122
    v_dot2_f32_bf16 v123, v113, v98, v123
    v_dot2_f32_bf16 v124, v114, v98, v124
    v_dot2_f32_bf16 v125, v115, v98, v125
    v_dot2_f32_bf16 v126, v116, v98, v126
    v_dot2_f32_bf16 v127, v117, v98, v127
    v_mul_f32 v120, v120, v128
    v_mul_f32 v121, v121, v129
    v_mul_f32 v122, v122, v130
    v_mul_f32 v123, v123, v131
    v_mul_f32 v124, v124, v132
    v_mul_f32 v125, v125, v133
    v_mul_f32 v126, v126, v134
    v_mul_f32 v127, v127, v135
    v_cvt_pk_bf16_f32 v140, v127, v126
    v_cvt_pk_bf16_f32 v141, v125, v124
    v_cvt_pk_bf16_f32 v142, v123, v122
    v_cvt_pk_bf16_f32 v143, v121, v120
    buffer_store_dwordx4 v[140:143], v5, s[40:43], s54 offen sc1
    s_add_u32 s54, s54, 4096
    v_perm_b32 v108, v18, v22, s52
    v_perm_b32 v109, v22, v26, s52
    v_perm_b32 v110, v26, v30, s52
    v_perm_b32 v111, v30, v34, s52
    v_perm_b32 v112, v34, v38, s52
    v_perm_b32 v113, v38, v42, s52
    v_perm_b32 v114, v42, v46, s52
    v_perm_b32 v115, v46, v50, s52
    v_perm_b32 v116, v50, v54, s52
    v_perm_b32 v117, v54, v58, s52
    v_dot2_f32_bf16 v120, v108, v101, 0
    v_dot2_f32_bf16 v121, v109, v101, 0
    v_dot2_f32_bf16 v122, v110, v101, 0
    v_dot2_f32_bf16 v123, v111, v101, 0
    v_dot2_f32_bf16 v124, v112, v101, 0
    v_dot2_f32_bf16 v125, v113, v101, 0
    v_dot2_f32_bf16 v126, v114, v101, 0
    v_dot2_f32_bf16 v127, v115, v101, 0
    v_lshlrev_b32 v128, 16, v62
    v_lshlrev_b32 v129, 16, v66
    v_lshlrev_b32 v130, 16, v70
    v_lshlrev_b32 v131, 16, v74
    v_lshlrev_b32 v132, 16, v78
    v_lshlrev_b32 v133, 16, v82
    v_lshlrev_b32 v134, 16, v86
    v_lshlrev_b32 v135, 16, v90
    v_dot2_f32_bf16 v120, v110, v100, v120
    v_dot2_f32_bf16 v121, v111, v100, v121
    v_dot2_f32_bf16 v122, v112, v100, v122
    v_dot2_f32_bf16 v123, v113, v100, v123
    v_dot2_f32_bf16 v124, v114, v100, v124
    v_dot2_f32_bf16 v125, v115, v100, v125
    v_dot2_f32_bf16 v126, v116, v100, v126
    v_dot2_f32_bf16 v127, v117, v100, v127
    v_mul_f32 v120, v120, v128
    v_mul_f32 v121, v121, v129
    v_mul_f32 v122, v122, v130
    v_mul_f32 v123, v123, v131
    v_mul_f32 v124, v124, v132
    v_mul_f32 v125, v125, v133
    v_mul_f32 v126, v126, v134
    v_mul_f32 v127, v127, v135
    v_cvt_pk_bf16_f32 v136, v127, v126
    v_cvt_pk_bf16_f32 v137, v125, v124
    v_cvt_pk_bf16_f32 v138, v123, v122
    v_cvt_pk_bf16_f32 v139, v121, v120
    buffer_store_dwordx4 v[136:139], v5, s[40:43], s54 offen sc1
    s_add_u32 s54, s54, 4096
    v_perm_b32 v108, v18, v22, s53
    v_perm_b32 v109, v22, v26, s53
    v_perm_b32 v110, v26, v30, s53
    v_perm_b32 v111, v30, v34, s53
    v_perm_b32 v112, v34, v38, s53
    v_perm_b32 v113, v38, v42, s53
    v_perm_b32 v114, v42, v46, s53
    v_perm_b32 v115, v46, v50, s53
    v_perm_b32 v116, v50, v54, s53
    v_perm_b32 v117, v54, v58, s53
    v_dot2_f32_bf16 v120, v108, v103, 0
    v_dot2_f32_bf16 v121, v109, v103, 0
    v_dot2_f32_bf16 v122, v110, v103, 0
    v_dot2_f32_bf16 v123, v111, v103, 0
    v_dot2_f32_bf16 v124, v112, v103, 0
    v_dot2_f32_bf16 v125, v113, v103, 0
    v_dot2_f32_bf16 v126, v114, v103, 0
    v_dot2_f32_bf16 v127, v115, v103, 0
    v_and_b32 v128, 0xffff0000, v62
    v_and_b32 v129, 0xffff0000, v66
    v_and_b32 v130, 0xffff0000, v70
    v_and_b32 v131, 0xffff0000, v74
    v_and_b32 v132, 0xffff0000, v78
    v_and_b32 v133, 0xffff0000, v82
    v_and_b32 v134, 0xffff0000, v86
    v_and_b32 v135, 0xffff0000, v90
    v_dot2_f32_bf16 v120, v110, v102, v120
    v_dot2_f32_bf16 v121, v111, v102, v121
    v_dot2_f32_bf16 v122, v112, v102, v122
    v_dot2_f32_bf16 v123, v113, v102, v123
    v_dot2_f32_bf16 v124, v114, v102, v124
    v_dot2_f32_bf16 v125, v115, v102, v125
    v_dot2_f32_bf16 v126, v116, v102, v126
    v_dot2_f32_bf16 v127, v117, v102, v127
    v_mul_f32 v120, v120, v128
    v_mul_f32 v121, v121, v129
    v_mul_f32 v122, v122, v130
    v_mul_f32 v123, v123, v131
    v_mul_f32 v124, v124, v132
    v_mul_f32 v125, v125, v133
    v_mul_f32 v126, v126, v134
    v_mul_f32 v127, v127, v135
    v_cvt_pk_bf16_f32 v140, v127, v126
    v_cvt_pk_bf16_f32 v141, v125, v124
    v_cvt_pk_bf16_f32 v142, v123, v122
    v_cvt_pk_bf16_f32 v143, v121, v120
    buffer_store_dwordx4 v[140:143], v5, s[40:43], s54 offen sc1
    s_add_u32 s54, s54, 4096
    v_perm_b32 v108, v19, v23, s52
    v_perm_b32 v109, v23, v27, s52
    v_perm_b32 v110, v27, v31, s52
    v_perm_b32 v111, v31, v35, s52
    v_perm_b32 v112, v35, v39, s52
    v_perm_b32 v113, v39, v43, s52
    v_perm_b32 v114, v43, v47, s52
    v_perm_b32 v115, v47, v51, s52
    v_perm_b32 v116, v51, v55, s52
    v_perm_b32 v117, v55, v59, s52
    v_dot2_f32_bf16 v120, v108, v105, 0
    v_dot2_f32_bf16 v121, v109, v105, 0
    v_dot2_f32_bf16 v122, v110, v105, 0
    v_dot2_f32_bf16 v123, v111, v105, 0
    v_dot2_f32_bf16 v124, v112, v105, 0
    v_dot2_f32_bf16 v125, v113, v105, 0
    v_dot2_f32_bf16 v126, v114, v105, 0
    v_dot2_f32_bf16 v127, v115, v105, 0
    v_lshlrev_b32 v128, 16, v63
    v_lshlrev_b32 v129, 16, v67
    v_lshlrev_b32 v130, 16, v71
    v_lshlrev_b32 v131, 16, v75
    v_lshlrev_b32 v132, 16, v79
    v_lshlrev_b32 v133, 16, v83
    v_lshlrev_b32 v134, 16, v87
    v_lshlrev_b32 v135, 16, v91
    v_dot2_f32_bf16 v120, v110, v104, v120
    v_dot2_f32_bf16 v121, v111, v104, v121
    v_dot2_f32_bf16 v122, v112, v104, v122
    v_dot2_f32_bf16 v123, v113, v104, v123
    v_dot2_f32_bf16 v124, v114, v104, v124
    v_dot2_f32_bf16 v125, v115, v104, v125
    v_dot2_f32_bf16 v126, v116, v104, v126
    v_dot2_f32_bf16 v127, v117, v104, v127
    v_mul_f32 v120, v120, v128
    v_mul_f32 v121, v121, v129
    v_mul_f32 v122, v122, v130
    v_mul_f32 v123, v123, v131
    v_mul_f32 v124, v124, v132
    v_mul_f32 v125, v125, v133
    v_mul_f32 v126, v126, v134
    v_mul_f32 v127, v127, v135
    v_cvt_pk_bf16_f32 v136, v127, v126
    v_cvt_pk_bf16_f32 v137, v125, v124
    v_cvt_pk_bf16_f32 v138, v123, v122
    v_cvt_pk_bf16_f32 v139, v121, v120
    buffer_store_dwordx4 v[136:139], v5, s[40:43], s54 offen sc1
    s_add_u32 s54, s54, 4096
    v_perm_b32 v108, v19, v23, s53
    v_perm_b32 v109, v23, v27, s53
    v_perm_b32 v110, v27, v31, s53
    v_perm_b32 v111, v31, v35, s53
    v_perm_b32 v112, v35, v39, s53
    v_perm_b32 v113, v39, v43, s53
    v_perm_b32 v114, v43, v47, s53
    v_perm_b32 v115, v47, v51, s53
    v_perm_b32 v116, v51, v55, s53
    v_perm_b32 v117, v55, v59, s53
    v_dot2_f32_bf16 v120, v108, v107, 0
    v_dot2_f32_bf16 v121, v109, v107, 0
    v_dot2_f32_bf16 v122, v110, v107, 0
    v_dot2_f32_bf16 v123, v111, v107, 0
    v_dot2_f32_bf16 v124, v112, v107, 0
    v_dot2_f32_bf16 v125, v113, v107, 0
    v_dot2_f32_bf16 v126, v114, v107, 0
    v_dot2_f32_bf16 v127, v115, v107, 0
    v_and_b32 v128, 0xffff0000, v63
    v_and_b32 v129, 0xffff0000, v67
    v_and_b32 v130, 0xffff0000, v71
    v_and_b32 v131, 0xffff0000, v75
    v_and_b32 v132, 0xffff0000, v79
    v_and_b32 v133, 0xffff0000, v83
    v_and_b32 v134, 0xffff0000, v87
    v_and_b32 v135, 0xffff0000, v91
    v_dot2_f32_bf16 v120, v110, v106, v120
    v_dot2_f32_bf16 v121, v111, v106, v121
    v_dot2_f32_bf16 v122, v112, v106, v122
    v_dot2_f32_bf16 v123, v113, v106, v123
    v_dot2_f32_bf16 v124, v114, v106, v124
    v_dot2_f32_bf16 v125, v115, v106, v125
    v_dot2_f32_bf16 v126, v116, v106, v126
    v_dot2_f32_bf16 v127, v117, v106, v127
    v_mul_f32 v120, v120, v128
    v_mul_f32 v121, v121, v129
    v_mul_f32 v122, v122, v130
    v_mul_f32 v123, v123, v131
    v_mul_f32 v124, v124, v132
    v_mul_f32 v125, v125, v133
    v_mul_f32 v126, v126, v134
    v_mul_f32 v127, v127, v135
    v_cvt_pk_bf16_f32 v140, v127, v126
    v_cvt_pk_bf16_f32 v141, v125, v124
    v_cvt_pk_bf16_f32 v142, v123, v122
    v_cvt_pk_bf16_f32 v143, v121, v120
    buffer_store_dwordx4 v[140:143], v5, s[40:43], s54 offen sc1
    s_barrier
    s_waitcnt vmcnt(0)
    s_barrier
    s_branch B_JOIN
B_HELP:
    s_waitcnt lgkmcnt(0)
    s_add_u32 s54, s26, 0x510000
    s_addc_u32 s55, s27, 0
    s_load_dword s62, s[54:55], 0
    s_lshl_b32 s52, s29, 3
    s_add_u32 s52, s52, s28
    s_and_b32 s53, s52, 0xfffffffe
    s_lshl_b32 s53, s53, 1
    s_add_u32 s54, s20, s53
    s_addc_u32 s55, s21, 0
    s_load_dword s64, s[54:55], 0
    s_barrier
    s_waitcnt lgkmcnt(0)
    s_mov_b32 s79, s62
    s_mul_i32 s62, s62, 0x9e3779b1
    s_add_u32 s62, s62, 0x85ebca6b
    s_barrier
    s_sub_u32 s56, s28, 4
    s_lshl_b32 s56, s56, 1
    s_lshl_b32 s52, s29, 3
    s_add_u32 s52, s52, s56
    v_lshlrev_b32 v6, 4, v10
    s_add_u32 s53, s52, 0
    s_lshl_b32 s53, s53, 12
    s_add_u32 s44, s18, s53
    s_addc_u32 s45, s19, 0
    s_and_b32 s45, s45, 0xffff
    s_mov_b32 s46, 4096
    s_mov_b32 s47, 0x20000
    buffer_load_dwordx4 v[16:19], v6, s[44:47], 0 offen offset:0 nt
    buffer_load_dwordx4 v[20:23], v6, s[44:47], 0 offen offset:1024 nt
    buffer_load_dwordx4 v[24:27], v6, s[44:47], 0 offen offset:2048 nt
    buffer_load_dwordx4 v[28:31], v6, s[44:47], 0 offen offset:3072 nt
    s_add_u32 s53, s52, 1
    s_lshl_b32 s53, s53, 12
    s_add_u32 s32, s18, s53
    s_addc_u32 s33, s19, 0
    s_and_b32 s33, s33, 0xffff
    s_mov_b32 s34, 4096
    s_mov_b32 s35, 0x20000
    buffer_load_dwordx4 v[48:51], v6, s[32:35], 0 offen offset:0 nt
    buffer_load_dwordx4 v[52:55], v6, s[32:35], 0 offen offset:1024 nt
    buffer_load_dwordx4 v[56:59], v6, s[32:35], 0 offen offset:2048 nt
    buffer_load_dwordx4 v[60:63], v6, s[32:35], 0 offen offset:3072 nt
    s_add_u32 s53, s29, 176
    s_add_u32 s40, s26, 0x500000
    s_addc_u32 s41, s27, 0
    s_and_b32 s41, s41, 0xffff
    s_mov_b32 s42, 0x8000
    s_mov_b32 s43, 0x20000
    s_barrier
    s_cmp_eq_u32 s28, 4
    s_cbranch_scc0 B_NF
    s_lshl_b32 s52, s53, 7
    s_mov_b64 exec, 1
    v_mov_b32 v1, s52
    v_mov_b32 v2, s62
    buffer_store_dword v2, v1, s[40:43], 0 offen sc1
    s_mov_b64 exec, -1
    s_branch B_NF2
B_NF:
    v_mov_b32 v1, 0x7ffffff0
    buffer_load_dword v0, v1, s[40:43], 0 offen
B_NF2:
    s_waitcnt vmcnt(5)
    s_sub_u32 s52, s28, 4
    s_lshl_b32 s52, s52, 1
    s_add_u32 s52, s52, 0
    s_mul_i32 s52, s52, 8384
    v_lshlrev_b32 v6, 4, v10
    v_add_u32 v6, s52, v6
    v_readfirstlane_b32 s53, v16
    v_mov_b32_dpp v80, v16 wave_shl:1 row_mask:0xf bank_mask:0xf bound_ctrl:0
    v_mov_b32_dpp v81, v20 wave_shl:1 row_mask:0xf bank_mask:0xf bound_ctrl:0
    v_mov_b32_dpp v82, v24 wave_shl:1 row_mask:0xf bank_mask:0xf bound_ctrl:0
    v_mov_b32_dpp v83, v28 wave_shl:1 row_mask:0xf bank_mask:0xf bound_ctrl:0
    v_readlane_b32 s72, v20, 0
    v_readlane_b32 s73, v24, 0
    v_readlane_b32 s74, v28, 0
    v_alignbit_b32 v32, v17, v16, 16
    v_alignbit_b32 v33, v18, v17, 16
    v_alignbit_b32 v34, v19, v18, 16
    v_alignbit_b32 v36, v21, v20, 16
    v_alignbit_b32 v37, v22, v21, 16
    v_alignbit_b32 v38, v23, v22, 16
    v_alignbit_b32 v40, v25, v24, 16
    v_alignbit_b32 v41, v26, v25, 16
    v_alignbit_b32 v42, v27, v26, 16
    v_alignbit_b32 v44, v29, v28, 16
    v_alignbit_b32 v45, v30, v29, 16
    v_alignbit_b32 v46, v31, v30, 16
    v_writelane_b32 v80, s72, 63
    v_writelane_b32 v81, s73, 63
    v_writelane_b32 v82, s74, 63
    v_alignbit_b32 v35, v80, v19, 16
    v_alignbit_b32 v39, v81, v23, 16
    v_alignbit_b32 v43, v82, v27, 16
    v_alignbit_b32 v47, v83, v31, 16
    ds_write_b128 v6, v[16:19] offset:32
    ds_write_b128 v6, v[32:35] offset:4192
    ds_write_b128 v6, v[20:23] offset:1056
    ds_write_b128 v6, v[36:39] offset:5216
    ds_write_b128 v6, v[24:27] offset:2080
    ds_write_b128 v6, v[40:43] offset:6240
    ds_write_b128 v6, v[28:31] offset:3104
    ds_write_b128 v6, v[44:47] offset:7264
    s_lshl_b32 s53, s53, 16
    v_lshlrev_b32 v7, 2, v10
    v_add_u32 v7, s52, v7
    v_mov_b32 v8, 0
    v_mov_b32 v9, s53
    v_cmp_eq_u32 vcc, 7, v10
    s_mov_b64 exec, 0xff
    s_nop 0
    v_cndmask_b32 v9, v8, v9, vcc
    ds_write_b32 v7, v8 offset:0
    ds_write_b32 v7, v9 offset:4160
    s_mov_b64 exec, -1
    s_waitcnt vmcnt(1)
    s_sub_u32 s52, s28, 4
    s_lshl_b32 s52, s52, 1
    s_add_u32 s52, s52, 1
    s_mul_i32 s52, s52, 8384
    v_lshlrev_b32 v6, 4, v10
    v_add_u32 v6, s52, v6
    v_readfirstlane_b32 s53, v48
    v_mov_b32_dpp v80, v48 wave_shl:1 row_mask:0xf bank_mask:0xf bound_ctrl:0
    v_mov_b32_dpp v81, v52 wave_shl:1 row_mask:0xf bank_mask:0xf bound_ctrl:0
    v_mov_b32_dpp v82, v56 wave_shl:1 row_mask:0xf bank_mask:0xf bound_ctrl:0
    v_mov_b32_dpp v83, v60 wave_shl:1 row_mask:0xf bank_mask:0xf bound_ctrl:0
    v_readlane_b32 s72, v52, 0
    v_readlane_b32 s73, v56, 0
    v_readlane_b32 s74, v60, 0
    v_alignbit_b32 v64, v49, v48, 16
    v_alignbit_b32 v65, v50, v49, 16
    v_alignbit_b32 v66, v51, v50, 16
    v_alignbit_b32 v68, v53, v52, 16
    v_alignbit_b32 v69, v54, v53, 16
    v_alignbit_b32 v70, v55, v54, 16
    v_alignbit_b32 v72, v57, v56, 16
    v_alignbit_b32 v73, v58, v57, 16
    v_alignbit_b32 v74, v59, v58, 16
    v_alignbit_b32 v76, v61, v60, 16
    v_alignbit_b32 v77, v62, v61, 16
    v_alignbit_b32 v78, v63, v62, 16
    v_writelane_b32 v80, s72, 63
    v_writelane_b32 v81, s73, 63
    v_writelane_b32 v82, s74, 63
    v_alignbit_b32 v67, v80, v51, 16
    v_alignbit_b32 v71, v81, v55, 16
    v_alignbit_b32 v75, v82, v59, 16
    v_alignbit_b32 v79, v83, v63, 16
    ds_write_b128 v6, v[48:51] offset:32
    ds_write_b128 v6, v[64:67] offset:4192
    ds_write_b128 v6, v[52:55] offset:1056
    ds_write_b128 v6, v[68:71] offset:5216
    ds_write_b128 v6, v[56:59] offset:2080
    ds_write_b128 v6, v[72:75] offset:6240
    ds_write_b128 v6, v[60:63] offset:3104
    ds_write_b128 v6, v[76:79] offset:7264
    s_lshl_b32 s53, s53, 16
    v_lshlrev_b32 v7, 2, v10
    v_add_u32 v7, s52, v7
    v_mov_b32 v8, 0
    v_mov_b32 v9, s53
    v_cmp_eq_u32 vcc, 7, v10
    s_mov_b64 exec, 0xff
    s_nop 0
    v_cndmask_b32 v9, v8, v9, vcc
    ds_write_b32 v7, v8 offset:0
    ds_write_b32 v7, v9 offset:4160
    s_mov_b64 exec, -1
    s_cmp_eq_u32 s28, 4
    s_cbranch_scc0 B_NP
    s_add_u32 s48, s26, 0x500000
    s_addc_u32 s49, s27, 0
    s_and_b32 s49, s49, 0xffff
    s_mov_b32 s50, 0x8000
    s_mov_b32 s51, 0x20000
    s_and_b32 s53, s29, 0xfffffff8
    s_add_u32 s53, s53, 176
    v_add_u32 v1, s53, v10
    v_lshlrev_b32 v1, 7, v1
    s_mov_b64 exec, 0xff
    s_mov_b32 s52, 0
    buffer_load_dword v2, v1, s[48:51], 0 offen sc1
    s_sleep 2
    buffer_load_dword v3, v1, s[48:51], 0 offen sc1
    s_sleep 2
POLL_B:
    buffer_load_dword v4, v1, s[48:51], 0 offen sc1
    s_waitcnt vmcnt(2)
    v_cmp_ne_u32 vcc, s62, v2
    s_add_u32 s52, s52, 1
    s_nop 0
    s_cmp_eq_u64 vcc, 0
    s_cbranch_scc1 POLLED_B
    s_sleep 2
    buffer_load_dword v2, v1, s[48:51], 0 offen sc1
    s_waitcnt vmcnt(2)
    v_cmp_ne_u32 vcc, s62, v3
    s_add_u32 s52, s52, 1
    s_nop 0
    s_cmp_eq_u64 vcc, 0
    s_cbranch_scc1 POLLED_B
    s_sleep 2
    buffer_load_dword v3, v1, s[48:51], 0 offen sc1
    s_waitcnt vmcnt(2)
    v_cmp_ne_u32 vcc, s62, v4
    s_add_u32 s52, s52, 1
    s_nop 0
    s_cmp_eq_u64 vcc, 0
    s_cbranch_scc1 POLLED_B
    s_sleep 2
    s_cmp_gt_u32 s52, 400000
    s_cbranch_scc0 POLL_B
POLLED_B:
    s_mov_b64 exec, -1
B_NP:
B_JOIN:
    s_barrier
    s_add_u32 s40, s26, 0x280000
    s_addc_u32 s41, s27, 0
    s_and_b32 s41, s41, 0xffff
    s_mov_b32 s42, 0x280000
    s_mov_b32 s43, 0x20000
    s_lshl_b32 s52, s29, 3
    s_add_u32 s52, s52, s28
    s_lshl_b32 s52, s52, 12
    v_lshlrev_b32 v8, 4, v10
    v_add_u32 v7, s52, v8
    buffer_load_dwordx4 v[128:131], v7, s[40:43], 0 offen offset:0 sc1
    buffer_load_dwordx4 v[132:135], v7, s[40:43], 0 offen offset:1024 sc1
    buffer_load_dwordx4 v[136:139], v7, s[40:43], 0 offen offset:2048 sc1
    buffer_load_dwordx4 v[140:143], v7, s[40:43], 0 offen offset:3072 sc1
    s_mov_b32 s36, s10
    s_mov_b32 s37, s11
    s_and_b32 s37, s37, 0xffff
    s_mov_b32 s38, 0x280000
    s_mov_b32 s39, 0x20000
    s_lshl_b32 s52, s28, 8
    v_add_u32 v7, s52, v10
    v_mul_u32_u24 v7, 1280, v7
    s_lshl_b32 s53, s29, 4
    v_add_u32 v7, s53, v7
    s_lshl_b32 s56, s28, 12
    s_add_u32 s56, s56, 103936
    s_mov_b32 s57, 0
    s_and_b32 s52, s29, 7
    s_lshl_b32 s52, s52, 8
    s_lshl_b32 s53, s28, 5
    s_add_u32 s52, s52, s53
    v_add_u32 v6, s52, v10
    v_mul_u32_u24 v6, 1280, v6
    s_lshl_b32 s52, s63, 7
    v_add_u32 v6, s52, v6
    v_cmp_gt_u32 vcc, 32, v10
    v_mov_b32 v8, 0x7ffffff0
    s_nop 0
    v_cndmask_b32 v6, v8, v6, vcc
    s_mul_i32 s52, s28, 4608
    s_add_u32 s52, s52, 67072
    v_lshlrev_b32 v8, 4, v10
    v_add_u32 v8, s52, v8
    v_mov_b32 v144, 0
    v_mov_b32 v145, 0
    v_mov_b32 v146, 0
    v_mov_b32 v147, 0
    s_mov_b32 exec_hi, 0
    ds_write_b128 v8, v[144:147] offset:4096
    s_mov_b64 exec, -1
    s_waitcnt vmcnt(3)
    ds_write_b128 v8, v[128:131] offset:0
    s_waitcnt vmcnt(2)
    ds_write_b128 v8, v[132:135] offset:1024
    s_waitcnt vmcnt(1)
    ds_write_b128 v8, v[136:139] offset:2048
    s_waitcnt vmcnt(0)
    ds_write_b128 v8, v[140:143] offset:3072
    s_waitcnt lgkmcnt(0)
    s_barrier
    v_and_b32 v11, 15, v10
    v_lshrrev_b32 v12, 4, v10
    v_and_b32 v13, 1, v11
    v_lshlrev_b32 v14, 1, v11
    v_cmp_eq_u32 vcc, 1, v13
    v_add_u32 v15, 2, v14
    v_add_u32 v14, 4160, v14
    v_cndmask_b32 v14, v14, v15, vcc
    v_lshl_add_u32 v14, v12, 4, v14
    s_mul_i32 s52, s28, 8384
    v_add_u32 v1, s52, v14
    v_add_u32 v2, 1024, v1
    v_add_u32 v3, 2048, v1
    v_add_u32 v4, 3072, v1
    s_mul_i32 s52, s28, 4608
    s_add_u32 s52, s52, 67552
    v_lshlrev_b32 v14, 5, v11
    v_lshlrev_b32 v15, 4, v12
    v_sub_u32 v14, v15, v14
    v_add_u32 v5, s52, v14
    ds_read_b128 v[48:51], v5 offset:3584
    ds_read2_b32 v[16:17], v1 offset0:0 offset1:1
    ds_read2_b32 v[18:19], v1 offset0:2 offset1:3
    ds_read_b128 v[52:55], v5 offset:3072
    ds_read2_b32 v[20:21], v1 offset0:128 offset1:129
    ds_read2_b32 v[22:23], v1 offset0:130 offset1:131
    ds_read_b128 v[56:59], v5 offset:2560
    ds_read2_b32 v[24:25], v2 offset0:0 offset1:1
    ds_read2_b32 v[26:27], v2 offset0:2 offset1:3
    ds_read_b128 v[60:63], v5 offset:2048
    ds_read2_b32 v[28:29], v2 offset0:128 offset1:129
    ds_read2_b32 v[30:31], v2 offset0:130 offset1:131
    ds_read_b128 v[64:67], v5 offset:1536
    ds_read2_b32 v[32:33], v3 offset0:0 offset1:1
    ds_read2_b32 v[34:35], v3 offset0:2 offset1:3
    ds_read_b128 v[68:71], v5 offset:1024
    ds_read2_b32 v[36:37], v3 offset0:128 offset1:129
    ds_read2_b32 v[38:39], v3 offset0:130 offset1:131
    ds_read_b128 v[72:75], v5 offset:512
    ds_read2_b32 v[40:41], v4 offset0:0 offset1:1
    ds_read2_b32 v[42:43], v4 offset0:2 offset1:3
    ds_read_b128 v[76:79], v5 offset:0
    ds_read2_b32 v[44:45], v4 offset0:128 offset1:129
    ds_read2_b32 v[46:47], v4 offset0:130 offset1:131
    s_waitcnt lgkmcnt(0)
    v_mfma_f32_16x16x32_bf16 v[144:147], v[16:19], v[48:51], 0
    ds_read_b128 v[112:115], v5 offset:3648
    v_mfma_f32_16x16x32_bf16 v[148:151], v[16:19], v[52:55], 0
    ds_read2_b32 v[80:81], v1 offset0:16 offset1:17
    v_mfma_f32_16x16x32_bf16 v[152:155], v[16:19], v[56:59], 0
    ds_read2_b32 v[82:83], v1 offset0:18 offset1:19
    v_mfma_f32_16x16x32_bf16 v[156:159], v[16:19], v[60:63], 0
    ds_read_b128 v[116:119], v5 offset:3136
    v_mfma_f32_16x16x32_bf16 v[160:163], v[16:19], v[64:67], 0
    ds_read2_b32 v[84:85], v1 offset0:144 offset1:145
    v_mfma_f32_16x16x32_bf16 v[164:167], v[16:19], v[68:71], 0
    ds_read2_b32 v[86:87], v1 offset0:146 offset1:147
    v_mfma_f32_16x16x32_bf16 v[168:171], v[16:19], v[72:75], 0
    ds_read_b128 v[120:123], v5 offset:2624
    v_mfma_f32_16x16x32_bf16 v[172:175], v[16:19], v[76:79], 0
    ds_read2_b32 v[88:89], v2 offset0:16 offset1:17
    v_mfma_f32_16x16x32_bf16 v[148:151], v[20:23], v[48:51], v[148:151]
    ds_read2_b32 v[90:91], v2 offset0:18 offset1:19
    v_mfma_f32_16x16x32_bf16 v[152:155], v[20:23], v[52:55], v[152:155]
    ds_read_b128 v[124:127], v5 offset:2112
    v_mfma_f32_16x16x32_bf16 v[156:159], v[20:23], v[56:59], v[156:159]
    ds_read2_b32 v[92:93], v2 offset0:144 offset1:145
    v_mfma_f32_16x16x32_bf16 v[160:163], v[20:23], v[60:63], v[160:163]
    ds_read2_b32 v[94:95], v2 offset0:146 offset1:147
    v_mfma_f32_16x16x32_bf16 v[164:167], v[20:23], v[64:67], v[164:167]
    ds_read_b128 v[128:131], v5 offset:1600
    v_mfma_f32_16x16x32_bf16 v[168:171], v[20:23], v[68:71], v[168:171]
    ds_read2_b32 v[96:97], v3 offset0:16 offset1:17
    v_mfma_f32_16x16x32_bf16 v[172:175], v[20:23], v[72:75], v[172:175]
    ds_read2_b32 v[98:99], v3 offset0:18 offset1:19
    v_mfma_f32_16x16x32_bf16 v[152:155], v[24:27], v[48:51], v[152:155]
    ds_read_b128 v[132:135], v5 offset:1088
    v_mfma_f32_16x16x32_bf16 v[156:159], v[24:27], v[52:55], v[156:159]
    ds_read2_b32 v[100:101], v3 offset0:144 offset1:145
    v_mfma_f32_16x16x32_bf16 v[160:163], v[24:27], v[56:59], v[160:163]
    ds_read2_b32 v[102:103], v3 offset0:146 offset1:147
    v_mfma_f32_16x16x32_bf16 v[164:167], v[24:27], v[60:63], v[164:167]
    ds_read_b128 v[136:139], v5 offset:576
    v_mfma_f32_16x16x32_bf16 v[168:171], v[24:27], v[64:67], v[168:171]
    ds_read2_b32 v[104:105], v4 offset0:16 offset1:17
    v_mfma_f32_16x16x32_bf16 v[172:175], v[24:27], v[68:71], v[172:175]
    ds_read2_b32 v[106:107], v4 offset0:18 offset1:19
    v_mfma_f32_16x16x32_bf16 v[156:159], v[28:31], v[48:51], v[156:159]
    ds_read_b128 v[140:143], v5 offset:64
    v_mfma_f32_16x16x32_bf16 v[160:163], v[28:31], v[52:55], v[160:163]
    ds_read2_b32 v[108:109], v4 offset0:144 offset1:145
    v_mfma_f32_16x16x32_bf16 v[164:167], v[28:31], v[56:59], v[164:167]
    ds_read2_b32 v[110:111], v4 offset0:146 offset1:147
    v_mfma_f32_16x16x32_bf16 v[168:171], v[28:31], v[60:63], v[168:171]
    v_mfma_f32_16x16x32_bf16 v[172:175], v[28:31], v[64:67], v[172:175]
    v_mfma_f32_16x16x32_bf16 v[160:163], v[32:35], v[48:51], v[160:163]
    v_mfma_f32_16x16x32_bf16 v[164:167], v[32:35], v[52:55], v[164:167]
    v_mfma_f32_16x16x32_bf16 v[168:171], v[32:35], v[56:59], v[168:171]
    v_mfma_f32_16x16x32_bf16 v[172:175], v[32:35], v[60:63], v[172:175]
    v_mfma_f32_16x16x32_bf16 v[164:167], v[36:39], v[48:51], v[164:167]
    v_mfma_f32_16x16x32_bf16 v[168:171], v[36:39], v[52:55], v[168:171]
    v_mfma_f32_16x16x32_bf16 v[172:175], v[36:39], v[56:59], v[172:175]
    v_mfma_f32_16x16x32_bf16 v[168:171], v[40:43], v[48:51], v[168:171]
    v_mfma_f32_16x16x32_bf16 v[172:175], v[40:43], v[52:55], v[172:175]
    v_mfma_f32_16x16x32_bf16 v[172:175], v[44:47], v[48:51], v[172:175]
    s_waitcnt lgkmcnt(0)
    v_mfma_f32_16x16x32_bf16 v[144:147], v[80:83], v[112:115], v[144:147]
    buffer_load_dword v0, v6, s[36:39], 0 offen
    v_mfma_f32_16x16x32_bf16 v[148:151], v[80:83], v[116:119], v[148:151]
    ds_read_b128 v[48:51], v5 offset:3712
    v_mfma_f32_16x16x32_bf16 v[152:155], v[80:83], v[120:123], v[152:155]
    ds_read2_b32 v[16:17], v1 offset0:32 offset1:33
    v_mfma_f32_16x16x32_bf16 v[156:159], v[80:83], v[124:127], v[156:159]
    ds_read2_b32 v[18:19], v1 offset0:34 offset1:35
    v_mfma_f32_16x16x32_bf16 v[160:163], v[80:83], v[128:131], v[160:163]
    ds_read_b128 v[52:55], v5 offset:3200
    v_mfma_f32_16x16x32_bf16 v[164:167], v[80:83], v[132:135], v[164:167]
    ds_read2_b32 v[20:21], v1 offset0:160 offset1:161
    v_mfma_f32_16x16x32_bf16 v[168:171], v[80:83], v[136:139], v[168:171]
    ds_read2_b32 v[22:23], v1 offset0:162 offset1:163
    v_mfma_f32_16x16x32_bf16 v[172:175], v[80:83], v[140:143], v[172:175]
    ds_read_b128 v[56:59], v5 offset:2688
    v_mfma_f32_16x16x32_bf16 v[148:151], v[84:87], v[112:115], v[148:151]
    ds_read2_b32 v[24:25], v2 offset0:32 offset1:33
    v_mfma_f32_16x16x32_bf16 v[152:155], v[84:87], v[116:119], v[152:155]
    ds_read2_b32 v[26:27], v2 offset0:34 offset1:35
    v_mfma_f32_16x16x32_bf16 v[156:159], v[84:87], v[120:123], v[156:159]
    ds_read_b128 v[60:63], v5 offset:2176
    v_mfma_f32_16x16x32_bf16 v[160:163], v[84:87], v[124:127], v[160:163]
    ds_read2_b32 v[28:29], v2 offset0:160 offset1:161
    v_mfma_f32_16x16x32_bf16 v[164:167], v[84:87], v[128:131], v[164:167]
    ds_read2_b32 v[30:31], v2 offset0:162 offset1:163
    v_mfma_f32_16x16x32_bf16 v[168:171], v[84:87], v[132:135], v[168:171]
    ds_read_b128 v[64:67], v5 offset:1664
    v_mfma_f32_16x16x32_bf16 v[172:175], v[84:87], v[136:139], v[172:175]
    ds_read2_b32 v[32:33], v3 offset0:32 offset1:33
    v_mfma_f32_16x16x32_bf16 v[152:155], v[88:91], v[112:115], v[152:155]
    ds_read2_b32 v[34:35], v3 offset0:34 offset1:35
    v_mfma_f32_16x16x32_bf16 v[156:159], v[88:91], v[116:119], v[156:159]
    ds_read_b128 v[68:71], v5 offset:1152
    v_mfma_f32_16x16x32_bf16 v[160:163], v[88:91], v[120:123], v[160:163]
    ds_read2_b32 v[36:37], v3 offset0:160 offset1:161
    v_mfma_f32_16x16x32_bf16 v[164:167], v[88:91], v[124:127], v[164:167]
    ds_read2_b32 v[38:39], v3 offset0:162 offset1:163
    v_mfma_f32_16x16x32_bf16 v[168:171], v[88:91], v[128:131], v[168:171]
    ds_read_b128 v[72:75], v5 offset:640
    v_mfma_f32_16x16x32_bf16 v[172:175], v[88:91], v[132:135], v[172:175]
    ds_read2_b32 v[40:41], v4 offset0:32 offset1:33
    v_mfma_f32_16x16x32_bf16 v[156:159], v[92:95], v[112:115], v[156:159]
    ds_read2_b32 v[42:43], v4 offset0:34 offset1:35
    v_mfma_f32_16x16x32_bf16 v[160:163], v[92:95], v[116:119], v[160:163]
    ds_read_b128 v[76:79], v5 offset:128
    v_mfma_f32_16x16x32_bf16 v[164:167], v[92:95], v[120:123], v[164:167]
    ds_read2_b32 v[44:45], v4 offset0:160 offset1:161
    v_mfma_f32_16x16x32_bf16 v[168:171], v[92:95], v[124:127], v[168:171]
    ds_read2_b32 v[46:47], v4 offset0:162 offset1:163
    v_mfma_f32_16x16x32_bf16 v[172:175], v[92:95], v[128:131], v[172:175]
    v_mfma_f32_16x16x32_bf16 v[160:163], v[96:99], v[112:115], v[160:163]
    v_mfma_f32_16x16x32_bf16 v[164:167], v[96:99], v[116:119], v[164:167]
    v_mfma_f32_16x16x32_bf16 v[168:171], v[96:99], v[120:123], v[168:171]
    v_mfma_f32_16x16x32_bf16 v[172:175], v[96:99], v[124:127], v[172:175]
    v_mfma_f32_16x16x32_bf16 v[164:167], v[100:103], v[112:115], v[164:167]
    v_mfma_f32_16x16x32_bf16 v[168:171], v[100:103], v[116:119], v[168:171]
    v_mfma_f32_16x16x32_bf16 v[172:175], v[100:103], v[120:123], v[172:175]
    v_mfma_f32_16x16x32_bf16 v[168:171], v[104:107], v[112:115], v[168:171]
    v_mfma_f32_16x16x32_bf16 v[172:175], v[104:107], v[116:119], v[172:175]
    v_mfma_f32_16x16x32_bf16 v[172:175], v[108:111], v[112:115], v[172:175]
    s_waitcnt lgkmcnt(0)
    v_mfma_f32_16x16x32_bf16 v[144:147], v[16:19], v[48:51], v[144:147]
    ds_read_b128 v[112:115], v5 offset:3776
    v_mfma_f32_16x16x32_bf16 v[148:151], v[16:19], v[52:55], v[148:151]
    ds_read2_b32 v[80:81], v1 offset0:48 offset1:49
    v_mfma_f32_16x16x32_bf16 v[152:155], v[16:19], v[56:59], v[152:155]
    ds_read2_b32 v[82:83], v1 offset0:50 offset1:51
    v_mfma_f32_16x16x32_bf16 v[156:159], v[16:19], v[60:63], v[156:159]
    ds_read_b128 v[116:119], v5 offset:3264
    v_mfma_f32_16x16x32_bf16 v[160:163], v[16:19], v[64:67], v[160:163]
    ds_read2_b32 v[84:85], v1 offset0:176 offset1:177
    v_mfma_f32_16x16x32_bf16 v[164:167], v[16:19], v[68:71], v[164:167]
    ds_read2_b32 v[86:87], v1 offset0:178 offset1:179
    v_mfma_f32_16x16x32_bf16 v[168:171], v[16:19], v[72:75], v[168:171]
    ds_read_b128 v[120:123], v5 offset:2752
    v_mfma_f32_16x16x32_bf16 v[172:175], v[16:19], v[76:79], v[172:175]
    ds_read2_b32 v[88:89], v2 offset0:48 offset1:49
    v_mfma_f32_16x16x32_bf16 v[148:151], v[20:23], v[48:51], v[148:151]
    ds_read2_b32 v[90:91], v2 offset0:50 offset1:51
    v_mfma_f32_16x16x32_bf16 v[152:155], v[20:23], v[52:55], v[152:155]
    ds_read_b128 v[124:127], v5 offset:2240
    v_mfma_f32_16x16x32_bf16 v[156:159], v[20:23], v[56:59], v[156:159]
    ds_read2_b32 v[92:93], v2 offset0:176 offset1:177
    v_mfma_f32_16x16x32_bf16 v[160:163], v[20:23], v[60:63], v[160:163]
    ds_read2_b32 v[94:95], v2 offset0:178 offset1:179
    v_mfma_f32_16x16x32_bf16 v[164:167], v[20:23], v[64:67], v[164:167]
    ds_read_b128 v[128:131], v5 offset:1728
    v_mfma_f32_16x16x32_bf16 v[168:171], v[20:23], v[68:71], v[168:171]
    ds_read2_b32 v[96:97], v3 offset0:48 offset1:49
    v_mfma_f32_16x16x32_bf16 v[172:175], v[20:23], v[72:75], v[172:175]
    ds_read2_b32 v[98:99], v3 offset0:50 offset1:51
    v_mfma_f32_16x16x32_bf16 v[152:155], v[24:27], v[48:51], v[152:155]
    ds_read_b128 v[132:135], v5 offset:1216
    v_mfma_f32_16x16x32_bf16 v[156:159], v[24:27], v[52:55], v[156:159]
    ds_read2_b32 v[100:101], v3 offset0:176 offset1:177
    v_mfma_f32_16x16x32_bf16 v[160:163], v[24:27], v[56:59], v[160:163]
    ds_read2_b32 v[102:103], v3 offset0:178 offset1:179
    v_mfma_f32_16x16x32_bf16 v[164:167], v[24:27], v[60:63], v[164:167]
    ds_read_b128 v[136:139], v5 offset:704
    v_mfma_f32_16x16x32_bf16 v[168:171], v[24:27], v[64:67], v[168:171]
    ds_read2_b32 v[104:105], v4 offset0:48 offset1:49
    v_mfma_f32_16x16x32_bf16 v[172:175], v[24:27], v[68:71], v[172:175]
    ds_read2_b32 v[106:107], v4 offset0:50 offset1:51
    v_mfma_f32_16x16x32_bf16 v[156:159], v[28:31], v[48:51], v[156:159]
    ds_read_b128 v[140:143], v5 offset:192
    v_mfma_f32_16x16x32_bf16 v[160:163], v[28:31], v[52:55], v[160:163]
    ds_read2_b32 v[108:109], v4 offset0:176 offset1:177
    v_mfma_f32_16x16x32_bf16 v[164:167], v[28:31], v[56:59], v[164:167]
    ds_read2_b32 v[110:111], v4 offset0:178 offset1:179
    v_mfma_f32_16x16x32_bf16 v[168:171], v[28:31], v[60:63], v[168:171]
    v_mfma_f32_16x16x32_bf16 v[172:175], v[28:31], v[64:67], v[172:175]
    v_mfma_f32_16x16x32_bf16 v[160:163], v[32:35], v[48:51], v[160:163]
    v_mfma_f32_16x16x32_bf16 v[164:167], v[32:35], v[52:55], v[164:167]
    v_mfma_f32_16x16x32_bf16 v[168:171], v[32:35], v[56:59], v[168:171]
    v_mfma_f32_16x16x32_bf16 v[172:175], v[32:35], v[60:63], v[172:175]
    v_mfma_f32_16x16x32_bf16 v[164:167], v[36:39], v[48:51], v[164:167]
    v_mfma_f32_16x16x32_bf16 v[168:171], v[36:39], v[52:55], v[168:171]
    v_mfma_f32_16x16x32_bf16 v[172:175], v[36:39], v[56:59], v[172:175]
    v_mfma_f32_16x16x32_bf16 v[168:171], v[40:43], v[48:51], v[168:171]
    v_mfma_f32_16x16x32_bf16 v[172:175], v[40:43], v[52:55], v[172:175]
    v_mfma_f32_16x16x32_bf16 v[172:175], v[44:47], v[48:51], v[172:175]
    s_waitcnt lgkmcnt(0)
    v_mfma_f32_16x16x32_bf16 v[144:147], v[80:83], v[112:115], v[144:147]
    ds_read_b128 v[48:51], v5 offset:3840
    v_mfma_f32_16x16x32_bf16 v[148:151], v[80:83], v[116:119], v[148:151]
    ds_read2_b32 v[16:17], v1 offset0:64 offset1:65
    v_mfma_f32_16x16x32_bf16 v[152:155], v[80:83], v[120:123], v[152:155]
    ds_read2_b32 v[18:19], v1 offset0:66 offset1:67
    v_mfma_f32_16x16x32_bf16 v[156:159], v[80:83], v[124:127], v[156:159]
    ds_read_b128 v[52:55], v5 offset:3328
    v_mfma_f32_16x16x32_bf16 v[160:163], v[80:83], v[128:131], v[160:163]
    s_add_u32 m0, s56, 0
    v_mfma_f32_16x16x32_bf16 v[164:167], v[80:83], v[132:135], v[164:167]
    s_mov_b32 s57, 0
    v_mfma_f32_16x16x32_bf16 v[168:171], v[80:83], v[136:139], v[168:171]
    buffer_load_dwordx4 v7, s[36:39], s57 offen lds
    v_mfma_f32_16x16x32_bf16 v[172:175], v[80:83], v[140:143], v[172:175]
    ds_read2_b32 v[20:21], v1 offset0:192 offset1:193
    v_mfma_f32_16x16x32_bf16 v[148:151], v[84:87], v[112:115], v[148:151]
    ds_read2_b32 v[22:23], v1 offset0:194 offset1:195
    v_mfma_f32_16x16x32_bf16 v[152:155], v[84:87], v[116:119], v[152:155]
    ds_read_b128 v[56:59], v5 offset:2816
    v_mfma_f32_16x16x32_bf16 v[156:159], v[84:87], v[120:123], v[156:159]
    ds_read2_b32 v[24:25], v2 offset0:64 offset1:65
    v_mfma_f32_16x16x32_bf16 v[160:163], v[84:87], v[124:127], v[160:163]
    ds_read2_b32 v[26:27], v2 offset0:66 offset1:67
    v_mfma_f32_16x16x32_bf16 v[164:167], v[84:87], v[128:131], v[164:167]
    ds_read_b128 v[60:63], v5 offset:2304
    v_mfma_f32_16x16x32_bf16 v[168:171], v[84:87], v[132:135], v[168:171]
    ds_read2_b32 v[28:29], v2 offset0:192 offset1:193
    v_mfma_f32_16x16x32_bf16 v[172:175], v[84:87], v[136:139], v[172:175]
    ds_read2_b32 v[30:31], v2 offset0:194 offset1:195
    v_mfma_f32_16x16x32_bf16 v[152:155], v[88:91], v[112:115], v[152:155]
    ds_read_b128 v[64:67], v5 offset:1792
    v_mfma_f32_16x16x32_bf16 v[156:159], v[88:91], v[116:119], v[156:159]
    ds_read2_b32 v[32:33], v3 offset0:64 offset1:65
    v_mfma_f32_16x16x32_bf16 v[160:163], v[88:91], v[120:123], v[160:163]
    ds_read2_b32 v[34:35], v3 offset0:66 offset1:67
    v_mfma_f32_16x16x32_bf16 v[164:167], v[88:91], v[124:127], v[164:167]
    ds_read_b128 v[68:71], v5 offset:1280
    v_mfma_f32_16x16x32_bf16 v[168:171], v[88:91], v[128:131], v[168:171]
    ds_read2_b32 v[36:37], v3 offset0:192 offset1:193
    v_mfma_f32_16x16x32_bf16 v[172:175], v[88:91], v[132:135], v[172:175]
    ds_read2_b32 v[38:39], v3 offset0:194 offset1:195
    v_mfma_f32_16x16x32_bf16 v[156:159], v[92:95], v[112:115], v[156:159]
    ds_read_b128 v[72:75], v5 offset:768
    v_mfma_f32_16x16x32_bf16 v[160:163], v[92:95], v[116:119], v[160:163]
    ds_read2_b32 v[40:41], v4 offset0:64 offset1:65
    v_mfma_f32_16x16x32_bf16 v[164:167], v[92:95], v[120:123], v[164:167]
    ds_read2_b32 v[42:43], v4 offset0:66 offset1:67
    v_mfma_f32_16x16x32_bf16 v[168:171], v[92:95], v[124:127], v[168:171]
    ds_read_b128 v[76:79], v5 offset:256
    v_mfma_f32_16x16x32_bf16 v[172:175], v[92:95], v[128:131], v[172:175]
    ds_read2_b32 v[44:45], v4 offset0:192 offset1:193
    v_mfma_f32_16x16x32_bf16 v[160:163], v[96:99], v[112:115], v[160:163]
    ds_read2_b32 v[46:47], v4 offset0:194 offset1:195
    v_mfma_f32_16x16x32_bf16 v[164:167], v[96:99], v[116:119], v[164:167]
    v_mfma_f32_16x16x32_bf16 v[168:171], v[96:99], v[120:123], v[168:171]
    v_mfma_f32_16x16x32_bf16 v[172:175], v[96:99], v[124:127], v[172:175]
    v_mfma_f32_16x16x32_bf16 v[164:167], v[100:103], v[112:115], v[164:167]
    v_mfma_f32_16x16x32_bf16 v[168:171], v[100:103], v[116:119], v[168:171]
    v_mfma_f32_16x16x32_bf16 v[172:175], v[100:103], v[120:123], v[172:175]
    v_mfma_f32_16x16x32_bf16 v[168:171], v[104:107], v[112:115], v[168:171]
    v_mfma_f32_16x16x32_bf16 v[172:175], v[104:107], v[116:119], v[172:175]
    v_mfma_f32_16x16x32_bf16 v[172:175], v[108:111], v[112:115], v[172:175]
    s_waitcnt lgkmcnt(0)
    v_mfma_f32_16x16x32_bf16 v[144:147], v[16:19], v[48:51], v[144:147]
    ds_read_b128 v[112:115], v5 offset:3904
    v_mfma_f32_16x16x32_bf16 v[148:151], v[16:19], v[52:55], v[148:151]
    ds_read2_b32 v[80:81], v1 offset0:80 offset1:81
    v_mfma_f32_16x16x32_bf16 v[152:155], v[16:19], v[56:59], v[152:155]
    ds_read2_b32 v[82:83], v1 offset0:82 offset1:83
    v_mfma_f32_16x16x32_bf16 v[156:159], v[16:19], v[60:63], v[156:159]
    ds_read_b128 v[116:119], v5 offset:3392
    v_mfma_f32_16x16x32_bf16 v[160:163], v[16:19], v[64:67], v[160:163]
    s_add_u32 m0, s56, 1024
    v_mfma_f32_16x16x32_bf16 v[164:167], v[16:19], v[68:71], v[164:167]
    s_mov_b32 s57, 81920
    v_mfma_f32_16x16x32_bf16 v[168:171], v[16:19], v[72:75], v[168:171]
    buffer_load_dwordx4 v7, s[36:39], s57 offen lds
    v_mfma_f32_16x16x32_bf16 v[172:175], v[16:19], v[76:79], v[172:175]
    ds_read2_b32 v[84:85], v1 offset0:208 offset1:209
    v_mfma_f32_16x16x32_bf16 v[148:151], v[20:23], v[48:51], v[148:151]
    ds_read2_b32 v[86:87], v1 offset0:210 offset1:211
    v_mfma_f32_16x16x32_bf16 v[152:155], v[20:23], v[52:55], v[152:155]
    ds_read_b128 v[120:123], v5 offset:2880
    v_mfma_f32_16x16x32_bf16 v[156:159], v[20:23], v[56:59], v[156:159]
    ds_read2_b32 v[88:89], v2 offset0:80 offset1:81
    v_mfma_f32_16x16x32_bf16 v[160:163], v[20:23], v[60:63], v[160:163]
    ds_read2_b32 v[90:91], v2 offset0:82 offset1:83
    v_mfma_f32_16x16x32_bf16 v[164:167], v[20:23], v[64:67], v[164:167]
    ds_read_b128 v[124:127], v5 offset:2368
    v_mfma_f32_16x16x32_bf16 v[168:171], v[20:23], v[68:71], v[168:171]
    ds_read2_b32 v[92:93], v2 offset0:208 offset1:209
    v_mfma_f32_16x16x32_bf16 v[172:175], v[20:23], v[72:75], v[172:175]
    ds_read2_b32 v[94:95], v2 offset0:210 offset1:211
    v_mfma_f32_16x16x32_bf16 v[152:155], v[24:27], v[48:51], v[152:155]
    ds_read_b128 v[128:131], v5 offset:1856
    v_mfma_f32_16x16x32_bf16 v[156:159], v[24:27], v[52:55], v[156:159]
    ds_read2_b32 v[96:97], v3 offset0:80 offset1:81
    v_mfma_f32_16x16x32_bf16 v[160:163], v[24:27], v[56:59], v[160:163]
    ds_read2_b32 v[98:99], v3 offset0:82 offset1:83
    v_mfma_f32_16x16x32_bf16 v[164:167], v[24:27], v[60:63], v[164:167]
    ds_read_b128 v[132:135], v5 offset:1344
    v_mfma_f32_16x16x32_bf16 v[168:171], v[24:27], v[64:67], v[168:171]
    ds_read2_b32 v[100:101], v3 offset0:208 offset1:209
    v_mfma_f32_16x16x32_bf16 v[172:175], v[24:27], v[68:71], v[172:175]
    ds_read2_b32 v[102:103], v3 offset0:210 offset1:211
    v_mfma_f32_16x16x32_bf16 v[156:159], v[28:31], v[48:51], v[156:159]
    ds_read_b128 v[136:139], v5 offset:832
    v_mfma_f32_16x16x32_bf16 v[160:163], v[28:31], v[52:55], v[160:163]
    ds_read2_b32 v[104:105], v4 offset0:80 offset1:81
    v_mfma_f32_16x16x32_bf16 v[164:167], v[28:31], v[56:59], v[164:167]
    ds_read2_b32 v[106:107], v4 offset0:82 offset1:83
    v_mfma_f32_16x16x32_bf16 v[168:171], v[28:31], v[60:63], v[168:171]
    ds_read_b128 v[140:143], v5 offset:320
    v_mfma_f32_16x16x32_bf16 v[172:175], v[28:31], v[64:67], v[172:175]
    ds_read2_b32 v[108:109], v4 offset0:208 offset1:209
    v_mfma_f32_16x16x32_bf16 v[160:163], v[32:35], v[48:51], v[160:163]
    ds_read2_b32 v[110:111], v4 offset0:210 offset1:211
    v_mfma_f32_16x16x32_bf16 v[164:167], v[32:35], v[52:55], v[164:167]
    v_mfma_f32_16x16x32_bf16 v[168:171], v[32:35], v[56:59], v[168:171]
    v_mfma_f32_16x16x32_bf16 v[172:175], v[32:35], v[60:63], v[172:175]
    v_mfma_f32_16x16x32_bf16 v[164:167], v[36:39], v[48:51], v[164:167]
    v_mfma_f32_16x16x32_bf16 v[168:171], v[36:39], v[52:55], v[168:171]
    v_mfma_f32_16x16x32_bf16 v[172:175], v[36:39], v[56:59], v[172:175]
    v_mfma_f32_16x16x32_bf16 v[168:171], v[40:43], v[48:51], v[168:171]
    v_mfma_f32_16x16x32_bf16 v[172:175], v[40:43], v[52:55], v[172:175]
    v_mfma_f32_16x16x32_bf16 v[172:175], v[44:47], v[48:51], v[172:175]
    s_waitcnt lgkmcnt(0)
    v_mfma_f32_16x16x32_bf16 v[144:147], v[80:83], v[112:115], v[144:147]
    ds_read_b128 v[48:51], v5 offset:3968
    v_mfma_f32_16x16x32_bf16 v[148:151], v[80:83], v[116:119], v[148:151]
    ds_read2_b32 v[16:17], v1 offset0:96 offset1:97
    v_mfma_f32_16x16x32_bf16 v[152:155], v[80:83], v[120:123], v[152:155]
    ds_read2_b32 v[18:19], v1 offset0:98 offset1:99
    v_mfma_f32_16x16x32_bf16 v[156:159], v[80:83], v[124:127], v[156:159]
    ds_read_b128 v[52:55], v5 offset:3456
    v_mfma_f32_16x16x32_bf16 v[160:163], v[80:83], v[128:131], v[160:163]
    s_add_u32 m0, s56, 2048
    v_mfma_f32_16x16x32_bf16 v[164:167], v[80:83], v[132:135], v[164:167]
    s_mov_b32 s57, 163840
    v_mfma_f32_16x16x32_bf16 v[168:171], v[80:83], v[136:139], v[168:171]
    buffer_load_dwordx4 v7, s[36:39], s57 offen lds
    v_mfma_f32_16x16x32_bf16 v[172:175], v[80:83], v[140:143], v[172:175]
    ds_read2_b32 v[20:21], v1 offset0:224 offset1:225
    v_mfma_f32_16x16x32_bf16 v[148:151], v[84:87], v[112:115], v[148:151]
    ds_read2_b32 v[22:23], v1 offset0:226 offset1:227
    v_mfma_f32_16x16x32_bf16 v[152:155], v[84:87], v[116:119], v[152:155]
    ds_read_b128 v[56:59], v5 offset:2944
    v_mfma_f32_16x16x32_bf16 v[156:159], v[84:87], v[120:123], v[156:159]
    ds_read2_b32 v[24:25], v2 offset0:96 offset1:97
    v_mfma_f32_16x16x32_bf16 v[160:163], v[84:87], v[124:127], v[160:163]
    ds_read2_b32 v[26:27], v2 offset0:98 offset1:99
    v_mfma_f32_16x16x32_bf16 v[164:167], v[84:87], v[128:131], v[164:167]
    ds_read_b128 v[60:63], v5 offset:2432
    v_mfma_f32_16x16x32_bf16 v[168:171], v[84:87], v[132:135], v[168:171]
    ds_read2_b32 v[28:29], v2 offset0:224 offset1:225
    v_mfma_f32_16x16x32_bf16 v[172:175], v[84:87], v[136:139], v[172:175]
    ds_read2_b32 v[30:31], v2 offset0:226 offset1:227
    v_mfma_f32_16x16x32_bf16 v[152:155], v[88:91], v[112:115], v[152:155]
    ds_read_b128 v[64:67], v5 offset:1920
    v_mfma_f32_16x16x32_bf16 v[156:159], v[88:91], v[116:119], v[156:159]
    ds_read2_b32 v[32:33], v3 offset0:96 offset1:97
    v_mfma_f32_16x16x32_bf16 v[160:163], v[88:91], v[120:123], v[160:163]
    ds_read2_b32 v[34:35], v3 offset0:98 offset1:99
    v_mfma_f32_16x16x32_bf16 v[164:167], v[88:91], v[124:127], v[164:167]
    ds_read_b128 v[68:71], v5 offset:1408
    v_mfma_f32_16x16x32_bf16 v[168:171], v[88:91], v[128:131], v[168:171]
    ds_read2_b32 v[36:37], v3 offset0:224 offset1:225
    v_mfma_f32_16x16x32_bf16 v[172:175], v[88:91], v[132:135], v[172:175]
    ds_read2_b32 v[38:39], v3 offset0:226 offset1:227
    v_mfma_f32_16x16x32_bf16 v[156:159], v[92:95], v[112:115], v[156:159]
    ds_read_b128 v[72:75], v5 offset:896
    v_mfma_f32_16x16x32_bf16 v[160:163], v[92:95], v[116:119], v[160:163]
    ds_read2_b32 v[40:41], v4 offset0:96 offset1:97
    v_mfma_f32_16x16x32_bf16 v[164:167], v[92:95], v[120:123], v[164:167]
    ds_read2_b32 v[42:43], v4 offset0:98 offset1:99
    v_mfma_f32_16x16x32_bf16 v[168:171], v[92:95], v[124:127], v[168:171]
    ds_read_b128 v[76:79], v5 offset:384
    v_mfma_f32_16x16x32_bf16 v[172:175], v[92:95], v[128:131], v[172:175]
    ds_read2_b32 v[44:45], v4 offset0:224 offset1:225
    v_mfma_f32_16x16x32_bf16 v[160:163], v[96:99], v[112:115], v[160:163]
    ds_read2_b32 v[46:47], v4 offset0:226 offset1:227
    v_mfma_f32_16x16x32_bf16 v[164:167], v[96:99], v[116:119], v[164:167]
    v_mfma_f32_16x16x32_bf16 v[168:171], v[96:99], v[120:123], v[168:171]
    v_mfma_f32_16x16x32_bf16 v[172:175], v[96:99], v[124:127], v[172:175]
    v_mfma_f32_16x16x32_bf16 v[164:167], v[100:103], v[112:115], v[164:167]
    v_mfma_f32_16x16x32_bf16 v[168:171], v[100:103], v[116:119], v[168:171]
    v_mfma_f32_16x16x32_bf16 v[172:175], v[100:103], v[120:123], v[172:175]
    v_mfma_f32_16x16x32_bf16 v[168:171], v[104:107], v[112:115], v[168:171]
    v_mfma_f32_16x16x32_bf16 v[172:175], v[104:107], v[116:119], v[172:175]
    v_mfma_f32_16x16x32_bf16 v[172:175], v[108:111], v[112:115], v[172:175]
    s_waitcnt lgkmcnt(0)
    v_mfma_f32_16x16x32_bf16 v[144:147], v[16:19], v[48:51], v[144:147]
    ds_read_b128 v[112:115], v5 offset:4032
    v_mfma_f32_16x16x32_bf16 v[148:151], v[16:19], v[52:55], v[148:151]
    ds_read2_b32 v[80:81], v1 offset0:112 offset1:113
    v_mfma_f32_16x16x32_bf16 v[152:155], v[16:19], v[56:59], v[152:155]
    ds_read2_b32 v[82:83], v1 offset0:114 offset1:115
    v_mfma_f32_16x16x32_bf16 v[156:159], v[16:19], v[60:63], v[156:159]
    ds_read_b128 v[116:119], v5 offset:3520
    v_mfma_f32_16x16x32_bf16 v[160:163], v[16:19], v[64:67], v[160:163]
    s_add_u32 m0, s56, 3072
    v_mfma_f32_16x16x32_bf16 v[164:167], v[16:19], v[68:71], v[164:167]
    s_mov_b32 s57, 245760
    v_mfma_f32_16x16x32_bf16 v[168:171], v[16:19], v[72:75], v[168:171]
    buffer_load_dwordx4 v7, s[36:39], s57 offen lds
    v_mfma_f32_16x16x32_bf16 v[172:175], v[16:19], v[76:79], v[172:175]
    ds_read2_b32 v[84:85], v1 offset0:240 offset1:241
    v_mfma_f32_16x16x32_bf16 v[148:151], v[20:23], v[48:51], v[148:151]
    ds_read2_b32 v[86:87], v1 offset0:242 offset1:243
    v_mfma_f32_16x16x32_bf16 v[152:155], v[20:23], v[52:55], v[152:155]
    ds_read_b128 v[120:123], v5 offset:3008
    v_mfma_f32_16x16x32_bf16 v[156:159], v[20:23], v[56:59], v[156:159]
    ds_read2_b32 v[88:89], v2 offset0:112 offset1:113
    v_mfma_f32_16x16x32_bf16 v[160:163], v[20:23], v[60:63], v[160:163]
    ds_read2_b32 v[90:91], v2 offset0:114 offset1:115
    v_mfma_f32_16x16x32_bf16 v[164:167], v[20:23], v[64:67], v[164:167]
    ds_read_b128 v[124:127], v5 offset:2496
    v_mfma_f32_16x16x32_bf16 v[168:171], v[20:23], v[68:71], v[168:171]
    ds_read2_b32 v[92:93], v2 offset0:240 offset1:241
    v_mfma_f32_16x16x32_bf16 v[172:175], v[20:23], v[72:75], v[172:175]
    ds_read2_b32 v[94:95], v2 offset0:242 offset1:243
    v_mfma_f32_16x16x32_bf16 v[152:155], v[24:27], v[48:51], v[152:155]
    ds_read_b128 v[128:131], v5 offset:1984
    v_mfma_f32_16x16x32_bf16 v[156:159], v[24:27], v[52:55], v[156:159]
    ds_read2_b32 v[96:97], v3 offset0:112 offset1:113
    v_mfma_f32_16x16x32_bf16 v[160:163], v[24:27], v[56:59], v[160:163]
    ds_read2_b32 v[98:99], v3 offset0:114 offset1:115
    v_mfma_f32_16x16x32_bf16 v[164:167], v[24:27], v[60:63], v[164:167]
    ds_read_b128 v[132:135], v5 offset:1472
    v_mfma_f32_16x16x32_bf16 v[168:171], v[24:27], v[64:67], v[168:171]
    ds_read2_b32 v[100:101], v3 offset0:240 offset1:241
    v_mfma_f32_16x16x32_bf16 v[172:175], v[24:27], v[68:71], v[172:175]
    ds_read2_b32 v[102:103], v3 offset0:242 offset1:243
    v_mfma_f32_16x16x32_bf16 v[156:159], v[28:31], v[48:51], v[156:159]
    ds_read_b128 v[136:139], v5 offset:960
    v_mfma_f32_16x16x32_bf16 v[160:163], v[28:31], v[52:55], v[160:163]
    ds_read2_b32 v[104:105], v4 offset0:112 offset1:113
    v_mfma_f32_16x16x32_bf16 v[164:167], v[28:31], v[56:59], v[164:167]
    ds_read2_b32 v[106:107], v4 offset0:114 offset1:115
    v_mfma_f32_16x16x32_bf16 v[168:171], v[28:31], v[60:63], v[168:171]
    ds_read_b128 v[140:143], v5 offset:448
    v_mfma_f32_16x16x32_bf16 v[172:175], v[28:31], v[64:67], v[172:175]
    ds_read2_b32 v[108:109], v4 offset0:240 offset1:241
    v_mfma_f32_16x16x32_bf16 v[160:163], v[32:35], v[48:51], v[160:163]
    ds_read2_b32 v[110:111], v4 offset0:242 offset1:243
    v_mfma_f32_16x16x32_bf16 v[164:167], v[32:35], v[52:55], v[164:167]
    v_mfma_f32_16x16x32_bf16 v[168:171], v[32:35], v[56:59], v[168:171]
    v_mfma_f32_16x16x32_bf16 v[172:175], v[32:35], v[60:63], v[172:175]
    v_mfma_f32_16x16x32_bf16 v[164:167], v[36:39], v[48:51], v[164:167]
    v_mfma_f32_16x16x32_bf16 v[168:171], v[36:39], v[52:55], v[168:171]
    v_mfma_f32_16x16x32_bf16 v[172:175], v[36:39], v[56:59], v[172:175]
    v_mfma_f32_16x16x32_bf16 v[168:171], v[40:43], v[48:51], v[168:171]
    v_mfma_f32_16x16x32_bf16 v[172:175], v[40:43], v[52:55], v[172:175]
    v_mfma_f32_16x16x32_bf16 v[172:175], v[44:47], v[48:51], v[172:175]
    s_waitcnt lgkmcnt(0)
    v_mfma_f32_16x16x32_bf16 v[144:147], v[80:83], v[112:115], v[144:147]
    v_mfma_f32_16x16x32_bf16 v[148:151], v[80:83], v[116:119], v[148:151]
    v_mfma_f32_16x16x32_bf16 v[152:155], v[80:83], v[120:123], v[152:155]
    v_mfma_f32_16x16x32_bf16 v[156:159], v[80:83], v[124:127], v[156:159]
    v_mfma_f32_16x16x32_bf16 v[160:163], v[80:83], v[128:131], v[160:163]
    v_mfma_f32_16x16x32_bf16 v[164:167], v[80:83], v[132:135], v[164:167]
    v_mfma_f32_16x16x32_bf16 v[168:171], v[80:83], v[136:139], v[168:171]
    v_mfma_f32_16x16x32_bf16 v[172:175], v[80:83], v[140:143], v[172:175]
    v_mfma_f32_16x16x32_bf16 v[148:151], v[84:87], v[112:115], v[148:151]
    v_mfma_f32_16x16x32_bf16 v[152:155], v[84:87], v[116:119], v[152:155]
    v_mfma_f32_16x16x32_bf16 v[156:159], v[84:87], v[120:123], v[156:159]
    v_mfma_f32_16x16x32_bf16 v[160:163], v[84:87], v[124:127], v[160:163]
    v_mfma_f32_16x16x32_bf16 v[164:167], v[84:87], v[128:131], v[164:167]
    v_mfma_f32_16x16x32_bf16 v[168:171], v[84:87], v[132:135], v[168:171]
    v_mfma_f32_16x16x32_bf16 v[172:175], v[84:87], v[136:139], v[172:175]
    v_mfma_f32_16x16x32_bf16 v[152:155], v[88:91], v[112:115], v[152:155]
    v_mfma_f32_16x16x32_bf16 v[156:159], v[88:91], v[116:119], v[156:159]
    v_mfma_f32_16x16x32_bf16 v[160:163], v[88:91], v[120:123], v[160:163]
    v_mfma_f32_16x16x32_bf16 v[164:167], v[88:91], v[124:127], v[164:167]
    v_mfma_f32_16x16x32_bf16 v[168:171], v[88:91], v[128:131], v[168:171]
    v_mfma_f32_16x16x32_bf16 v[172:175], v[88:91], v[132:135], v[172:175]
    v_mfma_f32_16x16x32_bf16 v[156:159], v[92:95], v[112:115], v[156:159]
    v_mfma_f32_16x16x32_bf16 v[160:163], v[92:95], v[116:119], v[160:163]
    v_mfma_f32_16x16x32_bf16 v[164:167], v[92:95], v[120:123], v[164:167]
    v_mfma_f32_16x16x32_bf16 v[168:171], v[92:95], v[124:127], v[168:171]
    v_mfma_f32_16x16x32_bf16 v[172:175], v[92:95], v[128:131], v[172:175]
    v_mfma_f32_16x16x32_bf16 v[160:163], v[96:99], v[112:115], v[160:163]
    v_mfma_f32_16x16x32_bf16 v[164:167], v[96:99], v[116:119], v[164:167]
    v_mfma_f32_16x16x32_bf16 v[168:171], v[96:99], v[120:123], v[168:171]
    v_mfma_f32_16x16x32_bf16 v[172:175], v[96:99], v[124:127], v[172:175]
    v_mfma_f32_16x16x32_bf16 v[164:167], v[100:103], v[112:115], v[164:167]
    v_mfma_f32_16x16x32_bf16 v[168:171], v[100:103], v[116:119], v[168:171]
    v_mfma_f32_16x16x32_bf16 v[172:175], v[100:103], v[120:123], v[172:175]
    v_mfma_f32_16x16x32_bf16 v[168:171], v[104:107], v[112:115], v[168:171]
    v_mfma_f32_16x16x32_bf16 v[172:175], v[104:107], v[116:119], v[172:175]
    v_mfma_f32_16x16x32_bf16 v[172:175], v[108:111], v[112:115], v[172:175]
    s_mul_i32 s52, s28, 4608
    s_add_u32 s52, s52, 67576
    v_lshlrev_b32 v14, 5, v11
    v_lshl_add_u32 v14, v12, 3, v14
    v_sub_u32 v14, s52, v14
    ds_read_b64 v[16:17], v14 offset:3584
    ds_read_b64 v[18:19], v14 offset:3072
    ds_read_b64 v[20:21], v14 offset:2560
    ds_read_b64 v[22:23], v14 offset:2048
    ds_read_b64 v[24:25], v14 offset:1536
    ds_read_b64 v[26:27], v14 offset:1024
    ds_read_b64 v[28:29], v14 offset:512
    ds_read_b64 v[30:31], v14 offset:0
    s_and_b32 s52, s28, 1
    s_cmp_eq_u32 s52, 0
    s_cbranch_scc1 B_DLO
    s_and_b32 s64, s64, 0xffff0000
    s_branch B_DD
B_DLO:
    s_lshl_b32 s64, s64, 16
B_DD:
    v_lshl_add_u32 v13, v11, 2, v12
    v_lshrrev_b32 v15, 2, v11
    v_xor_b32 v13, v13, v15
    s_mul_i32 s52, s28, 8384
    v_lshlrev_b32 v13, 3, v13
    v_add_u32 v13, s52, v13
    s_waitcnt lgkmcnt(0)
    v_and_b32 v32, 0xffff0000, v17
    v_lshlrev_b32 v33, 16, v17
    v_and_b32 v34, 0xffff0000, v16
    v_lshlrev_b32 v35, 16, v16
    v_fma_f32 v32, v32, s64, v144
    v_fma_f32 v33, v33, s64, v145
    v_fma_f32 v34, v34, s64, v146
    v_fma_f32 v35, v35, s64, v147
    v_cvt_pk_bf16_f32 v40, v32, v33
    v_cvt_pk_bf16_f32 v41, v34, v35
    ds_write_b64 v13, v[40:41] offset:0
    v_and_b32 v32, 0xffff0000, v19
    v_lshlrev_b32 v33, 16, v19
    v_and_b32 v34, 0xffff0000, v18
    v_lshlrev_b32 v35, 16, v18
    v_fma_f32 v32, v32, s64, v148
    v_fma_f32 v33, v33, s64, v149
    v_fma_f32 v34, v34, s64, v150
    v_fma_f32 v35, v35, s64, v151
    v_cvt_pk_bf16_f32 v42, v32, v33
    v_cvt_pk_bf16_f32 v43, v34, v35
    ds_write_b64 v13, v[42:43] offset:512
    v_and_b32 v32, 0xffff0000, v21
    v_lshlrev_b32 v33, 16, v21
    v_and_b32 v34, 0xffff0000, v20
    v_lshlrev_b32 v35, 16, v20
    v_fma_f32 v32, v32, s64, v152
    v_fma_f32 v33, v33, s64, v153
    v_fma_f32 v34, v34, s64, v154
    v_fma_f32 v35, v35, s64, v155
    v_cvt_pk_bf16_f32 v44, v32, v33
    v_cvt_pk_bf16_f32 v45, v34, v35
    ds_write_b64 v13, v[44:45] offset:1024
    v_and_b32 v32, 0xffff0000, v23
    v_lshlrev_b32 v33, 16, v23
    v_and_b32 v34, 0xffff0000, v22
    v_lshlrev_b32 v35, 16, v22
    v_fma_f32 v32, v32, s64, v156
    v_fma_f32 v33, v33, s64, v157
    v_fma_f32 v34, v34, s64, v158
    v_fma_f32 v35, v35, s64, v159
    v_cvt_pk_bf16_f32 v46, v32, v33
    v_cvt_pk_bf16_f32 v47, v34, v35
    ds_write_b64 v13, v[46:47] offset:1536
    v_and_b32 v32, 0xffff0000, v25
    v_lshlrev_b32 v33, 16, v25
    v_and_b32 v34, 0xffff0000, v24
    v_lshlrev_b32 v35, 16, v24
    v_fma_f32 v32, v32, s64, v160
    v_fma_f32 v33, v33, s64, v161
    v_fma_f32 v34, v34, s64, v162
    v_fma_f32 v35, v35, s64, v163
    v_cvt_pk_bf16_f32 v48, v32, v33
    v_cvt_pk_bf16_f32 v49, v34, v35
    ds_write_b64 v13, v[48:49] offset:2048
    v_and_b32 v32, 0xffff0000, v27
    v_lshlrev_b32 v33, 16, v27
    v_and_b32 v34, 0xffff0000, v26
    v_lshlrev_b32 v35, 16, v26
    v_fma_f32 v32, v32, s64, v164
    v_fma_f32 v33, v33, s64, v165
    v_fma_f32 v34, v34, s64, v166
    v_fma_f32 v35, v35, s64, v167
    v_cvt_pk_bf16_f32 v50, v32, v33
    v_cvt_pk_bf16_f32 v51, v34, v35
    ds_write_b64 v13, v[50:51] offset:2560
    v_and_b32 v32, 0xffff0000, v29
    v_lshlrev_b32 v33, 16, v29
    v_and_b32 v34, 0xffff0000, v28
    v_lshlrev_b32 v35, 16, v28
    v_fma_f32 v32, v32, s64, v168
    v_fma_f32 v33, v33, s64, v169
    v_fma_f32 v34, v34, s64, v170
    v_fma_f32 v35, v35, s64, v171
    v_cvt_pk_bf16_f32 v52, v32, v33
    v_cvt_pk_bf16_f32 v53, v34, v35
    ds_write_b64 v13, v[52:53] offset:3072
    v_and_b32 v32, 0xffff0000, v31
    v_lshlrev_b32 v33, 16, v31
    v_and_b32 v34, 0xffff0000, v30
    v_lshlrev_b32 v35, 16, v30
    v_fma_f32 v32, v32, s64, v172
    v_fma_f32 v33, v33, s64, v173
    v_fma_f32 v34, v34, s64, v174
    v_fma_f32 v35, v35, s64, v175
    v_cvt_pk_bf16_f32 v54, v32, v33
    v_cvt_pk_bf16_f32 v55, v34, v35
    ds_write_b64 v13, v[54:55] offset:3584
    v_bfe_u32 v1, v10, 2, 2
    v_mul_u32_u24 v1, 8384, v1
    s_lshl_b32 s52, s28, 9
    v_lshl_add_u32 v1, v12, 5, v1
    v_add_u32 v1, s52, v1
    v_and_b32 v2, 3, v10
    v_xor_b32 v3, 0, v2
    v_lshl_add_u32 v4, v3, 3, v1
    v_xor_b32 v3, 1, v2
    v_lshl_add_u32 v5, v3, 3, v1
    v_xor_b32 v3, 2, v2
    v_lshl_add_u32 v6, v3, 3, v1
    v_xor_b32 v3, 3, v2
    v_lshl_add_u32 v7, v3, 3, v1
    s_lshl_b32 s52, s28, 12
    s_add_u32 s52, s52, 103936
    v_lshlrev_b32 v8, 4, v10
    v_add_u32 v8, s52, v8
    s_mov_b32 s44, s22
    s_mov_b32 s45, s23
    s_and_b32 s45, s45, 0xffff
    s_mov_b32 s46, 0x500000
    s_mov_b32 s47, 0x20000
    s_lshl_b32 s52, s28, 8
    v_add_u32 v9, s52, v10
    v_mul_u32_u24 v9, 2560, v9
    s_lshl_b32 s52, s29, 4
    s_add_u32 s52, s52, 1280
    v_add_u32 v9, s52, v9
    s_waitcnt vmcnt(0) lgkmcnt(0)
    s_barrier
    ds_read_b64_tr_b16 v[64:65], v4 offset:0
    ds_read_b64_tr_b16 v[66:67], v4 offset:33536
    ds_read_b128 v[68:71], v8 offset:0
    ds_read_b64_tr_b16 v[72:73], v5 offset:128
    ds_read_b64_tr_b16 v[74:75], v5 offset:33664
    ds_read_b128 v[76:79], v8 offset:1024
    ds_read_b64_tr_b16 v[80:81], v6 offset:256
    ds_read_b64_tr_b16 v[82:83], v6 offset:33792
    ds_read_b128 v[84:87], v8 offset:2048
    ds_read_b64_tr_b16 v[88:89], v7 offset:384
    ds_read_b64_tr_b16 v[90:91], v7 offset:33920
    ds_read_b128 v[92:95], v8 offset:3072
    s_mov_b32 s53, 0
    s_waitcnt lgkmcnt(9)
    v_lshlrev_b32 v32, 16, v64
    v_and_b32 v33, 0xffff0000, v64
    v_lshlrev_b32 v34, 16, v68
    v_and_b32 v35, 0xffff0000, v68
    v_mul_f32 v32, v32, v34
    v_mul_f32 v33, v33, v35
    v_cvt_pk_bf16_f32 v100, v32, v33
    v_lshlrev_b32 v32, 16, v65
    v_and_b32 v33, 0xffff0000, v65
    v_lshlrev_b32 v34, 16, v69
    v_and_b32 v35, 0xffff0000, v69
    v_mul_f32 v32, v32, v34
    v_mul_f32 v33, v33, v35
    v_cvt_pk_bf16_f32 v101, v32, v33
    v_lshlrev_b32 v32, 16, v66
    v_and_b32 v33, 0xffff0000, v66
    v_lshlrev_b32 v34, 16, v70
    v_and_b32 v35, 0xffff0000, v70
    v_mul_f32 v32, v32, v34
    v_mul_f32 v33, v33, v35
    v_cvt_pk_bf16_f32 v102, v32, v33
    v_lshlrev_b32 v32, 16, v67
    v_and_b32 v33, 0xffff0000, v67
    v_lshlrev_b32 v34, 16, v71
    v_and_b32 v35, 0xffff0000, v71
    v_mul_f32 v32, v32, v34
    v_mul_f32 v33, v33, v35
    v_cvt_pk_bf16_f32 v103, v32, v33
    buffer_store_dwordx4 v[100:103], v9, s[44:47], s53 offen
    s_add_u32 s53, s53, 163840
    s_waitcnt lgkmcnt(6)
    v_lshlrev_b32 v32, 16, v72
    v_and_b32 v33, 0xffff0000, v72
    v_lshlrev_b32 v34, 16, v76
    v_and_b32 v35, 0xffff0000, v76
    v_mul_f32 v32, v32, v34
    v_mul_f32 v33, v33, v35
    v_cvt_pk_bf16_f32 v104, v32, v33
    v_lshlrev_b32 v32, 16, v73
    v_and_b32 v33, 0xffff0000, v73
    v_lshlrev_b32 v34, 16, v77
    v_and_b32 v35, 0xffff0000, v77
    v_mul_f32 v32, v32, v34
    v_mul_f32 v33, v33, v35
    v_cvt_pk_bf16_f32 v105, v32, v33
    v_lshlrev_b32 v32, 16, v74
    v_and_b32 v33, 0xffff0000, v74
    v_lshlrev_b32 v34, 16, v78
    v_and_b32 v35, 0xffff0000, v78
    v_mul_f32 v32, v32, v34
    v_mul_f32 v33, v33, v35
    v_cvt_pk_bf16_f32 v106, v32, v33
    v_lshlrev_b32 v32, 16, v75
    v_and_b32 v33, 0xffff0000, v75
    v_lshlrev_b32 v34, 16, v79
    v_and_b32 v35, 0xffff0000, v79
    v_mul_f32 v32, v32, v34
    v_mul_f32 v33, v33, v35
    v_cvt_pk_bf16_f32 v107, v32, v33
    buffer_store_dwordx4 v[104:107], v9, s[44:47], s53 offen
    s_add_u32 s53, s53, 163840
    s_waitcnt lgkmcnt(3)
    v_lshlrev_b32 v32, 16, v80
    v_and_b32 v33, 0xffff0000, v80
    v_lshlrev_b32 v34, 16, v84
    v_and_b32 v35, 0xffff0000, v84
    v_mul_f32 v32, v32, v34
    v_mul_f32 v33, v33, v35
    v_cvt_pk_bf16_f32 v108, v32, v33
    v_lshlrev_b32 v32, 16, v81
    v_and_b32 v33, 0xffff0000, v81
    v_lshlrev_b32 v34, 16, v85
    v_and_b32 v35, 0xffff0000, v85
    v_mul_f32 v32, v32, v34
    v_mul_f32 v33, v33, v35
    v_cvt_pk_bf16_f32 v109, v32, v33
    v_lshlrev_b32 v32, 16, v82
    v_and_b32 v33, 0xffff0000, v82
    v_lshlrev_b32 v34, 16, v86
    v_and_b32 v35, 0xffff0000, v86
    v_mul_f32 v32, v32, v34
    v_mul_f32 v33, v33, v35
    v_cvt_pk_bf16_f32 v110, v32, v33
    v_lshlrev_b32 v32, 16, v83
    v_and_b32 v33, 0xffff0000, v83
    v_lshlrev_b32 v34, 16, v87
    v_and_b32 v35, 0xffff0000, v87
    v_mul_f32 v32, v32, v34
    v_mul_f32 v33, v33, v35
    v_cvt_pk_bf16_f32 v111, v32, v33
    buffer_store_dwordx4 v[108:111], v9, s[44:47], s53 offen
    s_add_u32 s53, s53, 163840
    s_waitcnt lgkmcnt(0)
    v_lshlrev_b32 v32, 16, v88
    v_and_b32 v33, 0xffff0000, v88
    v_lshlrev_b32 v34, 16, v92
    v_and_b32 v35, 0xffff0000, v92
    v_mul_f32 v32, v32, v34
    v_mul_f32 v33, v33, v35
    v_cvt_pk_bf16_f32 v112, v32, v33
    v_lshlrev_b32 v32, 16, v89
    v_and_b32 v33, 0xffff0000, v89
    v_lshlrev_b32 v34, 16, v93
    v_and_b32 v35, 0xffff0000, v93
    v_mul_f32 v32, v32, v34
    v_mul_f32 v33, v33, v35
    v_cvt_pk_bf16_f32 v113, v32, v33
    v_lshlrev_b32 v32, 16, v90
    v_and_b32 v33, 0xffff0000, v90
    v_lshlrev_b32 v34, 16, v94
    v_and_b32 v35, 0xffff0000, v94
    v_mul_f32 v32, v32, v34
    v_mul_f32 v33, v33, v35
    v_cvt_pk_bf16_f32 v114, v32, v33
    v_lshlrev_b32 v32, 16, v91
    v_and_b32 v33, 0xffff0000, v91
    v_lshlrev_b32 v34, 16, v95
    v_and_b32 v35, 0xffff0000, v95
    v_mul_f32 v32, v32, v34
    v_mul_f32 v33, v33, v35
    v_cvt_pk_bf16_f32 v115, v32, v33
    buffer_store_dwordx4 v[112:115], v9, s[44:47], s53 offen
B_END:
    s_endpgm
A_COMPUTE:
    v_and_b32 v11, 15, v10
    v_lshrrev_b32 v12, 4, v10
    v_and_b32 v13, 7, v10
    v_xor_b32 v13, v12, v13
    v_lshlrev_b32 v13, 4, v13
    v_lshl_add_u32 v3, v11, 7, v13
    v_xor_b32 v4, 64, v3
    s_and_b32 s52, s28, 1
    s_mul_i32 s52, s52, 6144
    s_add_u32 s52, s52, 2048
    v_add_u32 v1, s52, v3
    v_add_u32 v2, s52, v4
    v_bfe_u32 v13, v10, 2, 2
    v_lshrrev_b32 v14, 1, v12
    v_lshl_add_u32 v13, v14, 4, v13
    v_and_b32 v14, 1, v12
    v_lshl_add_u32 v13, v14, 2, v13
    v_mul_u32_u24 v14, 480, v13
    s_lshr_b32 s52, s28, 1
    s_mul_i32 s52, s52, 80
    s_add_u32 s52, s52, 14336
    v_add_u32 v14, s52, v14
    v_and_b32 v13, 3, v10
    v_lshl_add_u32 v5, v13, 3, v14
    v_and_b32 v15, 1, v13
    v_mul_u32_u24 v15, 40, v15
    v_add_u32 v14, v14, v15
    v_add_u32 v7, 352, v14
    v_lshrrev_b32 v13, 1, v13
    v_mul_u32_u24 v13, 160, v13
    v_add3_u32 v6, v13, v14, 32
    s_mov_b32 s52, 0xf149f2ca
    v_lshlrev_b32 v13, 2, v12
    v_sub_u32 v13, v11, v13
    v_mov_b32 v15, s52
    v_subrev_u32 v14, 0, v13
    v_and_b32 v11, 1, v14
    v_cmp_eq_u32 vcc, 0, v11
    v_cmp_le_i32 s[58:59], 0, v14
    v_cmp_ge_i32 s[60:61], -2, v14
    s_and_b64 s[58:59], s[58:59], vcc
    s_and_b64 s[60:61], s[60:61], vcc
    v_mov_b32 v232, 0x3f803f80
    v_cndmask_b32 v228, v15, 0, s[58:59]
    v_cndmask_b32 v224, v15, 0, s[60:61]
    v_cndmask_b32 v220, v15, 0, s[60:61]
    v_subrev_u32 v14, 1, v13
    v_and_b32 v11, 1, v14
    v_cmp_eq_u32 vcc, 0, v11
    v_cmp_le_i32 s[58:59], 0, v14
    v_cmp_ge_i32 s[60:61], -2, v14
    s_and_b64 s[58:59], s[58:59], vcc
    s_and_b64 s[60:61], s[60:61], vcc
    v_mov_b32 v233, 0x3f803f80
    v_cndmask_b32 v229, v15, 0, s[58:59]
    v_cndmask_b32 v225, v15, 0, s[60:61]
    v_cndmask_b32 v221, v15, 0, s[60:61]
    v_subrev_u32 v14, 2, v13
    v_and_b32 v11, 1, v14
    v_cmp_eq_u32 vcc, 0, v11
    v_cmp_le_i32 s[58:59], 0, v14
    v_cmp_ge_i32 s[60:61], -2, v14
    s_and_b64 s[58:59], s[58:59], vcc
    s_and_b64 s[60:61], s[60:61], vcc
    v_mov_b32 v234, 0x3f803f80
    v_cndmask_b32 v230, v15, 0, s[58:59]
    v_cndmask_b32 v226, v15, 0, s[60:61]
    v_cndmask_b32 v222, v15, 0, s[60:61]
    v_subrev_u32 v14, 3, v13
    v_and_b32 v11, 1, v14
    v_cmp_eq_u32 vcc, 0, v11
    v_cmp_le_i32 s[58:59], 0, v14
    v_cmp_ge_i32 s[60:61], -2, v14
    s_and_b64 s[58:59], s[58:59], vcc
    s_and_b64 s[60:61], s[60:61], vcc
    v_mov_b32 v235, 0x3f803f80
    v_cndmask_b32 v231, v15, 0, s[58:59]
    v_cndmask_b32 v227, v15, 0, s[60:61]
    v_cndmask_b32 v223, v15, 0, s[60:61]
    s_and_b32 s53, s28, 1
    s_or_b32 s53, s30, s53
    s_cmp_eq_u32 s53, 0
    s_cbranch_scc0 AC_B_1
    v_mov_b32 v220, v15
    v_mov_b32 v221, v15
    v_mov_b32 v222, v15
    v_mov_b32 v223, v15
AC_B_1:
    s_lshr_b32 s54, s28, 1
    s_mul_i32 s54, s54, 6144
    s_add_u32 s54, s54, 81920
    s_mul_i32 s52, s28, 3840
    s_add_u32 s52, s52, 94208
    v_and_b32 v11, 15, v10
    v_lshlrev_b32 v11, 4, v11
    v_add_u32 v11, s52, v11
    v_lshrrev_b32 v12, 4, v10
    v_lshrrev_b32 v13, 1, v12
    v_and_b32 v14, 1, v12
    v_lshlrev_b32 v13, 8, v13
    v_lshl_add_u32 v13, v14, 3, v13
    v_add_u32 v8, v13, v11
    v_add_u32 v13, 5, v12
    v_and_b32 v14, 1, v13
    v_lshrrev_b32 v13, 1, v13
    v_lshlrev_b32 v13, 8, v13
    v_lshl_add_u32 v13, v14, 3, v13
    v_add_u32 v9, v13, v11
    v_mul_u32_u24 v13, 520, v12
    v_add_u32 v11, v13, v11
    v_add_u32 v11, 512, v11
    v_lshlrev_b32 v13, 4, v10
    v_add_u32 v13, s52, v13
    v_lshlrev_b32 v12, 3, v10
    v_add_u32 v12, s54, v12
    s_mul_i32 s53, s30, 6
    s_and_b32 s54, s28, 1
    s_mul_i32 s54, s54, 3
    s_add_u32 s53, s53, s54
    s_mul_i32 s53, s53, 20480
    s_lshl_b32 s54, s31, 1
    s_lshr_b32 s55, s28, 1
    s_add_u32 s54, s54, s55
    s_mul_i32 s54, s54, 1280
    s_add_u32 s53, s53, s54
    s_movk_i32 s54, 19200
    v_add_u32 v14, 0, v10
    v_mul_u32_u24 v15, 820, v14
    v_lshrrev_b32 v15, 16, v15
    v_mul_lo_u32 v15, v15, s54
    v_lshl_add_u32 v15, v14, 4, v15
    v_add_u32 v236, s53, v15
    v_add_u32 v14, 64, v10
    v_mul_u32_u24 v15, 820, v14
    v_lshrrev_b32 v15, 16, v15
    v_mul_lo_u32 v15, v15, s54
    v_lshl_add_u32 v15, v14, 4, v15
    v_add_u32 v237, s53, v15
    v_add_u32 v14, 128, v10
    v_mul_u32_u24 v15, 820, v14
    v_lshrrev_b32 v15, 16, v15
    v_mul_lo_u32 v15, v15, s54
    v_lshl_add_u32 v15, v14, 4, v15
    v_add_u32 v238, s53, v15
    v_add_u32 v14, 192, v10
    v_mul_u32_u24 v15, 820, v14
    v_lshrrev_b32 v15, 16, v15
    v_mul_lo_u32 v15, v15, s54
    v_lshl_add_u32 v15, v14, 4, v15
    v_add_u32 v239, s53, v15
    v_cmp_gt_u32 vcc, 48, v10
    v_mov_b32 v14, 0x7ffffff0
    s_nop 0
    v_cndmask_b32 v239, v14, v239, vcc
    s_mov_b32 s52, 46080
    s_mov_b32 s53, 4294875136
    s_bitcmp1_b32 s28, 0
    s_cbranch_scc1 AC_ODD_1
    s_barrier
    ds_read_b128 v[156:159], v1 offset:0
    ds_read_b128 v[160:163], v1 offset:2048
    ds_read_b128 v[164:167], v1 offset:4096
    ds_read_b64_tr_b16 v[124:125], v5 offset:0
    ds_read_b64_tr_b16 v[126:127], v5 offset:3840
    ds_read_b64_tr_b16 v[128:129], v5 offset:40
    ds_read_b64_tr_b16 v[130:131], v5 offset:3880
    ds_read_b64_tr_b16 v[132:133], v5 offset:160
    ds_read_b64_tr_b16 v[134:135], v5 offset:4000
    ds_read_b128 v[168:171], v3 offset:0
    ds_read_b64_tr_b16 v[136:137], v5 offset:200
    ds_read_b64_tr_b16 v[138:139], v5 offset:4040
    ds_read_b64_tr_b16 v[140:141], v6 offset:0
    ds_read_b64_tr_b16 v[142:143], v6 offset:3840
    ds_read_b64_tr_b16 v[144:145], v5 offset:320
    ds_read_b64_tr_b16 v[146:147], v5 offset:4160
    ds_read_b64_tr_b16 v[148:149], v5 offset:360
    ds_read_b64_tr_b16 v[150:151], v5 offset:4200
    ds_read_b64_tr_b16 v[152:153], v7 offset:0
    ds_read_b64_tr_b16 v[154:155], v7 offset:3840
    s_waitcnt lgkmcnt(0)
    v_mfma_f32_16x16x32_bf16 v[16:19], v[124:127], v[156:159], 0
    ds_read_b128 v[204:207], v2 offset:0
    v_mfma_f32_16x16x32_bf16 v[48:51], v[124:127], v[160:163], 0
    ds_read_b128 v[208:211], v2 offset:2048
    v_mfma_f32_16x16x32_bf16 v[80:83], v[124:127], v[164:167], 0
    ds_read_b128 v[212:215], v2 offset:4096
    v_mfma_f32_16x16x32_bf16 v[20:23], v[128:131], v[156:159], 0
    ds_read_b64_tr_b16 v[172:173], v5 offset:15360
    v_mfma_f32_16x16x32_bf16 v[52:55], v[128:131], v[160:163], 0
    ds_read_b64_tr_b16 v[174:175], v5 offset:19200
    v_mfma_f32_16x16x32_bf16 v[84:87], v[128:131], v[164:167], 0
    ds_read_b64_tr_b16 v[176:177], v5 offset:15400
    v_mfma_f32_16x16x32_bf16 v[24:27], v[132:135], v[156:159], 0
    ds_read_b64_tr_b16 v[178:179], v5 offset:19240
    v_mfma_f32_16x16x32_bf16 v[56:59], v[132:135], v[160:163], 0
    ds_read_b64_tr_b16 v[180:181], v5 offset:15520
    v_mfma_f32_16x16x32_bf16 v[88:91], v[132:135], v[164:167], 0
    ds_read_b64_tr_b16 v[182:183], v5 offset:19360
    v_mfma_f32_16x16x32_bf16 v[112:115], v[132:135], v[168:171], 0
    ds_read_b128 v[216:219], v4 offset:0
    v_mfma_f32_16x16x32_bf16 v[28:31], v[136:139], v[156:159], 0
    ds_read_b64_tr_b16 v[184:185], v5 offset:15560
    v_mfma_f32_16x16x32_bf16 v[60:63], v[136:139], v[160:163], 0
    ds_read_b64_tr_b16 v[186:187], v5 offset:19400
    v_mfma_f32_16x16x32_bf16 v[92:95], v[136:139], v[164:167], 0
    ds_read_b64_tr_b16 v[188:189], v6 offset:15360
    v_mfma_f32_16x16x32_bf16 v[32:35], v[140:143], v[156:159], 0
    ds_read_b64_tr_b16 v[190:191], v6 offset:19200
    v_mfma_f32_16x16x32_bf16 v[64:67], v[140:143], v[160:163], 0
    ds_read_b64_tr_b16 v[192:193], v5 offset:15680
    v_mfma_f32_16x16x32_bf16 v[96:99], v[140:143], v[164:167], 0
    ds_read_b64_tr_b16 v[194:195], v5 offset:19520
    v_mfma_f32_16x16x32_bf16 v[116:119], v[140:143], v[168:171], 0
    ds_read_b64_tr_b16 v[196:197], v5 offset:15720
    v_mfma_f32_16x16x32_bf16 v[36:39], v[156:159], v[144:147], 0
    ds_read_b64_tr_b16 v[198:199], v5 offset:19560
    v_mfma_f32_16x16x32_bf16 v[68:71], v[160:163], v[144:147], 0
    ds_read_b64_tr_b16 v[200:201], v7 offset:15360
    v_mfma_f32_16x16x32_bf16 v[100:103], v[164:167], v[144:147], 0
    ds_read_b64_tr_b16 v[202:203], v7 offset:19200
    v_mfma_f32_16x16x32_bf16 v[120:123], v[168:171], v[144:147], 0
    v_add_u32 v1, s52, v1
    v_mfma_f32_16x16x32_bf16 v[40:43], v[156:159], v[148:151], 0
    v_add_u32 v2, s52, v2
    v_mfma_f32_16x16x32_bf16 v[72:75], v[160:163], v[148:151], 0
    v_add_u32 v3, s52, v3
    v_mfma_f32_16x16x32_bf16 v[104:107], v[164:167], v[148:151], 0
    v_add_u32 v4, s52, v4
    v_mfma_f32_16x16x32_bf16 v[44:47], v[156:159], v[152:155], 0
    v_add_u32 v5, s52, v5
    v_mfma_f32_16x16x32_bf16 v[76:79], v[160:163], v[152:155], 0
    v_add_u32 v6, s52, v6
    v_mfma_f32_16x16x32_bf16 v[108:111], v[164:167], v[152:155], 0
    v_add_u32 v7, s52, v7
    s_waitcnt lgkmcnt(0)
    s_barrier
    v_mfma_f32_16x16x32_bf16 v[16:19], v[172:175], v[204:207], v[16:19]
    ds_read_b128 v[156:159], v1 offset:0
    v_mfma_f32_16x16x32_bf16 v[48:51], v[172:175], v[208:211], v[48:51]
    ds_read_b128 v[160:163], v1 offset:2048
    v_mfma_f32_16x16x32_bf16 v[80:83], v[172:175], v[212:215], v[80:83]
    ds_read_b128 v[164:167], v1 offset:4096
    v_mfma_f32_16x16x32_bf16 v[20:23], v[176:179], v[204:207], v[20:23]
    ds_read_b64_tr_b16 v[124:125], v5 offset:0
    v_mfma_f32_16x16x32_bf16 v[52:55], v[176:179], v[208:211], v[52:55]
    ds_read_b64_tr_b16 v[126:127], v5 offset:3840
    v_mfma_f32_16x16x32_bf16 v[84:87], v[176:179], v[212:215], v[84:87]
    ds_read_b64_tr_b16 v[128:129], v5 offset:40
    v_mfma_f32_16x16x32_bf16 v[24:27], v[180:183], v[204:207], v[24:27]
    ds_read_b64_tr_b16 v[130:131], v5 offset:3880
    v_mfma_f32_16x16x32_bf16 v[56:59], v[180:183], v[208:211], v[56:59]
    ds_read_b64_tr_b16 v[132:133], v5 offset:160
    v_mfma_f32_16x16x32_bf16 v[88:91], v[180:183], v[212:215], v[88:91]
    ds_read_b64_tr_b16 v[134:135], v5 offset:4000
    v_mfma_f32_16x16x32_bf16 v[112:115], v[180:183], v[216:219], v[112:115]
    ds_read_b128 v[168:171], v3 offset:0
    v_mfma_f32_16x16x32_bf16 v[28:31], v[184:187], v[204:207], v[28:31]
    ds_read_b64_tr_b16 v[136:137], v5 offset:200
    v_mfma_f32_16x16x32_bf16 v[60:63], v[184:187], v[208:211], v[60:63]
    ds_read_b64_tr_b16 v[138:139], v5 offset:4040
    v_mfma_f32_16x16x32_bf16 v[92:95], v[184:187], v[212:215], v[92:95]
    ds_read_b64_tr_b16 v[140:141], v6 offset:0
    v_mfma_f32_16x16x32_bf16 v[32:35], v[188:191], v[204:207], v[32:35]
    ds_read_b64_tr_b16 v[142:143], v6 offset:3840
    v_mfma_f32_16x16x32_bf16 v[64:67], v[188:191], v[208:211], v[64:67]
    ds_read_b64_tr_b16 v[144:145], v5 offset:320
    v_mfma_f32_16x16x32_bf16 v[96:99], v[188:191], v[212:215], v[96:99]
    ds_read_b64_tr_b16 v[146:147], v5 offset:4160
    v_mfma_f32_16x16x32_bf16 v[116:119], v[188:191], v[216:219], v[116:119]
    ds_read_b64_tr_b16 v[148:149], v5 offset:360
    v_mfma_f32_16x16x32_bf16 v[36:39], v[204:207], v[192:195], v[36:39]
    ds_read_b64_tr_b16 v[150:151], v5 offset:4200
    v_mfma_f32_16x16x32_bf16 v[68:71], v[208:211], v[192:195], v[68:71]
    ds_read_b64_tr_b16 v[152:153], v7 offset:0
    v_mfma_f32_16x16x32_bf16 v[100:103], v[212:215], v[192:195], v[100:103]
    ds_read_b64_tr_b16 v[154:155], v7 offset:3840
    v_mfma_f32_16x16x32_bf16 v[120:123], v[216:219], v[192:195], v[120:123]
    v_mfma_f32_16x16x32_bf16 v[40:43], v[204:207], v[196:199], v[40:43]
    v_mfma_f32_16x16x32_bf16 v[72:75], v[208:211], v[196:199], v[72:75]
    v_mfma_f32_16x16x32_bf16 v[104:107], v[212:215], v[196:199], v[104:107]
    v_mfma_f32_16x16x32_bf16 v[44:47], v[204:207], v[200:203], v[44:47]
    v_mfma_f32_16x16x32_bf16 v[76:79], v[208:211], v[200:203], v[76:79]
    v_mfma_f32_16x16x32_bf16 v[108:111], v[212:215], v[200:203], v[108:111]
    s_waitcnt lgkmcnt(0)
    v_mfma_f32_16x16x32_bf16 v[16:19], v[124:127], v[156:159], v[16:19]
    ds_read_b128 v[204:207], v2 offset:0
    v_mfma_f32_16x16x32_bf16 v[48:51], v[124:127], v[160:163], v[48:51]
    ds_read_b128 v[208:211], v2 offset:2048
    v_mfma_f32_16x16x32_bf16 v[80:83], v[124:127], v[164:167], v[80:83]
    ds_read_b128 v[212:215], v2 offset:4096
    v_mfma_f32_16x16x32_bf16 v[20:23], v[128:131], v[156:159], v[20:23]
    ds_read_b64_tr_b16 v[172:173], v5 offset:15360
    v_mfma_f32_16x16x32_bf16 v[52:55], v[128:131], v[160:163], v[52:55]
    ds_read_b64_tr_b16 v[174:175], v5 offset:19200
    v_mfma_f32_16x16x32_bf16 v[84:87], v[128:131], v[164:167], v[84:87]
    ds_read_b64_tr_b16 v[176:177], v5 offset:15400
    v_mfma_f32_16x16x32_bf16 v[24:27], v[132:135], v[156:159], v[24:27]
    ds_read_b64_tr_b16 v[178:179], v5 offset:19240
    v_mfma_f32_16x16x32_bf16 v[56:59], v[132:135], v[160:163], v[56:59]
    ds_read_b64_tr_b16 v[180:181], v5 offset:15520
    v_mfma_f32_16x16x32_bf16 v[88:91], v[132:135], v[164:167], v[88:91]
    ds_read_b64_tr_b16 v[182:183], v5 offset:19360
    v_mfma_f32_16x16x32_bf16 v[112:115], v[132:135], v[168:171], v[112:115]
    ds_read_b128 v[216:219], v4 offset:0
    v_mfma_f32_16x16x32_bf16 v[28:31], v[136:139], v[156:159], v[28:31]
    ds_read_b64_tr_b16 v[184:185], v5 offset:15560
    v_mfma_f32_16x16x32_bf16 v[60:63], v[136:139], v[160:163], v[60:63]
    ds_read_b64_tr_b16 v[186:187], v5 offset:19400
    v_mfma_f32_16x16x32_bf16 v[92:95], v[136:139], v[164:167], v[92:95]
    ds_read_b64_tr_b16 v[188:189], v6 offset:15360
    v_mfma_f32_16x16x32_bf16 v[32:35], v[140:143], v[156:159], v[32:35]
    ds_read_b64_tr_b16 v[190:191], v6 offset:19200
    v_mfma_f32_16x16x32_bf16 v[64:67], v[140:143], v[160:163], v[64:67]
    ds_read_b64_tr_b16 v[192:193], v5 offset:15680
    v_mfma_f32_16x16x32_bf16 v[96:99], v[140:143], v[164:167], v[96:99]
    ds_read_b64_tr_b16 v[194:195], v5 offset:19520
    v_mfma_f32_16x16x32_bf16 v[116:119], v[140:143], v[168:171], v[116:119]
    ds_read_b64_tr_b16 v[196:197], v5 offset:15720
    v_mfma_f32_16x16x32_bf16 v[36:39], v[156:159], v[144:147], v[36:39]
    ds_read_b64_tr_b16 v[198:199], v5 offset:19560
    v_mfma_f32_16x16x32_bf16 v[68:71], v[160:163], v[144:147], v[68:71]
    ds_read_b64_tr_b16 v[200:201], v7 offset:15360
    v_mfma_f32_16x16x32_bf16 v[100:103], v[164:167], v[144:147], v[100:103]
    ds_read_b64_tr_b16 v[202:203], v7 offset:19200
    v_mfma_f32_16x16x32_bf16 v[120:123], v[168:171], v[144:147], v[120:123]
    v_add_u32 v1, s52, v1
    v_mfma_f32_16x16x32_bf16 v[40:43], v[156:159], v[148:151], v[40:43]
    v_add_u32 v2, s52, v2
    v_mfma_f32_16x16x32_bf16 v[72:75], v[160:163], v[148:151], v[72:75]
    v_add_u32 v3, s52, v3
    v_mfma_f32_16x16x32_bf16 v[104:107], v[164:167], v[148:151], v[104:107]
    v_add_u32 v4, s52, v4
    v_mfma_f32_16x16x32_bf16 v[44:47], v[156:159], v[152:155], v[44:47]
    v_add_u32 v5, s52, v5
    v_mfma_f32_16x16x32_bf16 v[76:79], v[160:163], v[152:155], v[76:79]
    v_add_u32 v6, s52, v6
    v_mfma_f32_16x16x32_bf16 v[108:111], v[164:167], v[152:155], v[108:111]
    v_add_u32 v7, s52, v7
    s_waitcnt lgkmcnt(0)
    s_barrier
    v_mfma_f32_16x16x32_bf16 v[16:19], v[172:175], v[204:207], v[16:19]
    ds_read_b128 v[156:159], v1 offset:0
    v_mfma_f32_16x16x32_bf16 v[48:51], v[172:175], v[208:211], v[48:51]
    ds_read_b128 v[160:163], v1 offset:2048
    v_mfma_f32_16x16x32_bf16 v[80:83], v[172:175], v[212:215], v[80:83]
    ds_read_b128 v[164:167], v1 offset:4096
    v_mfma_f32_16x16x32_bf16 v[20:23], v[176:179], v[204:207], v[20:23]
    ds_read_b64_tr_b16 v[124:125], v5 offset:0
    v_mfma_f32_16x16x32_bf16 v[52:55], v[176:179], v[208:211], v[52:55]
    ds_read_b64_tr_b16 v[126:127], v5 offset:3840
    v_mfma_f32_16x16x32_bf16 v[84:87], v[176:179], v[212:215], v[84:87]
    ds_read_b64_tr_b16 v[128:129], v5 offset:40
    v_mfma_f32_16x16x32_bf16 v[24:27], v[180:183], v[204:207], v[24:27]
    ds_read_b64_tr_b16 v[130:131], v5 offset:3880
    v_mfma_f32_16x16x32_bf16 v[56:59], v[180:183], v[208:211], v[56:59]
    ds_read_b64_tr_b16 v[132:133], v5 offset:160
    v_mfma_f32_16x16x32_bf16 v[88:91], v[180:183], v[212:215], v[88:91]
    ds_read_b64_tr_b16 v[134:135], v5 offset:4000
    v_mfma_f32_16x16x32_bf16 v[112:115], v[180:183], v[216:219], v[112:115]
    ds_read_b128 v[168:171], v3 offset:0
    v_mfma_f32_16x16x32_bf16 v[28:31], v[184:187], v[204:207], v[28:31]
    ds_read_b64_tr_b16 v[136:137], v5 offset:200
    v_mfma_f32_16x16x32_bf16 v[60:63], v[184:187], v[208:211], v[60:63]
    ds_read_b64_tr_b16 v[138:139], v5 offset:4040
    v_mfma_f32_16x16x32_bf16 v[92:95], v[184:187], v[212:215], v[92:95]
    ds_read_b64_tr_b16 v[140:141], v6 offset:0
    v_mfma_f32_16x16x32_bf16 v[32:35], v[188:191], v[204:207], v[32:35]
    ds_read_b64_tr_b16 v[142:143], v6 offset:3840
    v_mfma_f32_16x16x32_bf16 v[64:67], v[188:191], v[208:211], v[64:67]
    ds_read_b64_tr_b16 v[144:145], v5 offset:320
    v_mfma_f32_16x16x32_bf16 v[96:99], v[188:191], v[212:215], v[96:99]
    ds_read_b64_tr_b16 v[146:147], v5 offset:4160
    v_mfma_f32_16x16x32_bf16 v[116:119], v[188:191], v[216:219], v[116:119]
    ds_read_b64_tr_b16 v[148:149], v5 offset:360
    v_mfma_f32_16x16x32_bf16 v[36:39], v[204:207], v[192:195], v[36:39]
    ds_read_b64_tr_b16 v[150:151], v5 offset:4200
    v_mfma_f32_16x16x32_bf16 v[68:71], v[208:211], v[192:195], v[68:71]
    ds_read_b64_tr_b16 v[152:153], v7 offset:0
    v_mfma_f32_16x16x32_bf16 v[100:103], v[212:215], v[192:195], v[100:103]
    ds_read_b64_tr_b16 v[154:155], v7 offset:3840
    v_mfma_f32_16x16x32_bf16 v[120:123], v[216:219], v[192:195], v[120:123]
    v_mfma_f32_16x16x32_bf16 v[40:43], v[204:207], v[196:199], v[40:43]
    v_mfma_f32_16x16x32_bf16 v[72:75], v[208:211], v[196:199], v[72:75]
    v_mfma_f32_16x16x32_bf16 v[104:107], v[212:215], v[196:199], v[104:107]
    v_mfma_f32_16x16x32_bf16 v[44:47], v[204:207], v[200:203], v[44:47]
    v_mfma_f32_16x16x32_bf16 v[76:79], v[208:211], v[200:203], v[76:79]
    v_mfma_f32_16x16x32_bf16 v[108:111], v[212:215], v[200:203], v[108:111]
    s_waitcnt lgkmcnt(0)
    v_mfma_f32_16x16x32_bf16 v[16:19], v[124:127], v[156:159], v[16:19]
    ds_read_b128 v[204:207], v2 offset:0
    v_mfma_f32_16x16x32_bf16 v[48:51], v[124:127], v[160:163], v[48:51]
    ds_read_b128 v[208:211], v2 offset:2048
    v_mfma_f32_16x16x32_bf16 v[80:83], v[124:127], v[164:167], v[80:83]
    ds_read_b128 v[212:215], v2 offset:4096
    v_mfma_f32_16x16x32_bf16 v[20:23], v[128:131], v[156:159], v[20:23]
    ds_read_b64_tr_b16 v[172:173], v5 offset:15360
    v_mfma_f32_16x16x32_bf16 v[52:55], v[128:131], v[160:163], v[52:55]
    ds_read_b64_tr_b16 v[174:175], v5 offset:19200
    v_mfma_f32_16x16x32_bf16 v[84:87], v[128:131], v[164:167], v[84:87]
    ds_read_b64_tr_b16 v[176:177], v5 offset:15400
    v_mfma_f32_16x16x32_bf16 v[24:27], v[132:135], v[156:159], v[24:27]
    ds_read_b64_tr_b16 v[178:179], v5 offset:19240
    v_mfma_f32_16x16x32_bf16 v[56:59], v[132:135], v[160:163], v[56:59]
    ds_read_b64_tr_b16 v[180:181], v5 offset:15520
    v_mfma_f32_16x16x32_bf16 v[88:91], v[132:135], v[164:167], v[88:91]
    ds_read_b64_tr_b16 v[182:183], v5 offset:19360
    v_mfma_f32_16x16x32_bf16 v[112:115], v[132:135], v[168:171], v[112:115]
    ds_read_b128 v[216:219], v4 offset:0
    v_mfma_f32_16x16x32_bf16 v[28:31], v[136:139], v[156:159], v[28:31]
    ds_read_b64_tr_b16 v[184:185], v5 offset:15560
    v_mfma_f32_16x16x32_bf16 v[60:63], v[136:139], v[160:163], v[60:63]
    ds_read_b64_tr_b16 v[186:187], v5 offset:19400
    v_mfma_f32_16x16x32_bf16 v[92:95], v[136:139], v[164:167], v[92:95]
    ds_read_b64_tr_b16 v[188:189], v6 offset:15360
    v_mfma_f32_16x16x32_bf16 v[32:35], v[140:143], v[156:159], v[32:35]
    ds_read_b64_tr_b16 v[190:191], v6 offset:19200
    v_mfma_f32_16x16x32_bf16 v[64:67], v[140:143], v[160:163], v[64:67]
    ds_read_b64_tr_b16 v[192:193], v5 offset:15680
    v_mfma_f32_16x16x32_bf16 v[96:99], v[140:143], v[164:167], v[96:99]
    ds_read_b64_tr_b16 v[194:195], v5 offset:19520
    v_mfma_f32_16x16x32_bf16 v[116:119], v[140:143], v[168:171], v[116:119]
    ds_read_b64_tr_b16 v[196:197], v5 offset:15720
    v_mfma_f32_16x16x32_bf16 v[36:39], v[156:159], v[144:147], v[36:39]
    ds_read_b64_tr_b16 v[198:199], v5 offset:19560
    v_mfma_f32_16x16x32_bf16 v[68:71], v[160:163], v[144:147], v[68:71]
    ds_read_b64_tr_b16 v[200:201], v7 offset:15360
    v_mfma_f32_16x16x32_bf16 v[100:103], v[164:167], v[144:147], v[100:103]
    ds_read_b64_tr_b16 v[202:203], v7 offset:19200
    v_mfma_f32_16x16x32_bf16 v[120:123], v[168:171], v[144:147], v[120:123]
    v_add_u32 v1, s53, v1
    v_mfma_f32_16x16x32_bf16 v[40:43], v[156:159], v[148:151], v[40:43]
    v_add_u32 v2, s53, v2
    v_mfma_f32_16x16x32_bf16 v[72:75], v[160:163], v[148:151], v[72:75]
    v_add_u32 v3, s53, v3
    v_mfma_f32_16x16x32_bf16 v[104:107], v[164:167], v[148:151], v[104:107]
    v_add_u32 v4, s53, v4
    v_mfma_f32_16x16x32_bf16 v[44:47], v[156:159], v[152:155], v[44:47]
    v_add_u32 v5, s53, v5
    v_mfma_f32_16x16x32_bf16 v[76:79], v[160:163], v[152:155], v[76:79]
    v_add_u32 v6, s53, v6
    v_mfma_f32_16x16x32_bf16 v[108:111], v[164:167], v[152:155], v[108:111]
    v_add_u32 v7, s53, v7
    s_waitcnt lgkmcnt(0)
    s_barrier
    v_mfma_f32_16x16x32_bf16 v[16:19], v[172:175], v[204:207], v[16:19]
    ds_read_b128 v[156:159], v1 offset:0
    v_mfma_f32_16x16x32_bf16 v[48:51], v[172:175], v[208:211], v[48:51]
    ds_read_b128 v[160:163], v1 offset:2048
    v_mfma_f32_16x16x32_bf16 v[80:83], v[172:175], v[212:215], v[80:83]
    ds_read_b128 v[164:167], v1 offset:4096
    v_mfma_f32_16x16x32_bf16 v[20:23], v[176:179], v[204:207], v[20:23]
    ds_read_b64_tr_b16 v[124:125], v5 offset:0
    v_mfma_f32_16x16x32_bf16 v[52:55], v[176:179], v[208:211], v[52:55]
    ds_read_b64_tr_b16 v[126:127], v5 offset:3840
    v_mfma_f32_16x16x32_bf16 v[84:87], v[176:179], v[212:215], v[84:87]
    ds_read_b64_tr_b16 v[128:129], v5 offset:40
    v_mfma_f32_16x16x32_bf16 v[24:27], v[180:183], v[204:207], v[24:27]
    ds_read_b64_tr_b16 v[130:131], v5 offset:3880
    v_mfma_f32_16x16x32_bf16 v[56:59], v[180:183], v[208:211], v[56:59]
    ds_read_b64_tr_b16 v[132:133], v5 offset:160
    v_mfma_f32_16x16x32_bf16 v[88:91], v[180:183], v[212:215], v[88:91]
    ds_read_b64_tr_b16 v[134:135], v5 offset:4000
    v_mfma_f32_16x16x32_bf16 v[112:115], v[180:183], v[216:219], v[112:115]
    ds_read_b128 v[168:171], v3 offset:0
    v_mfma_f32_16x16x32_bf16 v[28:31], v[184:187], v[204:207], v[28:31]
    ds_read_b64_tr_b16 v[136:137], v5 offset:200
    v_mfma_f32_16x16x32_bf16 v[60:63], v[184:187], v[208:211], v[60:63]
    ds_read_b64_tr_b16 v[138:139], v5 offset:4040
    v_mfma_f32_16x16x32_bf16 v[92:95], v[184:187], v[212:215], v[92:95]
    ds_read_b64_tr_b16 v[140:141], v6 offset:0
    v_mfma_f32_16x16x32_bf16 v[32:35], v[188:191], v[204:207], v[32:35]
    ds_read_b64_tr_b16 v[142:143], v6 offset:3840
    v_mfma_f32_16x16x32_bf16 v[64:67], v[188:191], v[208:211], v[64:67]
    ds_read_b64_tr_b16 v[144:145], v5 offset:320
    v_mfma_f32_16x16x32_bf16 v[96:99], v[188:191], v[212:215], v[96:99]
    ds_read_b64_tr_b16 v[146:147], v5 offset:4160
    v_mfma_f32_16x16x32_bf16 v[116:119], v[188:191], v[216:219], v[116:119]
    ds_read_b64_tr_b16 v[148:149], v5 offset:360
    v_mfma_f32_16x16x32_bf16 v[36:39], v[204:207], v[192:195], v[36:39]
    ds_read_b64_tr_b16 v[150:151], v5 offset:4200
    v_mfma_f32_16x16x32_bf16 v[68:71], v[208:211], v[192:195], v[68:71]
    ds_read_b64_tr_b16 v[152:153], v7 offset:0
    v_mfma_f32_16x16x32_bf16 v[100:103], v[212:215], v[192:195], v[100:103]
    ds_read_b64_tr_b16 v[154:155], v7 offset:3840
    v_mfma_f32_16x16x32_bf16 v[120:123], v[216:219], v[192:195], v[120:123]
    v_mfma_f32_16x16x32_bf16 v[40:43], v[204:207], v[196:199], v[40:43]
    v_mfma_f32_16x16x32_bf16 v[72:75], v[208:211], v[196:199], v[72:75]
    v_mfma_f32_16x16x32_bf16 v[104:107], v[212:215], v[196:199], v[104:107]
    v_mfma_f32_16x16x32_bf16 v[44:47], v[204:207], v[200:203], v[44:47]
    v_mfma_f32_16x16x32_bf16 v[76:79], v[208:211], v[200:203], v[76:79]
    v_mfma_f32_16x16x32_bf16 v[108:111], v[212:215], v[200:203], v[108:111]
    s_waitcnt lgkmcnt(0)
    v_mfma_f32_16x16x32_bf16 v[16:19], v[124:127], v[156:159], v[16:19]
    ds_read_b128 v[204:207], v2 offset:0
    v_mfma_f32_16x16x32_bf16 v[48:51], v[124:127], v[160:163], v[48:51]
    ds_read_b128 v[208:211], v2 offset:2048
    v_mfma_f32_16x16x32_bf16 v[80:83], v[124:127], v[164:167], v[80:83]
    ds_read_b128 v[212:215], v2 offset:4096
    v_mfma_f32_16x16x32_bf16 v[20:23], v[128:131], v[156:159], v[20:23]
    ds_read_b64_tr_b16 v[172:173], v5 offset:15360
    v_mfma_f32_16x16x32_bf16 v[52:55], v[128:131], v[160:163], v[52:55]
    ds_read_b64_tr_b16 v[174:175], v5 offset:19200
    v_mfma_f32_16x16x32_bf16 v[84:87], v[128:131], v[164:167], v[84:87]
    ds_read_b64_tr_b16 v[176:177], v5 offset:15400
    v_mfma_f32_16x16x32_bf16 v[24:27], v[132:135], v[156:159], v[24:27]
    ds_read_b64_tr_b16 v[178:179], v5 offset:19240
    v_mfma_f32_16x16x32_bf16 v[56:59], v[132:135], v[160:163], v[56:59]
    ds_read_b64_tr_b16 v[180:181], v5 offset:15520
    v_mfma_f32_16x16x32_bf16 v[88:91], v[132:135], v[164:167], v[88:91]
    ds_read_b64_tr_b16 v[182:183], v5 offset:19360
    v_mfma_f32_16x16x32_bf16 v[112:115], v[132:135], v[168:171], v[112:115]
    ds_read_b128 v[216:219], v4 offset:0
    v_mfma_f32_16x16x32_bf16 v[28:31], v[136:139], v[156:159], v[28:31]
    ds_read_b64_tr_b16 v[184:185], v5 offset:15560
    v_mfma_f32_16x16x32_bf16 v[60:63], v[136:139], v[160:163], v[60:63]
    ds_read_b64_tr_b16 v[186:187], v5 offset:19400
    v_mfma_f32_16x16x32_bf16 v[92:95], v[136:139], v[164:167], v[92:95]
    ds_read_b64_tr_b16 v[188:189], v6 offset:15360
    v_mfma_f32_16x16x32_bf16 v[32:35], v[140:143], v[156:159], v[32:35]
    ds_read_b64_tr_b16 v[190:191], v6 offset:19200
    v_mfma_f32_16x16x32_bf16 v[64:67], v[140:143], v[160:163], v[64:67]
    ds_read_b64_tr_b16 v[192:193], v5 offset:15680
    v_mfma_f32_16x16x32_bf16 v[96:99], v[140:143], v[164:167], v[96:99]
    ds_read_b64_tr_b16 v[194:195], v5 offset:19520
    v_mfma_f32_16x16x32_bf16 v[116:119], v[140:143], v[168:171], v[116:119]
    ds_read_b64_tr_b16 v[196:197], v5 offset:15720
    v_mfma_f32_16x16x32_bf16 v[36:39], v[156:159], v[144:147], v[36:39]
    ds_read_b64_tr_b16 v[198:199], v5 offset:19560
    v_mfma_f32_16x16x32_bf16 v[68:71], v[160:163], v[144:147], v[68:71]
    ds_read_b64_tr_b16 v[200:201], v7 offset:15360
    v_mfma_f32_16x16x32_bf16 v[100:103], v[164:167], v[144:147], v[100:103]
    ds_read_b64_tr_b16 v[202:203], v7 offset:19200
    v_mfma_f32_16x16x32_bf16 v[120:123], v[168:171], v[144:147], v[120:123]
    v_add_u32 v1, s52, v1
    v_mfma_f32_16x16x32_bf16 v[40:43], v[156:159], v[148:151], v[40:43]
    v_add_u32 v2, s52, v2
    v_mfma_f32_16x16x32_bf16 v[72:75], v[160:163], v[148:151], v[72:75]
    v_add_u32 v3, s52, v3
    v_mfma_f32_16x16x32_bf16 v[104:107], v[164:167], v[148:151], v[104:107]
    v_add_u32 v4, s52, v4
    v_mfma_f32_16x16x32_bf16 v[44:47], v[156:159], v[152:155], v[44:47]
    v_add_u32 v5, s52, v5
    v_mfma_f32_16x16x32_bf16 v[76:79], v[160:163], v[152:155], v[76:79]
    v_add_u32 v6, s52, v6
    v_mfma_f32_16x16x32_bf16 v[108:111], v[164:167], v[152:155], v[108:111]
    v_add_u32 v7, s52, v7
    s_waitcnt lgkmcnt(0)
    s_barrier
    v_mfma_f32_16x16x32_bf16 v[16:19], v[172:175], v[204:207], v[16:19]
    ds_read_b128 v[156:159], v1 offset:0
    v_mfma_f32_16x16x32_bf16 v[48:51], v[172:175], v[208:211], v[48:51]
    ds_read_b128 v[160:163], v1 offset:2048
    v_mfma_f32_16x16x32_bf16 v[80:83], v[172:175], v[212:215], v[80:83]
    ds_read_b128 v[164:167], v1 offset:4096
    v_mfma_f32_16x16x32_bf16 v[20:23], v[176:179], v[204:207], v[20:23]
    ds_read_b64_tr_b16 v[124:125], v5 offset:0
    v_mfma_f32_16x16x32_bf16 v[52:55], v[176:179], v[208:211], v[52:55]
    ds_read_b64_tr_b16 v[126:127], v5 offset:3840
    v_mfma_f32_16x16x32_bf16 v[84:87], v[176:179], v[212:215], v[84:87]
    ds_read_b64_tr_b16 v[128:129], v5 offset:40
    v_mfma_f32_16x16x32_bf16 v[24:27], v[180:183], v[204:207], v[24:27]
    ds_read_b64_tr_b16 v[130:131], v5 offset:3880
    v_mfma_f32_16x16x32_bf16 v[56:59], v[180:183], v[208:211], v[56:59]
    ds_read_b64_tr_b16 v[132:133], v5 offset:160
    v_mfma_f32_16x16x32_bf16 v[88:91], v[180:183], v[212:215], v[88:91]
    ds_read_b64_tr_b16 v[134:135], v5 offset:4000
    v_mfma_f32_16x16x32_bf16 v[112:115], v[180:183], v[216:219], v[112:115]
    ds_read_b128 v[168:171], v3 offset:0
    v_mfma_f32_16x16x32_bf16 v[28:31], v[184:187], v[204:207], v[28:31]
    ds_read_b64_tr_b16 v[136:137], v5 offset:200
    v_mfma_f32_16x16x32_bf16 v[60:63], v[184:187], v[208:211], v[60:63]
    ds_read_b64_tr_b16 v[138:139], v5 offset:4040
    v_mfma_f32_16x16x32_bf16 v[92:95], v[184:187], v[212:215], v[92:95]
    ds_read_b64_tr_b16 v[140:141], v6 offset:0
    v_mfma_f32_16x16x32_bf16 v[32:35], v[188:191], v[204:207], v[32:35]
    ds_read_b64_tr_b16 v[142:143], v6 offset:3840
    v_mfma_f32_16x16x32_bf16 v[64:67], v[188:191], v[208:211], v[64:67]
    ds_read_b64_tr_b16 v[144:145], v5 offset:320
    v_mfma_f32_16x16x32_bf16 v[96:99], v[188:191], v[212:215], v[96:99]
    ds_read_b64_tr_b16 v[146:147], v5 offset:4160
    v_mfma_f32_16x16x32_bf16 v[116:119], v[188:191], v[216:219], v[116:119]
    ds_read_b64_tr_b16 v[148:149], v5 offset:360
    v_mfma_f32_16x16x32_bf16 v[36:39], v[204:207], v[192:195], v[36:39]
    ds_read_b64_tr_b16 v[150:151], v5 offset:4200
    v_mfma_f32_16x16x32_bf16 v[68:71], v[208:211], v[192:195], v[68:71]
    ds_read_b64_tr_b16 v[152:153], v7 offset:0
    v_mfma_f32_16x16x32_bf16 v[100:103], v[212:215], v[192:195], v[100:103]
    ds_read_b64_tr_b16 v[154:155], v7 offset:3840
    v_mfma_f32_16x16x32_bf16 v[120:123], v[216:219], v[192:195], v[120:123]
    v_mfma_f32_16x16x32_bf16 v[40:43], v[204:207], v[196:199], v[40:43]
    v_mfma_f32_16x16x32_bf16 v[72:75], v[208:211], v[196:199], v[72:75]
    v_mfma_f32_16x16x32_bf16 v[104:107], v[212:215], v[196:199], v[104:107]
    v_mfma_f32_16x16x32_bf16 v[44:47], v[204:207], v[200:203], v[44:47]
    v_mfma_f32_16x16x32_bf16 v[76:79], v[208:211], v[200:203], v[76:79]
    v_mfma_f32_16x16x32_bf16 v[108:111], v[212:215], v[200:203], v[108:111]
    s_waitcnt lgkmcnt(0)
    v_mfma_f32_16x16x32_bf16 v[16:19], v[124:127], v[156:159], v[16:19]
    ds_read_b128 v[204:207], v2 offset:0
    v_mfma_f32_16x16x32_bf16 v[48:51], v[124:127], v[160:163], v[48:51]
    ds_read_b128 v[208:211], v2 offset:2048
    v_mfma_f32_16x16x32_bf16 v[80:83], v[124:127], v[164:167], v[80:83]
    ds_read_b128 v[212:215], v2 offset:4096
    v_mfma_f32_16x16x32_bf16 v[20:23], v[128:131], v[156:159], v[20:23]
    ds_read_b64_tr_b16 v[172:173], v5 offset:15360
    v_mfma_f32_16x16x32_bf16 v[52:55], v[128:131], v[160:163], v[52:55]
    ds_read_b64_tr_b16 v[174:175], v5 offset:19200
    v_mfma_f32_16x16x32_bf16 v[84:87], v[128:131], v[164:167], v[84:87]
    ds_read_b64_tr_b16 v[176:177], v5 offset:15400
    v_mfma_f32_16x16x32_bf16 v[24:27], v[132:135], v[156:159], v[24:27]
    ds_read_b64_tr_b16 v[178:179], v5 offset:19240
    v_mfma_f32_16x16x32_bf16 v[56:59], v[132:135], v[160:163], v[56:59]
    ds_read_b64_tr_b16 v[180:181], v5 offset:15520
    v_mfma_f32_16x16x32_bf16 v[88:91], v[132:135], v[164:167], v[88:91]
    ds_read_b64_tr_b16 v[182:183], v5 offset:19360
    v_mfma_f32_16x16x32_bf16 v[112:115], v[132:135], v[168:171], v[112:115]
    ds_read_b128 v[216:219], v4 offset:0
    v_mfma_f32_16x16x32_bf16 v[28:31], v[136:139], v[156:159], v[28:31]
    ds_read_b64_tr_b16 v[184:185], v5 offset:15560
    v_mfma_f32_16x16x32_bf16 v[60:63], v[136:139], v[160:163], v[60:63]
    ds_read_b64_tr_b16 v[186:187], v5 offset:19400
    v_mfma_f32_16x16x32_bf16 v[92:95], v[136:139], v[164:167], v[92:95]
    ds_read_b64_tr_b16 v[188:189], v6 offset:15360
    v_mfma_f32_16x16x32_bf16 v[32:35], v[140:143], v[156:159], v[32:35]
    ds_read_b64_tr_b16 v[190:191], v6 offset:19200
    v_mfma_f32_16x16x32_bf16 v[64:67], v[140:143], v[160:163], v[64:67]
    ds_read_b64_tr_b16 v[192:193], v5 offset:15680
    v_mfma_f32_16x16x32_bf16 v[96:99], v[140:143], v[164:167], v[96:99]
    ds_read_b64_tr_b16 v[194:195], v5 offset:19520
    v_mfma_f32_16x16x32_bf16 v[116:119], v[140:143], v[168:171], v[116:119]
    ds_read_b64_tr_b16 v[196:197], v5 offset:15720
    v_mfma_f32_16x16x32_bf16 v[36:39], v[156:159], v[144:147], v[36:39]
    ds_read_b64_tr_b16 v[198:199], v5 offset:19560
    v_mfma_f32_16x16x32_bf16 v[68:71], v[160:163], v[144:147], v[68:71]
    ds_read_b64_tr_b16 v[200:201], v7 offset:15360
    v_mfma_f32_16x16x32_bf16 v[100:103], v[164:167], v[144:147], v[100:103]
    ds_read_b64_tr_b16 v[202:203], v7 offset:19200
    v_mfma_f32_16x16x32_bf16 v[120:123], v[168:171], v[144:147], v[120:123]
    v_add_u32 v1, s52, v1
    v_mfma_f32_16x16x32_bf16 v[40:43], v[156:159], v[148:151], v[40:43]
    v_add_u32 v2, s52, v2
    v_mfma_f32_16x16x32_bf16 v[72:75], v[160:163], v[148:151], v[72:75]
    v_add_u32 v3, s52, v3
    v_mfma_f32_16x16x32_bf16 v[104:107], v[164:167], v[148:151], v[104:107]
    v_add_u32 v4, s52, v4
    v_mfma_f32_16x16x32_bf16 v[44:47], v[156:159], v[152:155], v[44:47]
    v_add_u32 v5, s52, v5
    v_mfma_f32_16x16x32_bf16 v[76:79], v[160:163], v[152:155], v[76:79]
    v_add_u32 v6, s52, v6
    v_mfma_f32_16x16x32_bf16 v[108:111], v[164:167], v[152:155], v[108:111]
    v_add_u32 v7, s52, v7
    s_waitcnt lgkmcnt(0)
    s_barrier
    v_mfma_f32_16x16x32_bf16 v[16:19], v[172:175], v[204:207], v[16:19]
    ds_read_b128 v[156:159], v1 offset:0
    v_mfma_f32_16x16x32_bf16 v[48:51], v[172:175], v[208:211], v[48:51]
    ds_read_b128 v[160:163], v1 offset:2048
    v_mfma_f32_16x16x32_bf16 v[80:83], v[172:175], v[212:215], v[80:83]
    ds_read_b128 v[164:167], v1 offset:4096
    v_mfma_f32_16x16x32_bf16 v[20:23], v[176:179], v[204:207], v[20:23]
    ds_read_b64_tr_b16 v[124:125], v5 offset:0
    v_mfma_f32_16x16x32_bf16 v[52:55], v[176:179], v[208:211], v[52:55]
    ds_read_b64_tr_b16 v[126:127], v5 offset:3840
    v_mfma_f32_16x16x32_bf16 v[84:87], v[176:179], v[212:215], v[84:87]
    ds_read_b64_tr_b16 v[128:129], v5 offset:40
    v_mfma_f32_16x16x32_bf16 v[24:27], v[180:183], v[204:207], v[24:27]
    ds_read_b64_tr_b16 v[130:131], v5 offset:3880
    v_mfma_f32_16x16x32_bf16 v[56:59], v[180:183], v[208:211], v[56:59]
    ds_read_b64_tr_b16 v[132:133], v5 offset:160
    v_mfma_f32_16x16x32_bf16 v[88:91], v[180:183], v[212:215], v[88:91]
    ds_read_b64_tr_b16 v[134:135], v5 offset:4000
    v_mfma_f32_16x16x32_bf16 v[112:115], v[180:183], v[216:219], v[112:115]
    ds_read_b128 v[168:171], v3 offset:0
    v_mfma_f32_16x16x32_bf16 v[28:31], v[184:187], v[204:207], v[28:31]
    ds_read_b64_tr_b16 v[136:137], v5 offset:200
    v_mfma_f32_16x16x32_bf16 v[60:63], v[184:187], v[208:211], v[60:63]
    ds_read_b64_tr_b16 v[138:139], v5 offset:4040
    v_mfma_f32_16x16x32_bf16 v[92:95], v[184:187], v[212:215], v[92:95]
    ds_read_b64_tr_b16 v[140:141], v6 offset:0
    v_mfma_f32_16x16x32_bf16 v[32:35], v[188:191], v[204:207], v[32:35]
    ds_read_b64_tr_b16 v[142:143], v6 offset:3840
    v_mfma_f32_16x16x32_bf16 v[64:67], v[188:191], v[208:211], v[64:67]
    ds_read_b64_tr_b16 v[144:145], v5 offset:320
    v_mfma_f32_16x16x32_bf16 v[96:99], v[188:191], v[212:215], v[96:99]
    ds_read_b64_tr_b16 v[146:147], v5 offset:4160
    v_mfma_f32_16x16x32_bf16 v[116:119], v[188:191], v[216:219], v[116:119]
    ds_read_b64_tr_b16 v[148:149], v5 offset:360
    v_mfma_f32_16x16x32_bf16 v[36:39], v[204:207], v[192:195], v[36:39]
    ds_read_b64_tr_b16 v[150:151], v5 offset:4200
    v_mfma_f32_16x16x32_bf16 v[68:71], v[208:211], v[192:195], v[68:71]
    ds_read_b64_tr_b16 v[152:153], v7 offset:0
    v_mfma_f32_16x16x32_bf16 v[100:103], v[212:215], v[192:195], v[100:103]
    ds_read_b64_tr_b16 v[154:155], v7 offset:3840
    v_mfma_f32_16x16x32_bf16 v[120:123], v[216:219], v[192:195], v[120:123]
    v_mfma_f32_16x16x32_bf16 v[40:43], v[204:207], v[196:199], v[40:43]
    v_mfma_f32_16x16x32_bf16 v[72:75], v[208:211], v[196:199], v[72:75]
    v_mfma_f32_16x16x32_bf16 v[104:107], v[212:215], v[196:199], v[104:107]
    v_mfma_f32_16x16x32_bf16 v[44:47], v[204:207], v[200:203], v[44:47]
    v_mfma_f32_16x16x32_bf16 v[76:79], v[208:211], v[200:203], v[76:79]
    v_mfma_f32_16x16x32_bf16 v[108:111], v[212:215], v[200:203], v[108:111]
    s_waitcnt lgkmcnt(0)
    v_mfma_f32_16x16x32_bf16 v[16:19], v[124:127], v[156:159], v[16:19]
    ds_read_b128 v[204:207], v2 offset:0
    v_mfma_f32_16x16x32_bf16 v[48:51], v[124:127], v[160:163], v[48:51]
    ds_read_b128 v[208:211], v2 offset:2048
    v_mfma_f32_16x16x32_bf16 v[80:83], v[124:127], v[164:167], v[80:83]
    ds_read_b128 v[212:215], v2 offset:4096
    v_mfma_f32_16x16x32_bf16 v[20:23], v[128:131], v[156:159], v[20:23]
    ds_read_b64_tr_b16 v[172:173], v5 offset:15360
    v_mfma_f32_16x16x32_bf16 v[52:55], v[128:131], v[160:163], v[52:55]
    ds_read_b64_tr_b16 v[174:175], v5 offset:19200
    v_mfma_f32_16x16x32_bf16 v[84:87], v[128:131], v[164:167], v[84:87]
    ds_read_b64_tr_b16 v[176:177], v5 offset:15400
    v_mfma_f32_16x16x32_bf16 v[24:27], v[132:135], v[156:159], v[24:27]
    ds_read_b64_tr_b16 v[178:179], v5 offset:19240
    v_mfma_f32_16x16x32_bf16 v[56:59], v[132:135], v[160:163], v[56:59]
    ds_read_b64_tr_b16 v[180:181], v5 offset:15520
    v_mfma_f32_16x16x32_bf16 v[88:91], v[132:135], v[164:167], v[88:91]
    ds_read_b64_tr_b16 v[182:183], v5 offset:19360
    v_mfma_f32_16x16x32_bf16 v[112:115], v[132:135], v[168:171], v[112:115]
    ds_read_b128 v[216:219], v4 offset:0
    v_mfma_f32_16x16x32_bf16 v[28:31], v[136:139], v[156:159], v[28:31]
    ds_read_b64_tr_b16 v[184:185], v5 offset:15560
    v_mfma_f32_16x16x32_bf16 v[60:63], v[136:139], v[160:163], v[60:63]
    ds_read_b64_tr_b16 v[186:187], v5 offset:19400
    v_mfma_f32_16x16x32_bf16 v[92:95], v[136:139], v[164:167], v[92:95]
    ds_read_b64_tr_b16 v[188:189], v6 offset:15360
    v_mfma_f32_16x16x32_bf16 v[32:35], v[140:143], v[156:159], v[32:35]
    ds_read_b64_tr_b16 v[190:191], v6 offset:19200
    v_mfma_f32_16x16x32_bf16 v[64:67], v[140:143], v[160:163], v[64:67]
    ds_read_b64_tr_b16 v[192:193], v5 offset:15680
    v_mfma_f32_16x16x32_bf16 v[96:99], v[140:143], v[164:167], v[96:99]
    ds_read_b64_tr_b16 v[194:195], v5 offset:19520
    v_mfma_f32_16x16x32_bf16 v[116:119], v[140:143], v[168:171], v[116:119]
    ds_read_b64_tr_b16 v[196:197], v5 offset:15720
    v_mfma_f32_16x16x32_bf16 v[36:39], v[156:159], v[144:147], v[36:39]
    ds_read_b64_tr_b16 v[198:199], v5 offset:19560
    v_mfma_f32_16x16x32_bf16 v[68:71], v[160:163], v[144:147], v[68:71]
    ds_read_b64_tr_b16 v[200:201], v7 offset:15360
    v_mfma_f32_16x16x32_bf16 v[100:103], v[164:167], v[144:147], v[100:103]
    ds_read_b64_tr_b16 v[202:203], v7 offset:19200
    v_mfma_f32_16x16x32_bf16 v[120:123], v[168:171], v[144:147], v[120:123]
    v_add_u32 v1, s53, v1
    v_mfma_f32_16x16x32_bf16 v[40:43], v[156:159], v[148:151], v[40:43]
    v_add_u32 v2, s53, v2
    v_mfma_f32_16x16x32_bf16 v[72:75], v[160:163], v[148:151], v[72:75]
    v_add_u32 v3, s53, v3
    v_mfma_f32_16x16x32_bf16 v[104:107], v[164:167], v[148:151], v[104:107]
    v_add_u32 v4, s53, v4
    v_mfma_f32_16x16x32_bf16 v[44:47], v[156:159], v[152:155], v[44:47]
    v_add_u32 v5, s53, v5
    v_mfma_f32_16x16x32_bf16 v[76:79], v[160:163], v[152:155], v[76:79]
    v_add_u32 v6, s53, v6
    v_mfma_f32_16x16x32_bf16 v[108:111], v[164:167], v[152:155], v[108:111]
    v_add_u32 v7, s53, v7
    s_waitcnt lgkmcnt(0)
    s_barrier
    v_mfma_f32_16x16x32_bf16 v[16:19], v[172:175], v[204:207], v[16:19]
    ds_read_b128 v[156:159], v1 offset:0
    v_mfma_f32_16x16x32_bf16 v[48:51], v[172:175], v[208:211], v[48:51]
    ds_read_b128 v[160:163], v1 offset:2048
    v_mfma_f32_16x16x32_bf16 v[80:83], v[172:175], v[212:215], v[80:83]
    ds_read_b128 v[164:167], v1 offset:4096
    v_mfma_f32_16x16x32_bf16 v[20:23], v[176:179], v[204:207], v[20:23]
    ds_read_b64_tr_b16 v[124:125], v5 offset:0
    v_mfma_f32_16x16x32_bf16 v[52:55], v[176:179], v[208:211], v[52:55]
    ds_read_b64_tr_b16 v[126:127], v5 offset:3840
    v_mfma_f32_16x16x32_bf16 v[84:87], v[176:179], v[212:215], v[84:87]
    ds_read_b64_tr_b16 v[128:129], v5 offset:40
    v_mfma_f32_16x16x32_bf16 v[24:27], v[180:183], v[204:207], v[24:27]
    ds_read_b64_tr_b16 v[130:131], v5 offset:3880
    v_mfma_f32_16x16x32_bf16 v[56:59], v[180:183], v[208:211], v[56:59]
    ds_read_b64_tr_b16 v[132:133], v5 offset:160
    v_mfma_f32_16x16x32_bf16 v[88:91], v[180:183], v[212:215], v[88:91]
    ds_read_b64_tr_b16 v[134:135], v5 offset:4000
    v_mfma_f32_16x16x32_bf16 v[112:115], v[180:183], v[216:219], v[112:115]
    ds_read_b128 v[168:171], v3 offset:0
    v_mfma_f32_16x16x32_bf16 v[28:31], v[184:187], v[204:207], v[28:31]
    ds_read_b64_tr_b16 v[136:137], v5 offset:200
    v_mfma_f32_16x16x32_bf16 v[60:63], v[184:187], v[208:211], v[60:63]
    ds_read_b64_tr_b16 v[138:139], v5 offset:4040
    v_mfma_f32_16x16x32_bf16 v[92:95], v[184:187], v[212:215], v[92:95]
    ds_read_b64_tr_b16 v[140:141], v6 offset:0
    v_mfma_f32_16x16x32_bf16 v[32:35], v[188:191], v[204:207], v[32:35]
    ds_read_b64_tr_b16 v[142:143], v6 offset:3840
    v_mfma_f32_16x16x32_bf16 v[64:67], v[188:191], v[208:211], v[64:67]
    ds_read_b64_tr_b16 v[144:145], v5 offset:320
    v_mfma_f32_16x16x32_bf16 v[96:99], v[188:191], v[212:215], v[96:99]
    ds_read_b64_tr_b16 v[146:147], v5 offset:4160
    v_mfma_f32_16x16x32_bf16 v[116:119], v[188:191], v[216:219], v[116:119]
    ds_read_b64_tr_b16 v[148:149], v5 offset:360
    v_mfma_f32_16x16x32_bf16 v[36:39], v[204:207], v[192:195], v[36:39]
    ds_read_b64_tr_b16 v[150:151], v5 offset:4200
    v_mfma_f32_16x16x32_bf16 v[68:71], v[208:211], v[192:195], v[68:71]
    ds_read_b64_tr_b16 v[152:153], v7 offset:0
    v_mfma_f32_16x16x32_bf16 v[100:103], v[212:215], v[192:195], v[100:103]
    ds_read_b64_tr_b16 v[154:155], v7 offset:3840
    v_mfma_f32_16x16x32_bf16 v[120:123], v[216:219], v[192:195], v[120:123]
    v_mfma_f32_16x16x32_bf16 v[40:43], v[204:207], v[196:199], v[40:43]
    v_mfma_f32_16x16x32_bf16 v[72:75], v[208:211], v[196:199], v[72:75]
    v_mfma_f32_16x16x32_bf16 v[104:107], v[212:215], v[196:199], v[104:107]
    v_mfma_f32_16x16x32_bf16 v[44:47], v[204:207], v[200:203], v[44:47]
    v_mfma_f32_16x16x32_bf16 v[76:79], v[208:211], v[200:203], v[76:79]
    v_mfma_f32_16x16x32_bf16 v[108:111], v[212:215], v[200:203], v[108:111]
    s_waitcnt lgkmcnt(0)
    v_mfma_f32_16x16x32_bf16 v[16:19], v[124:127], v[156:159], v[16:19]
    ds_read_b128 v[204:207], v2 offset:0
    v_mfma_f32_16x16x32_bf16 v[48:51], v[124:127], v[160:163], v[48:51]
    ds_read_b128 v[208:211], v2 offset:2048
    v_mfma_f32_16x16x32_bf16 v[80:83], v[124:127], v[164:167], v[80:83]
    ds_read_b128 v[212:215], v2 offset:4096
    v_mfma_f32_16x16x32_bf16 v[20:23], v[128:131], v[156:159], v[20:23]
    ds_read_b64_tr_b16 v[172:173], v5 offset:15360
    v_mfma_f32_16x16x32_bf16 v[52:55], v[128:131], v[160:163], v[52:55]
    ds_read_b64_tr_b16 v[174:175], v5 offset:19200
    v_mfma_f32_16x16x32_bf16 v[84:87], v[128:131], v[164:167], v[84:87]
    ds_read_b64_tr_b16 v[176:177], v5 offset:15400
    v_mfma_f32_16x16x32_bf16 v[24:27], v[132:135], v[156:159], v[24:27]
    ds_read_b64_tr_b16 v[178:179], v5 offset:19240
    v_mfma_f32_16x16x32_bf16 v[56:59], v[132:135], v[160:163], v[56:59]
    ds_read_b64_tr_b16 v[180:181], v5 offset:15520
    v_mfma_f32_16x16x32_bf16 v[88:91], v[132:135], v[164:167], v[88:91]
    ds_read_b64_tr_b16 v[182:183], v5 offset:19360
    v_mfma_f32_16x16x32_bf16 v[112:115], v[132:135], v[168:171], v[112:115]
    ds_read_b128 v[216:219], v4 offset:0
    v_mfma_f32_16x16x32_bf16 v[28:31], v[136:139], v[156:159], v[28:31]
    ds_read_b64_tr_b16 v[184:185], v5 offset:15560
    v_mfma_f32_16x16x32_bf16 v[60:63], v[136:139], v[160:163], v[60:63]
    ds_read_b64_tr_b16 v[186:187], v5 offset:19400
    v_mfma_f32_16x16x32_bf16 v[92:95], v[136:139], v[164:167], v[92:95]
    ds_read_b64_tr_b16 v[188:189], v6 offset:15360
    v_mfma_f32_16x16x32_bf16 v[32:35], v[140:143], v[156:159], v[32:35]
    ds_read_b64_tr_b16 v[190:191], v6 offset:19200
    v_mfma_f32_16x16x32_bf16 v[64:67], v[140:143], v[160:163], v[64:67]
    ds_read_b64_tr_b16 v[192:193], v5 offset:15680
    v_mfma_f32_16x16x32_bf16 v[96:99], v[140:143], v[164:167], v[96:99]
    ds_read_b64_tr_b16 v[194:195], v5 offset:19520
    v_mfma_f32_16x16x32_bf16 v[116:119], v[140:143], v[168:171], v[116:119]
    ds_read_b64_tr_b16 v[196:197], v5 offset:15720
    v_mfma_f32_16x16x32_bf16 v[36:39], v[156:159], v[144:147], v[36:39]
    ds_read_b64_tr_b16 v[198:199], v5 offset:19560
    v_mfma_f32_16x16x32_bf16 v[68:71], v[160:163], v[144:147], v[68:71]
    ds_read_b64_tr_b16 v[200:201], v7 offset:15360
    v_mfma_f32_16x16x32_bf16 v[100:103], v[164:167], v[144:147], v[100:103]
    ds_read_b64_tr_b16 v[202:203], v7 offset:19200
    v_mfma_f32_16x16x32_bf16 v[120:123], v[168:171], v[144:147], v[120:123]
    v_add_u32 v1, s52, v1
    v_mfma_f32_16x16x32_bf16 v[40:43], v[156:159], v[148:151], v[40:43]
    v_add_u32 v2, s52, v2
    v_mfma_f32_16x16x32_bf16 v[72:75], v[160:163], v[148:151], v[72:75]
    v_add_u32 v3, s52, v3
    v_mfma_f32_16x16x32_bf16 v[104:107], v[164:167], v[148:151], v[104:107]
    v_add_u32 v4, s52, v4
    v_mfma_f32_16x16x32_bf16 v[44:47], v[156:159], v[152:155], v[44:47]
    v_add_u32 v5, s52, v5
    v_mfma_f32_16x16x32_bf16 v[76:79], v[160:163], v[152:155], v[76:79]
    v_add_u32 v6, s52, v6
    v_mfma_f32_16x16x32_bf16 v[108:111], v[164:167], v[152:155], v[108:111]
    v_add_u32 v7, s52, v7
    s_waitcnt lgkmcnt(0)
    s_barrier
    v_mfma_f32_16x16x32_bf16 v[16:19], v[172:175], v[204:207], v[16:19]
    ds_read_b128 v[156:159], v1 offset:0
    v_mfma_f32_16x16x32_bf16 v[48:51], v[172:175], v[208:211], v[48:51]
    ds_read_b128 v[160:163], v1 offset:2048
    v_mfma_f32_16x16x32_bf16 v[80:83], v[172:175], v[212:215], v[80:83]
    ds_read_b128 v[164:167], v1 offset:4096
    v_mfma_f32_16x16x32_bf16 v[20:23], v[176:179], v[204:207], v[20:23]
    ds_read_b64_tr_b16 v[124:125], v5 offset:0
    v_mfma_f32_16x16x32_bf16 v[52:55], v[176:179], v[208:211], v[52:55]
    ds_read_b64_tr_b16 v[126:127], v5 offset:3840
    v_mfma_f32_16x16x32_bf16 v[84:87], v[176:179], v[212:215], v[84:87]
    ds_read_b64_tr_b16 v[128:129], v5 offset:40
    v_mfma_f32_16x16x32_bf16 v[24:27], v[180:183], v[204:207], v[24:27]
    ds_read_b64_tr_b16 v[130:131], v5 offset:3880
    v_mfma_f32_16x16x32_bf16 v[56:59], v[180:183], v[208:211], v[56:59]
    ds_read_b64_tr_b16 v[132:133], v5 offset:160
    v_mfma_f32_16x16x32_bf16 v[88:91], v[180:183], v[212:215], v[88:91]
    ds_read_b64_tr_b16 v[134:135], v5 offset:4000
    v_mfma_f32_16x16x32_bf16 v[112:115], v[180:183], v[216:219], v[112:115]
    ds_read_b128 v[168:171], v3 offset:0
    v_mfma_f32_16x16x32_bf16 v[28:31], v[184:187], v[204:207], v[28:31]
    ds_read_b64_tr_b16 v[136:137], v5 offset:200
    v_mfma_f32_16x16x32_bf16 v[60:63], v[184:187], v[208:211], v[60:63]
    ds_read_b64_tr_b16 v[138:139], v5 offset:4040
    v_mfma_f32_16x16x32_bf16 v[92:95], v[184:187], v[212:215], v[92:95]
    ds_read_b64_tr_b16 v[140:141], v6 offset:0
    v_mfma_f32_16x16x32_bf16 v[32:35], v[188:191], v[204:207], v[32:35]
    ds_read_b64_tr_b16 v[142:143], v6 offset:3840
    v_mfma_f32_16x16x32_bf16 v[64:67], v[188:191], v[208:211], v[64:67]
    ds_read_b64_tr_b16 v[144:145], v5 offset:320
    v_mfma_f32_16x16x32_bf16 v[96:99], v[188:191], v[212:215], v[96:99]
    ds_read_b64_tr_b16 v[146:147], v5 offset:4160
    v_mfma_f32_16x16x32_bf16 v[116:119], v[188:191], v[216:219], v[116:119]
    ds_read_b64_tr_b16 v[148:149], v5 offset:360
    v_mfma_f32_16x16x32_bf16 v[36:39], v[204:207], v[192:195], v[36:39]
    ds_read_b64_tr_b16 v[150:151], v5 offset:4200
    v_mfma_f32_16x16x32_bf16 v[68:71], v[208:211], v[192:195], v[68:71]
    ds_read_b64_tr_b16 v[152:153], v7 offset:0
    v_mfma_f32_16x16x32_bf16 v[100:103], v[212:215], v[192:195], v[100:103]
    ds_read_b64_tr_b16 v[154:155], v7 offset:3840
    v_mfma_f32_16x16x32_bf16 v[120:123], v[216:219], v[192:195], v[120:123]
    v_mfma_f32_16x16x32_bf16 v[40:43], v[204:207], v[196:199], v[40:43]
    v_mfma_f32_16x16x32_bf16 v[72:75], v[208:211], v[196:199], v[72:75]
    v_mfma_f32_16x16x32_bf16 v[104:107], v[212:215], v[196:199], v[104:107]
    v_mfma_f32_16x16x32_bf16 v[44:47], v[204:207], v[200:203], v[44:47]
    v_mfma_f32_16x16x32_bf16 v[76:79], v[208:211], v[200:203], v[76:79]
    v_mfma_f32_16x16x32_bf16 v[108:111], v[212:215], v[200:203], v[108:111]
    s_waitcnt lgkmcnt(0)
    v_mfma_f32_16x16x32_bf16 v[16:19], v[124:127], v[156:159], v[16:19]
    ds_read_b128 v[204:207], v2 offset:0
    v_mfma_f32_16x16x32_bf16 v[48:51], v[124:127], v[160:163], v[48:51]
    ds_read_b128 v[208:211], v2 offset:2048
    v_mfma_f32_16x16x32_bf16 v[80:83], v[124:127], v[164:167], v[80:83]
    ds_read_b128 v[212:215], v2 offset:4096
    v_mfma_f32_16x16x32_bf16 v[20:23], v[128:131], v[156:159], v[20:23]
    ds_read_b64_tr_b16 v[172:173], v5 offset:15360
    v_mfma_f32_16x16x32_bf16 v[52:55], v[128:131], v[160:163], v[52:55]
    ds_read_b64_tr_b16 v[174:175], v5 offset:19200
    v_mfma_f32_16x16x32_bf16 v[84:87], v[128:131], v[164:167], v[84:87]
    ds_read_b64_tr_b16 v[176:177], v5 offset:15400
    v_mfma_f32_16x16x32_bf16 v[24:27], v[132:135], v[156:159], v[24:27]
    ds_read_b64_tr_b16 v[178:179], v5 offset:19240
    v_mfma_f32_16x16x32_bf16 v[56:59], v[132:135], v[160:163], v[56:59]
    ds_read_b64_tr_b16 v[180:181], v5 offset:15520
    v_mfma_f32_16x16x32_bf16 v[88:91], v[132:135], v[164:167], v[88:91]
    ds_read_b64_tr_b16 v[182:183], v5 offset:19360
    v_mfma_f32_16x16x32_bf16 v[112:115], v[132:135], v[168:171], v[112:115]
    ds_read_b128 v[216:219], v4 offset:0
    v_mfma_f32_16x16x32_bf16 v[28:31], v[136:139], v[156:159], v[28:31]
    ds_read_b64_tr_b16 v[184:185], v5 offset:15560
    v_mfma_f32_16x16x32_bf16 v[60:63], v[136:139], v[160:163], v[60:63]
    ds_read_b64_tr_b16 v[186:187], v5 offset:19400
    v_mfma_f32_16x16x32_bf16 v[92:95], v[136:139], v[164:167], v[92:95]
    ds_read_b64_tr_b16 v[188:189], v6 offset:15360
    v_mfma_f32_16x16x32_bf16 v[32:35], v[140:143], v[156:159], v[32:35]
    ds_read_b64_tr_b16 v[190:191], v6 offset:19200
    v_mfma_f32_16x16x32_bf16 v[64:67], v[140:143], v[160:163], v[64:67]
    ds_read_b64_tr_b16 v[192:193], v5 offset:15680
    v_mfma_f32_16x16x32_bf16 v[96:99], v[140:143], v[164:167], v[96:99]
    ds_read_b64_tr_b16 v[194:195], v5 offset:19520
    v_mfma_f32_16x16x32_bf16 v[116:119], v[140:143], v[168:171], v[116:119]
    ds_read_b64_tr_b16 v[196:197], v5 offset:15720
    v_mfma_f32_16x16x32_bf16 v[36:39], v[156:159], v[144:147], v[36:39]
    ds_read_b64_tr_b16 v[198:199], v5 offset:19560
    v_mfma_f32_16x16x32_bf16 v[68:71], v[160:163], v[144:147], v[68:71]
    ds_read_b64_tr_b16 v[200:201], v7 offset:15360
    v_mfma_f32_16x16x32_bf16 v[100:103], v[164:167], v[144:147], v[100:103]
    ds_read_b64_tr_b16 v[202:203], v7 offset:19200
    v_mfma_f32_16x16x32_bf16 v[120:123], v[168:171], v[144:147], v[120:123]
    v_add_u32 v1, s52, v1
    v_mfma_f32_16x16x32_bf16 v[40:43], v[156:159], v[148:151], v[40:43]
    v_add_u32 v2, s52, v2
    v_mfma_f32_16x16x32_bf16 v[72:75], v[160:163], v[148:151], v[72:75]
    v_add_u32 v3, s52, v3
    v_mfma_f32_16x16x32_bf16 v[104:107], v[164:167], v[148:151], v[104:107]
    v_add_u32 v4, s52, v4
    v_mfma_f32_16x16x32_bf16 v[44:47], v[156:159], v[152:155], v[44:47]
    v_add_u32 v5, s52, v5
    v_mfma_f32_16x16x32_bf16 v[76:79], v[160:163], v[152:155], v[76:79]
    v_add_u32 v6, s52, v6
    v_mfma_f32_16x16x32_bf16 v[108:111], v[164:167], v[152:155], v[108:111]
    v_add_u32 v7, s52, v7
    s_waitcnt lgkmcnt(0)
    s_barrier
    v_mfma_f32_16x16x32_bf16 v[16:19], v[172:175], v[204:207], v[16:19]
    ds_read_b128 v[156:159], v1 offset:0
    v_mfma_f32_16x16x32_bf16 v[48:51], v[172:175], v[208:211], v[48:51]
    ds_read_b128 v[160:163], v1 offset:2048
    v_mfma_f32_16x16x32_bf16 v[80:83], v[172:175], v[212:215], v[80:83]
    ds_read_b128 v[164:167], v1 offset:4096
    v_mfma_f32_16x16x32_bf16 v[20:23], v[176:179], v[204:207], v[20:23]
    ds_read_b64_tr_b16 v[124:125], v5 offset:0
    v_mfma_f32_16x16x32_bf16 v[52:55], v[176:179], v[208:211], v[52:55]
    ds_read_b64_tr_b16 v[126:127], v5 offset:3840
    v_mfma_f32_16x16x32_bf16 v[84:87], v[176:179], v[212:215], v[84:87]
    ds_read_b64_tr_b16 v[128:129], v5 offset:40
    v_mfma_f32_16x16x32_bf16 v[24:27], v[180:183], v[204:207], v[24:27]
    ds_read_b64_tr_b16 v[130:131], v5 offset:3880
    v_mfma_f32_16x16x32_bf16 v[56:59], v[180:183], v[208:211], v[56:59]
    ds_read_b64_tr_b16 v[132:133], v5 offset:160
    v_mfma_f32_16x16x32_bf16 v[88:91], v[180:183], v[212:215], v[88:91]
    ds_read_b64_tr_b16 v[134:135], v5 offset:4000
    v_mfma_f32_16x16x32_bf16 v[112:115], v[180:183], v[216:219], v[112:115]
    ds_read_b128 v[168:171], v3 offset:0
    v_mfma_f32_16x16x32_bf16 v[28:31], v[184:187], v[204:207], v[28:31]
    ds_read_b64_tr_b16 v[136:137], v5 offset:200
    v_mfma_f32_16x16x32_bf16 v[60:63], v[184:187], v[208:211], v[60:63]
    ds_read_b64_tr_b16 v[138:139], v5 offset:4040
    v_mfma_f32_16x16x32_bf16 v[92:95], v[184:187], v[212:215], v[92:95]
    ds_read_b64_tr_b16 v[140:141], v6 offset:0
    v_mfma_f32_16x16x32_bf16 v[32:35], v[188:191], v[204:207], v[32:35]
    ds_read_b64_tr_b16 v[142:143], v6 offset:3840
    v_mfma_f32_16x16x32_bf16 v[64:67], v[188:191], v[208:211], v[64:67]
    ds_read_b64_tr_b16 v[144:145], v5 offset:320
    v_mfma_f32_16x16x32_bf16 v[96:99], v[188:191], v[212:215], v[96:99]
    ds_read_b64_tr_b16 v[146:147], v5 offset:4160
    v_mfma_f32_16x16x32_bf16 v[116:119], v[188:191], v[216:219], v[116:119]
    ds_read_b64_tr_b16 v[148:149], v5 offset:360
    v_mfma_f32_16x16x32_bf16 v[36:39], v[204:207], v[192:195], v[36:39]
    ds_read_b64_tr_b16 v[150:151], v5 offset:4200
    v_mfma_f32_16x16x32_bf16 v[68:71], v[208:211], v[192:195], v[68:71]
    ds_read_b64_tr_b16 v[152:153], v7 offset:0
    v_mfma_f32_16x16x32_bf16 v[100:103], v[212:215], v[192:195], v[100:103]
    ds_read_b64_tr_b16 v[154:155], v7 offset:3840
    v_mfma_f32_16x16x32_bf16 v[120:123], v[216:219], v[192:195], v[120:123]
    v_mfma_f32_16x16x32_bf16 v[40:43], v[204:207], v[196:199], v[40:43]
    v_mfma_f32_16x16x32_bf16 v[72:75], v[208:211], v[196:199], v[72:75]
    v_mfma_f32_16x16x32_bf16 v[104:107], v[212:215], v[196:199], v[104:107]
    v_mfma_f32_16x16x32_bf16 v[44:47], v[204:207], v[200:203], v[44:47]
    v_mfma_f32_16x16x32_bf16 v[76:79], v[208:211], v[200:203], v[76:79]
    v_mfma_f32_16x16x32_bf16 v[108:111], v[212:215], v[200:203], v[108:111]
    s_waitcnt lgkmcnt(0)
    v_mfma_f32_16x16x32_bf16 v[16:19], v[124:127], v[156:159], v[16:19]
    ds_read_b128 v[204:207], v2 offset:0
    v_mfma_f32_16x16x32_bf16 v[48:51], v[124:127], v[160:163], v[48:51]
    ds_read_b128 v[208:211], v2 offset:2048
    v_mfma_f32_16x16x32_bf16 v[80:83], v[124:127], v[164:167], v[80:83]
    ds_read_b128 v[212:215], v2 offset:4096
    v_mfma_f32_16x16x32_bf16 v[20:23], v[128:131], v[156:159], v[20:23]
    ds_read_b64_tr_b16 v[172:173], v5 offset:15360
    v_mfma_f32_16x16x32_bf16 v[52:55], v[128:131], v[160:163], v[52:55]
    ds_read_b64_tr_b16 v[174:175], v5 offset:19200
    v_mfma_f32_16x16x32_bf16 v[84:87], v[128:131], v[164:167], v[84:87]
    ds_read_b64_tr_b16 v[176:177], v5 offset:15400
    v_mfma_f32_16x16x32_bf16 v[24:27], v[132:135], v[156:159], v[24:27]
    ds_read_b64_tr_b16 v[178:179], v5 offset:19240
    v_mfma_f32_16x16x32_bf16 v[56:59], v[132:135], v[160:163], v[56:59]
    ds_read_b64_tr_b16 v[180:181], v5 offset:15520
    v_mfma_f32_16x16x32_bf16 v[88:91], v[132:135], v[164:167], v[88:91]
    ds_read_b64_tr_b16 v[182:183], v5 offset:19360
    v_mfma_f32_16x16x32_bf16 v[112:115], v[132:135], v[168:171], v[112:115]
    ds_read_b128 v[216:219], v4 offset:0
    v_mfma_f32_16x16x32_bf16 v[28:31], v[136:139], v[156:159], v[28:31]
    ds_read_b64_tr_b16 v[184:185], v5 offset:15560
    v_mfma_f32_16x16x32_bf16 v[60:63], v[136:139], v[160:163], v[60:63]
    ds_read_b64_tr_b16 v[186:187], v5 offset:19400
    v_mfma_f32_16x16x32_bf16 v[92:95], v[136:139], v[164:167], v[92:95]
    ds_read_b64_tr_b16 v[188:189], v6 offset:15360
    v_mfma_f32_16x16x32_bf16 v[32:35], v[140:143], v[156:159], v[32:35]
    ds_read_b64_tr_b16 v[190:191], v6 offset:19200
    v_mfma_f32_16x16x32_bf16 v[64:67], v[140:143], v[160:163], v[64:67]
    ds_read_b64_tr_b16 v[192:193], v5 offset:15680
    v_mfma_f32_16x16x32_bf16 v[96:99], v[140:143], v[164:167], v[96:99]
    ds_read_b64_tr_b16 v[194:195], v5 offset:19520
    v_mfma_f32_16x16x32_bf16 v[116:119], v[140:143], v[168:171], v[116:119]
    ds_read_b64_tr_b16 v[196:197], v5 offset:15720
    v_mfma_f32_16x16x32_bf16 v[36:39], v[156:159], v[144:147], v[36:39]
    ds_read_b64_tr_b16 v[198:199], v5 offset:19560
    v_mfma_f32_16x16x32_bf16 v[68:71], v[160:163], v[144:147], v[68:71]
    ds_read_b64_tr_b16 v[200:201], v7 offset:15360
    v_mfma_f32_16x16x32_bf16 v[100:103], v[164:167], v[144:147], v[100:103]
    ds_read_b64_tr_b16 v[202:203], v7 offset:19200
    v_mfma_f32_16x16x32_bf16 v[120:123], v[168:171], v[144:147], v[120:123]
    v_add_u32 v1, s53, v1
    v_mfma_f32_16x16x32_bf16 v[40:43], v[156:159], v[148:151], v[40:43]
    v_add_u32 v2, s53, v2
    v_mfma_f32_16x16x32_bf16 v[72:75], v[160:163], v[148:151], v[72:75]
    v_add_u32 v3, s53, v3
    v_mfma_f32_16x16x32_bf16 v[104:107], v[164:167], v[148:151], v[104:107]
    v_add_u32 v4, s53, v4
    v_mfma_f32_16x16x32_bf16 v[44:47], v[156:159], v[152:155], v[44:47]
    v_add_u32 v5, s53, v5
    v_mfma_f32_16x16x32_bf16 v[76:79], v[160:163], v[152:155], v[76:79]
    v_add_u32 v6, s53, v6
    v_mfma_f32_16x16x32_bf16 v[108:111], v[164:167], v[152:155], v[108:111]
    v_add_u32 v7, s53, v7
    s_waitcnt lgkmcnt(0)
    s_barrier
    v_mfma_f32_16x16x32_bf16 v[16:19], v[172:175], v[204:207], v[16:19]
    ds_read_b128 v[156:159], v1 offset:0
    v_mfma_f32_16x16x32_bf16 v[48:51], v[172:175], v[208:211], v[48:51]
    ds_read_b128 v[160:163], v1 offset:2048
    v_mfma_f32_16x16x32_bf16 v[80:83], v[172:175], v[212:215], v[80:83]
    ds_read_b128 v[164:167], v1 offset:4096
    v_mfma_f32_16x16x32_bf16 v[20:23], v[176:179], v[204:207], v[20:23]
    ds_read_b64_tr_b16 v[124:125], v5 offset:0
    v_mfma_f32_16x16x32_bf16 v[52:55], v[176:179], v[208:211], v[52:55]
    ds_read_b64_tr_b16 v[126:127], v5 offset:3840
    v_mfma_f32_16x16x32_bf16 v[84:87], v[176:179], v[212:215], v[84:87]
    ds_read_b64_tr_b16 v[128:129], v5 offset:40
    v_mfma_f32_16x16x32_bf16 v[24:27], v[180:183], v[204:207], v[24:27]
    ds_read_b64_tr_b16 v[130:131], v5 offset:3880
    v_mfma_f32_16x16x32_bf16 v[56:59], v[180:183], v[208:211], v[56:59]
    ds_read_b64_tr_b16 v[132:133], v5 offset:160
    v_mfma_f32_16x16x32_bf16 v[88:91], v[180:183], v[212:215], v[88:91]
    ds_read_b64_tr_b16 v[134:135], v5 offset:4000
    v_mfma_f32_16x16x32_bf16 v[112:115], v[180:183], v[216:219], v[112:115]
    ds_read_b128 v[168:171], v3 offset:0
    v_mfma_f32_16x16x32_bf16 v[28:31], v[184:187], v[204:207], v[28:31]
    ds_read_b64_tr_b16 v[136:137], v5 offset:200
    v_mfma_f32_16x16x32_bf16 v[60:63], v[184:187], v[208:211], v[60:63]
    ds_read_b64_tr_b16 v[138:139], v5 offset:4040
    v_mfma_f32_16x16x32_bf16 v[92:95], v[184:187], v[212:215], v[92:95]
    ds_read_b64_tr_b16 v[140:141], v6 offset:0
    v_mfma_f32_16x16x32_bf16 v[32:35], v[188:191], v[204:207], v[32:35]
    ds_read_b64_tr_b16 v[142:143], v6 offset:3840
    v_mfma_f32_16x16x32_bf16 v[64:67], v[188:191], v[208:211], v[64:67]
    ds_read_b64_tr_b16 v[144:145], v5 offset:320
    v_mfma_f32_16x16x32_bf16 v[96:99], v[188:191], v[212:215], v[96:99]
    ds_read_b64_tr_b16 v[146:147], v5 offset:4160
    v_mfma_f32_16x16x32_bf16 v[116:119], v[188:191], v[216:219], v[116:119]
    ds_read_b64_tr_b16 v[148:149], v5 offset:360
    v_mfma_f32_16x16x32_bf16 v[36:39], v[204:207], v[192:195], v[36:39]
    ds_read_b64_tr_b16 v[150:151], v5 offset:4200
    v_mfma_f32_16x16x32_bf16 v[68:71], v[208:211], v[192:195], v[68:71]
    ds_read_b64_tr_b16 v[152:153], v7 offset:0
    v_mfma_f32_16x16x32_bf16 v[100:103], v[212:215], v[192:195], v[100:103]
    ds_read_b64_tr_b16 v[154:155], v7 offset:3840
    v_mfma_f32_16x16x32_bf16 v[120:123], v[216:219], v[192:195], v[120:123]
    v_mfma_f32_16x16x32_bf16 v[40:43], v[204:207], v[196:199], v[40:43]
    v_mfma_f32_16x16x32_bf16 v[72:75], v[208:211], v[196:199], v[72:75]
    v_mfma_f32_16x16x32_bf16 v[104:107], v[212:215], v[196:199], v[104:107]
    v_mfma_f32_16x16x32_bf16 v[44:47], v[204:207], v[200:203], v[44:47]
    v_mfma_f32_16x16x32_bf16 v[76:79], v[208:211], v[200:203], v[76:79]
    v_mfma_f32_16x16x32_bf16 v[108:111], v[212:215], v[200:203], v[108:111]
    s_waitcnt lgkmcnt(0)
    v_mfma_f32_16x16x32_bf16 v[16:19], v[124:127], v[156:159], v[16:19]
    ds_read_b128 v[204:207], v2 offset:0
    v_mfma_f32_16x16x32_bf16 v[48:51], v[124:127], v[160:163], v[48:51]
    ds_read_b128 v[208:211], v2 offset:2048
    v_mfma_f32_16x16x32_bf16 v[80:83], v[124:127], v[164:167], v[80:83]
    ds_read_b128 v[212:215], v2 offset:4096
    v_mfma_f32_16x16x32_bf16 v[20:23], v[128:131], v[156:159], v[20:23]
    ds_read_b64_tr_b16 v[172:173], v5 offset:15360
    v_mfma_f32_16x16x32_bf16 v[52:55], v[128:131], v[160:163], v[52:55]
    ds_read_b64_tr_b16 v[174:175], v5 offset:19200
    v_mfma_f32_16x16x32_bf16 v[84:87], v[128:131], v[164:167], v[84:87]
    ds_read_b64_tr_b16 v[176:177], v5 offset:15400
    v_mfma_f32_16x16x32_bf16 v[24:27], v[132:135], v[156:159], v[24:27]
    ds_read_b64_tr_b16 v[178:179], v5 offset:19240
    v_mfma_f32_16x16x32_bf16 v[56:59], v[132:135], v[160:163], v[56:59]
    ds_read_b64_tr_b16 v[180:181], v5 offset:15520
    v_mfma_f32_16x16x32_bf16 v[88:91], v[132:135], v[164:167], v[88:91]
    ds_read_b64_tr_b16 v[182:183], v5 offset:19360
    v_mfma_f32_16x16x32_bf16 v[112:115], v[132:135], v[168:171], v[112:115]
    ds_read_b128 v[216:219], v4 offset:0
    v_mfma_f32_16x16x32_bf16 v[28:31], v[136:139], v[156:159], v[28:31]
    ds_read_b64_tr_b16 v[184:185], v5 offset:15560
    v_mfma_f32_16x16x32_bf16 v[60:63], v[136:139], v[160:163], v[60:63]
    ds_read_b64_tr_b16 v[186:187], v5 offset:19400
    v_mfma_f32_16x16x32_bf16 v[92:95], v[136:139], v[164:167], v[92:95]
    ds_read_b64_tr_b16 v[188:189], v6 offset:15360
    v_mfma_f32_16x16x32_bf16 v[32:35], v[140:143], v[156:159], v[32:35]
    ds_read_b64_tr_b16 v[190:191], v6 offset:19200
    v_mfma_f32_16x16x32_bf16 v[64:67], v[140:143], v[160:163], v[64:67]
    ds_read_b64_tr_b16 v[192:193], v5 offset:15680
    v_mfma_f32_16x16x32_bf16 v[96:99], v[140:143], v[164:167], v[96:99]
    ds_read_b64_tr_b16 v[194:195], v5 offset:19520
    v_mfma_f32_16x16x32_bf16 v[116:119], v[140:143], v[168:171], v[116:119]
    ds_read_b64_tr_b16 v[196:197], v5 offset:15720
    v_mfma_f32_16x16x32_bf16 v[36:39], v[156:159], v[144:147], v[36:39]
    ds_read_b64_tr_b16 v[198:199], v5 offset:19560
    v_mfma_f32_16x16x32_bf16 v[68:71], v[160:163], v[144:147], v[68:71]
    ds_read_b64_tr_b16 v[200:201], v7 offset:15360
    v_mfma_f32_16x16x32_bf16 v[100:103], v[164:167], v[144:147], v[100:103]
    ds_read_b64_tr_b16 v[202:203], v7 offset:19200
    v_mfma_f32_16x16x32_bf16 v[120:123], v[168:171], v[144:147], v[120:123]
    v_mfma_f32_16x16x32_bf16 v[40:43], v[156:159], v[148:151], v[40:43]
    v_mfma_f32_16x16x32_bf16 v[72:75], v[160:163], v[148:151], v[72:75]
    v_mfma_f32_16x16x32_bf16 v[104:107], v[164:167], v[148:151], v[104:107]
    v_mfma_f32_16x16x32_bf16 v[44:47], v[156:159], v[152:155], v[44:47]
    v_mfma_f32_16x16x32_bf16 v[76:79], v[160:163], v[152:155], v[76:79]
    v_mfma_f32_16x16x32_bf16 v[108:111], v[164:167], v[152:155], v[108:111]
    s_waitcnt lgkmcnt(0)
    s_barrier
    v_mfma_f32_16x16x32_bf16 v[16:19], v[172:175], v[204:207], v[16:19]
    v_mfma_f32_16x16x32_bf16 v[48:51], v[172:175], v[208:211], v[48:51]
    v_mfma_f32_16x16x32_bf16 v[80:83], v[172:175], v[212:215], v[80:83]
    v_mfma_f32_16x16x32_bf16 v[20:23], v[176:179], v[204:207], v[20:23]
    v_mfma_f32_16x16x32_bf16 v[52:55], v[176:179], v[208:211], v[52:55]
    v_mfma_f32_16x16x32_bf16 v[84:87], v[176:179], v[212:215], v[84:87]
    v_mfma_f32_16x16x32_bf16 v[24:27], v[180:183], v[204:207], v[24:27]
    v_mfma_f32_16x16x32_bf16 v[56:59], v[180:183], v[208:211], v[56:59]
    v_mfma_f32_16x16x32_bf16 v[88:91], v[180:183], v[212:215], v[88:91]
    v_mfma_f32_16x16x32_bf16 v[112:115], v[180:183], v[216:219], v[112:115]
    v_mfma_f32_16x16x32_bf16 v[28:31], v[184:187], v[204:207], v[28:31]
    v_mfma_f32_16x16x32_bf16 v[60:63], v[184:187], v[208:211], v[60:63]
    v_mfma_f32_16x16x32_bf16 v[92:95], v[184:187], v[212:215], v[92:95]
    v_mfma_f32_16x16x32_bf16 v[32:35], v[188:191], v[204:207], v[32:35]
    v_mfma_f32_16x16x32_bf16 v[64:67], v[188:191], v[208:211], v[64:67]
    v_mfma_f32_16x16x32_bf16 v[96:99], v[188:191], v[212:215], v[96:99]
    v_mfma_f32_16x16x32_bf16 v[116:119], v[188:191], v[216:219], v[116:119]
    v_mfma_f32_16x16x32_bf16 v[36:39], v[204:207], v[192:195], v[36:39]
    v_mfma_f32_16x16x32_bf16 v[68:71], v[208:211], v[192:195], v[68:71]
    v_mfma_f32_16x16x32_bf16 v[100:103], v[212:215], v[192:195], v[100:103]
    v_mfma_f32_16x16x32_bf16 v[120:123], v[216:219], v[192:195], v[120:123]
    v_mfma_f32_16x16x32_bf16 v[40:43], v[204:207], v[196:199], v[40:43]
    v_mfma_f32_16x16x32_bf16 v[72:75], v[208:211], v[196:199], v[72:75]
    v_mfma_f32_16x16x32_bf16 v[104:107], v[212:215], v[196:199], v[104:107]
    v_mfma_f32_16x16x32_bf16 v[44:47], v[204:207], v[200:203], v[44:47]
    v_mfma_f32_16x16x32_bf16 v[76:79], v[208:211], v[200:203], v[76:79]
    v_mfma_f32_16x16x32_bf16 v[108:111], v[212:215], v[200:203], v[108:111]
    s_nop 5
    v_cvt_pk_bf16_f32 v148, v88, v89
    v_cvt_pk_bf16_f32 v149, v90, v91
    v_cvt_pk_bf16_f32 v152, v92, v93
    v_cvt_pk_bf16_f32 v153, v94, v95
    v_cvt_pk_bf16_f32 v162, v100, v101
    v_cvt_pk_bf16_f32 v163, v102, v103
    v_cvt_pk_bf16_f32 v170, v104, v105
    v_cvt_pk_bf16_f32 v171, v106, v107
    v_cvt_pk_bf16_f32 v178, v108, v109
    v_cvt_pk_bf16_f32 v179, v110, v111
    v_cvt_pk_bf16_f32 v212, v96, v97
    v_cvt_pk_bf16_f32 v213, v98, v99
    v_mov_b32 v150, 0
    v_mov_b32 v151, 0
    v_mov_b32 v14, 0
    v_mov_b32 v15, 0
    v_cvt_pk_bf16_f32 v214, v112, v113
    v_cvt_pk_bf16_f32 v215, v114, v115
    v_cvt_pk_bf16_f32 v216, v116, v117
    v_cvt_pk_bf16_f32 v217, v118, v119
    v_cvt_pk_bf16_f32 v218, v120, v121
    v_cvt_pk_bf16_f32 v219, v122, v123
    v_permlane32_swap_b32 v212, v150
    v_permlane32_swap_b32 v213, v151
    v_permlane32_swap_b32 v216, v14
    v_permlane32_swap_b32 v217, v15
    ds_write_b64 v12, v[148:149] offset:3072
    ds_write_b64 v12, v[150:151] offset:3584
    ds_write_b64 v12, v[152:153] offset:4096
    ds_write_b64 v12, v[162:163] offset:4608
    ds_write_b64 v12, v[170:171] offset:5120
    ds_write_b64 v12, v[178:179] offset:5632
    ds_write_b64 v12, v[214:215] offset:0
    ds_write_b64 v12, v[14:15] offset:512
    ds_write_b64 v12, v[218:219] offset:1536
    v_cvt_pk_bf16_f32 v132, v24, v25
    v_cvt_pk_bf16_f32 v133, v26, v27
    v_cvt_pk_bf16_f32 v136, v28, v29
    v_cvt_pk_bf16_f32 v137, v30, v31
    v_cvt_pk_bf16_f32 v158, v36, v37
    v_cvt_pk_bf16_f32 v159, v38, v39
    v_cvt_pk_bf16_f32 v166, v40, v41
    v_cvt_pk_bf16_f32 v167, v42, v43
    v_cvt_pk_bf16_f32 v174, v44, v45
    v_cvt_pk_bf16_f32 v175, v46, v47
    v_cvt_pk_bf16_f32 v208, v32, v33
    v_cvt_pk_bf16_f32 v209, v34, v35
    v_mov_b32 v134, 0
    v_mov_b32 v135, 0
    v_cvt_pk_bf16_f32 v140, v56, v57
    v_cvt_pk_bf16_f32 v141, v58, v59
    v_cvt_pk_bf16_f32 v144, v60, v61
    v_cvt_pk_bf16_f32 v145, v62, v63
    v_cvt_pk_bf16_f32 v160, v68, v69
    v_cvt_pk_bf16_f32 v161, v70, v71
    v_cvt_pk_bf16_f32 v168, v72, v73
    v_cvt_pk_bf16_f32 v169, v74, v75
    v_cvt_pk_bf16_f32 v176, v76, v77
    v_cvt_pk_bf16_f32 v177, v78, v79
    v_cvt_pk_bf16_f32 v210, v64, v65
    v_cvt_pk_bf16_f32 v211, v66, v67
    v_mov_b32 v142, 0
    v_mov_b32 v143, 0
    v_cvt_pk_bf16_f32 v180, v16, v17
    v_cvt_pk_bf16_f32 v181, v18, v19
    v_cvt_pk_bf16_f32 v186, v20, v21
    v_cvt_pk_bf16_f32 v187, v22, v23
    v_cvt_pk_bf16_f32 v188, v48, v49
    v_cvt_pk_bf16_f32 v189, v50, v51
    v_cvt_pk_bf16_f32 v194, v52, v53
    v_cvt_pk_bf16_f32 v195, v54, v55
    v_cvt_pk_bf16_f32 v196, v80, v81
    v_cvt_pk_bf16_f32 v197, v82, v83
    v_cvt_pk_bf16_f32 v202, v84, v85
    v_cvt_pk_bf16_f32 v203, v86, v87
    v_permlane32_swap_b32 v208, v134
    v_permlane32_swap_b32 v209, v135
    v_permlane32_swap_b32 v210, v142
    v_permlane32_swap_b32 v211, v143
    s_branch AC_ATT_1
AC_ODD_1:
    s_barrier
    ds_read_b128 v[156:159], v1 offset:0
    ds_read_b128 v[160:163], v1 offset:2048
    ds_read_b128 v[164:167], v1 offset:4096
    ds_read_b64_tr_b16 v[124:125], v5 offset:0
    ds_read_b64_tr_b16 v[126:127], v5 offset:3840
    ds_read_b64_tr_b16 v[128:129], v5 offset:40
    ds_read_b64_tr_b16 v[130:131], v5 offset:3880
    ds_read_b64_tr_b16 v[132:133], v5 offset:160
    ds_read_b64_tr_b16 v[134:135], v5 offset:4000
    ds_read_b128 v[168:171], v3 offset:0
    ds_read_b64_tr_b16 v[136:137], v5 offset:200
    ds_read_b64_tr_b16 v[138:139], v5 offset:4040
    ds_read_b64_tr_b16 v[140:141], v6 offset:0
    ds_read_b64_tr_b16 v[142:143], v6 offset:3840
    ds_read_b64_tr_b16 v[144:145], v5 offset:320
    ds_read_b64_tr_b16 v[146:147], v5 offset:4160
    ds_read_b64_tr_b16 v[148:149], v5 offset:360
    ds_read_b64_tr_b16 v[150:151], v5 offset:4200
    ds_read_b64_tr_b16 v[152:153], v7 offset:0
    ds_read_b64_tr_b16 v[154:155], v7 offset:3840
    s_waitcnt lgkmcnt(0)
    v_mfma_f32_16x16x32_bf16 v[16:19], v[124:127], v[156:159], 0
    ds_read_b128 v[204:207], v2 offset:0
    v_mfma_f32_16x16x32_bf16 v[48:51], v[124:127], v[160:163], 0
    ds_read_b128 v[208:211], v2 offset:2048
    v_mfma_f32_16x16x32_bf16 v[80:83], v[124:127], v[164:167], 0
    ds_read_b128 v[212:215], v2 offset:4096
    v_mfma_f32_16x16x32_bf16 v[20:23], v[128:131], v[156:159], 0
    ds_read_b64_tr_b16 v[172:173], v5 offset:15360
    v_mfma_f32_16x16x32_bf16 v[52:55], v[128:131], v[160:163], 0
    ds_read_b64_tr_b16 v[174:175], v5 offset:19200
    v_mfma_f32_16x16x32_bf16 v[84:87], v[128:131], v[164:167], 0
    ds_read_b64_tr_b16 v[176:177], v5 offset:15400
    v_mfma_f32_16x16x32_bf16 v[24:27], v[132:135], v[156:159], 0
    ds_read_b64_tr_b16 v[178:179], v5 offset:19240
    v_mfma_f32_16x16x32_bf16 v[56:59], v[132:135], v[160:163], 0
    ds_read_b64_tr_b16 v[180:181], v5 offset:15520
    v_mfma_f32_16x16x32_bf16 v[88:91], v[132:135], v[164:167], 0
    ds_read_b64_tr_b16 v[182:183], v5 offset:19360
    v_mfma_f32_16x16x32_bf16 v[28:31], v[136:139], v[156:159], 0
    ds_read_b128 v[216:219], v4 offset:0
    v_mfma_f32_16x16x32_bf16 v[60:63], v[136:139], v[160:163], 0
    ds_read_b64_tr_b16 v[184:185], v5 offset:15560
    v_mfma_f32_16x16x32_bf16 v[92:95], v[136:139], v[164:167], 0
    ds_read_b64_tr_b16 v[186:187], v5 offset:19400
    v_mfma_f32_16x16x32_bf16 v[112:115], v[136:139], v[168:171], 0
    ds_read_b64_tr_b16 v[188:189], v6 offset:15360
    v_mfma_f32_16x16x32_bf16 v[32:35], v[140:143], v[156:159], 0
    ds_read_b64_tr_b16 v[190:191], v6 offset:19200
    v_mfma_f32_16x16x32_bf16 v[64:67], v[140:143], v[160:163], 0
    ds_read_b64_tr_b16 v[192:193], v5 offset:15680
    v_mfma_f32_16x16x32_bf16 v[96:99], v[140:143], v[164:167], 0
    ds_read_b64_tr_b16 v[194:195], v5 offset:19520
    v_mfma_f32_16x16x32_bf16 v[36:39], v[156:159], v[144:147], 0
    ds_read_b64_tr_b16 v[196:197], v5 offset:15720
    v_mfma_f32_16x16x32_bf16 v[68:71], v[160:163], v[144:147], 0
    ds_read_b64_tr_b16 v[198:199], v5 offset:19560
    v_mfma_f32_16x16x32_bf16 v[100:103], v[164:167], v[144:147], 0
    ds_read_b64_tr_b16 v[200:201], v7 offset:15360
    v_mfma_f32_16x16x32_bf16 v[40:43], v[156:159], v[148:151], 0
    ds_read_b64_tr_b16 v[202:203], v7 offset:19200
    v_mfma_f32_16x16x32_bf16 v[72:75], v[160:163], v[148:151], 0
    v_add_u32 v1, s52, v1
    v_mfma_f32_16x16x32_bf16 v[104:107], v[164:167], v[148:151], 0
    v_add_u32 v2, s52, v2
    v_mfma_f32_16x16x32_bf16 v[116:119], v[168:171], v[148:151], 0
    v_add_u32 v3, s52, v3
    v_mfma_f32_16x16x32_bf16 v[44:47], v[156:159], v[152:155], 0
    v_add_u32 v4, s52, v4
    v_mfma_f32_16x16x32_bf16 v[76:79], v[160:163], v[152:155], 0
    v_add_u32 v5, s52, v5
    v_mfma_f32_16x16x32_bf16 v[108:111], v[164:167], v[152:155], 0
    v_add_u32 v6, s52, v6
    v_mfma_f32_16x16x32_bf16 v[120:123], v[168:171], v[152:155], 0
    v_add_u32 v7, s52, v7
    s_waitcnt lgkmcnt(0)
    s_barrier
    v_mfma_f32_16x16x32_bf16 v[16:19], v[172:175], v[204:207], v[16:19]
    ds_read_b128 v[156:159], v1 offset:0
    v_mfma_f32_16x16x32_bf16 v[48:51], v[172:175], v[208:211], v[48:51]
    ds_read_b128 v[160:163], v1 offset:2048
    v_mfma_f32_16x16x32_bf16 v[80:83], v[172:175], v[212:215], v[80:83]
    ds_read_b128 v[164:167], v1 offset:4096
    v_mfma_f32_16x16x32_bf16 v[20:23], v[176:179], v[204:207], v[20:23]
    ds_read_b64_tr_b16 v[124:125], v5 offset:0
    v_mfma_f32_16x16x32_bf16 v[52:55], v[176:179], v[208:211], v[52:55]
    ds_read_b64_tr_b16 v[126:127], v5 offset:3840
    v_mfma_f32_16x16x32_bf16 v[84:87], v[176:179], v[212:215], v[84:87]
    ds_read_b64_tr_b16 v[128:129], v5 offset:40
    v_mfma_f32_16x16x32_bf16 v[24:27], v[180:183], v[204:207], v[24:27]
    ds_read_b64_tr_b16 v[130:131], v5 offset:3880
    v_mfma_f32_16x16x32_bf16 v[56:59], v[180:183], v[208:211], v[56:59]
    ds_read_b64_tr_b16 v[132:133], v5 offset:160
    v_mfma_f32_16x16x32_bf16 v[88:91], v[180:183], v[212:215], v[88:91]
    ds_read_b64_tr_b16 v[134:135], v5 offset:4000
    v_mfma_f32_16x16x32_bf16 v[28:31], v[184:187], v[204:207], v[28:31]
    ds_read_b128 v[168:171], v3 offset:0
    v_mfma_f32_16x16x32_bf16 v[60:63], v[184:187], v[208:211], v[60:63]
    ds_read_b64_tr_b16 v[136:137], v5 offset:200
    v_mfma_f32_16x16x32_bf16 v[92:95], v[184:187], v[212:215], v[92:95]
    ds_read_b64_tr_b16 v[138:139], v5 offset:4040
    v_mfma_f32_16x16x32_bf16 v[112:115], v[184:187], v[216:219], v[112:115]
    ds_read_b64_tr_b16 v[140:141], v6 offset:0
    v_mfma_f32_16x16x32_bf16 v[32:35], v[188:191], v[204:207], v[32:35]
    ds_read_b64_tr_b16 v[142:143], v6 offset:3840
    v_mfma_f32_16x16x32_bf16 v[64:67], v[188:191], v[208:211], v[64:67]
    ds_read_b64_tr_b16 v[144:145], v5 offset:320
    v_mfma_f32_16x16x32_bf16 v[96:99], v[188:191], v[212:215], v[96:99]
    ds_read_b64_tr_b16 v[146:147], v5 offset:4160
    v_mfma_f32_16x16x32_bf16 v[36:39], v[204:207], v[192:195], v[36:39]
    ds_read_b64_tr_b16 v[148:149], v5 offset:360
    v_mfma_f32_16x16x32_bf16 v[68:71], v[208:211], v[192:195], v[68:71]
    ds_read_b64_tr_b16 v[150:151], v5 offset:4200
    v_mfma_f32_16x16x32_bf16 v[100:103], v[212:215], v[192:195], v[100:103]
    ds_read_b64_tr_b16 v[152:153], v7 offset:0
    v_mfma_f32_16x16x32_bf16 v[40:43], v[204:207], v[196:199], v[40:43]
    ds_read_b64_tr_b16 v[154:155], v7 offset:3840
    v_mfma_f32_16x16x32_bf16 v[72:75], v[208:211], v[196:199], v[72:75]
    v_mfma_f32_16x16x32_bf16 v[104:107], v[212:215], v[196:199], v[104:107]
    v_mfma_f32_16x16x32_bf16 v[116:119], v[216:219], v[196:199], v[116:119]
    v_mfma_f32_16x16x32_bf16 v[44:47], v[204:207], v[200:203], v[44:47]
    v_mfma_f32_16x16x32_bf16 v[76:79], v[208:211], v[200:203], v[76:79]
    v_mfma_f32_16x16x32_bf16 v[108:111], v[212:215], v[200:203], v[108:111]
    v_mfma_f32_16x16x32_bf16 v[120:123], v[216:219], v[200:203], v[120:123]
    s_waitcnt lgkmcnt(0)
    v_mfma_f32_16x16x32_bf16 v[16:19], v[124:127], v[156:159], v[16:19]
    ds_read_b128 v[204:207], v2 offset:0
    v_mfma_f32_16x16x32_bf16 v[48:51], v[124:127], v[160:163], v[48:51]
    ds_read_b128 v[208:211], v2 offset:2048
    v_mfma_f32_16x16x32_bf16 v[80:83], v[124:127], v[164:167], v[80:83]
    ds_read_b128 v[212:215], v2 offset:4096
    v_mfma_f32_16x16x32_bf16 v[20:23], v[128:131], v[156:159], v[20:23]
    ds_read_b64_tr_b16 v[172:173], v5 offset:15360
    v_mfma_f32_16x16x32_bf16 v[52:55], v[128:131], v[160:163], v[52:55]
    ds_read_b64_tr_b16 v[174:175], v5 offset:19200
    v_mfma_f32_16x16x32_bf16 v[84:87], v[128:131], v[164:167], v[84:87]
    ds_read_b64_tr_b16 v[176:177], v5 offset:15400
    v_mfma_f32_16x16x32_bf16 v[24:27], v[132:135], v[156:159], v[24:27]
    ds_read_b64_tr_b16 v[178:179], v5 offset:19240
    v_mfma_f32_16x16x32_bf16 v[56:59], v[132:135], v[160:163], v[56:59]
    ds_read_b64_tr_b16 v[180:181], v5 offset:15520
    v_mfma_f32_16x16x32_bf16 v[88:91], v[132:135], v[164:167], v[88:91]
    ds_read_b64_tr_b16 v[182:183], v5 offset:19360
    v_mfma_f32_16x16x32_bf16 v[28:31], v[136:139], v[156:159], v[28:31]
    ds_read_b128 v[216:219], v4 offset:0
    v_mfma_f32_16x16x32_bf16 v[60:63], v[136:139], v[160:163], v[60:63]
    ds_read_b64_tr_b16 v[184:185], v5 offset:15560
    v_mfma_f32_16x16x32_bf16 v[92:95], v[136:139], v[164:167], v[92:95]
    ds_read_b64_tr_b16 v[186:187], v5 offset:19400
    v_mfma_f32_16x16x32_bf16 v[112:115], v[136:139], v[168:171], v[112:115]
    ds_read_b64_tr_b16 v[188:189], v6 offset:15360
    v_mfma_f32_16x16x32_bf16 v[32:35], v[140:143], v[156:159], v[32:35]
    ds_read_b64_tr_b16 v[190:191], v6 offset:19200
    v_mfma_f32_16x16x32_bf16 v[64:67], v[140:143], v[160:163], v[64:67]
    ds_read_b64_tr_b16 v[192:193], v5 offset:15680
    v_mfma_f32_16x16x32_bf16 v[96:99], v[140:143], v[164:167], v[96:99]
    ds_read_b64_tr_b16 v[194:195], v5 offset:19520
    v_mfma_f32_16x16x32_bf16 v[36:39], v[156:159], v[144:147], v[36:39]
    ds_read_b64_tr_b16 v[196:197], v5 offset:15720
    v_mfma_f32_16x16x32_bf16 v[68:71], v[160:163], v[144:147], v[68:71]
    ds_read_b64_tr_b16 v[198:199], v5 offset:19560
    v_mfma_f32_16x16x32_bf16 v[100:103], v[164:167], v[144:147], v[100:103]
    ds_read_b64_tr_b16 v[200:201], v7 offset:15360
    v_mfma_f32_16x16x32_bf16 v[40:43], v[156:159], v[148:151], v[40:43]
    ds_read_b64_tr_b16 v[202:203], v7 offset:19200
    v_mfma_f32_16x16x32_bf16 v[72:75], v[160:163], v[148:151], v[72:75]
    v_add_u32 v1, s52, v1
    v_mfma_f32_16x16x32_bf16 v[104:107], v[164:167], v[148:151], v[104:107]
    v_add_u32 v2, s52, v2
    v_mfma_f32_16x16x32_bf16 v[116:119], v[168:171], v[148:151], v[116:119]
    v_add_u32 v3, s52, v3
    v_mfma_f32_16x16x32_bf16 v[44:47], v[156:159], v[152:155], v[44:47]
    v_add_u32 v4, s52, v4
    v_mfma_f32_16x16x32_bf16 v[76:79], v[160:163], v[152:155], v[76:79]
    v_add_u32 v5, s52, v5
    v_mfma_f32_16x16x32_bf16 v[108:111], v[164:167], v[152:155], v[108:111]
    v_add_u32 v6, s52, v6
    v_mfma_f32_16x16x32_bf16 v[120:123], v[168:171], v[152:155], v[120:123]
    v_add_u32 v7, s52, v7
    s_waitcnt lgkmcnt(0)
    s_barrier
    v_mfma_f32_16x16x32_bf16 v[16:19], v[172:175], v[204:207], v[16:19]
    ds_read_b128 v[156:159], v1 offset:0
    v_mfma_f32_16x16x32_bf16 v[48:51], v[172:175], v[208:211], v[48:51]
    ds_read_b128 v[160:163], v1 offset:2048
    v_mfma_f32_16x16x32_bf16 v[80:83], v[172:175], v[212:215], v[80:83]
    ds_read_b128 v[164:167], v1 offset:4096
    v_mfma_f32_16x16x32_bf16 v[20:23], v[176:179], v[204:207], v[20:23]
    ds_read_b64_tr_b16 v[124:125], v5 offset:0
    v_mfma_f32_16x16x32_bf16 v[52:55], v[176:179], v[208:211], v[52:55]
    ds_read_b64_tr_b16 v[126:127], v5 offset:3840
    v_mfma_f32_16x16x32_bf16 v[84:87], v[176:179], v[212:215], v[84:87]
    ds_read_b64_tr_b16 v[128:129], v5 offset:40
    v_mfma_f32_16x16x32_bf16 v[24:27], v[180:183], v[204:207], v[24:27]
    ds_read_b64_tr_b16 v[130:131], v5 offset:3880
    v_mfma_f32_16x16x32_bf16 v[56:59], v[180:183], v[208:211], v[56:59]
    ds_read_b64_tr_b16 v[132:133], v5 offset:160
    v_mfma_f32_16x16x32_bf16 v[88:91], v[180:183], v[212:215], v[88:91]
    ds_read_b64_tr_b16 v[134:135], v5 offset:4000
    v_mfma_f32_16x16x32_bf16 v[28:31], v[184:187], v[204:207], v[28:31]
    ds_read_b128 v[168:171], v3 offset:0
    v_mfma_f32_16x16x32_bf16 v[60:63], v[184:187], v[208:211], v[60:63]
    ds_read_b64_tr_b16 v[136:137], v5 offset:200
    v_mfma_f32_16x16x32_bf16 v[92:95], v[184:187], v[212:215], v[92:95]
    ds_read_b64_tr_b16 v[138:139], v5 offset:4040
    v_mfma_f32_16x16x32_bf16 v[112:115], v[184:187], v[216:219], v[112:115]
    ds_read_b64_tr_b16 v[140:141], v6 offset:0
    v_mfma_f32_16x16x32_bf16 v[32:35], v[188:191], v[204:207], v[32:35]
    ds_read_b64_tr_b16 v[142:143], v6 offset:3840
    v_mfma_f32_16x16x32_bf16 v[64:67], v[188:191], v[208:211], v[64:67]
    ds_read_b64_tr_b16 v[144:145], v5 offset:320
    v_mfma_f32_16x16x32_bf16 v[96:99], v[188:191], v[212:215], v[96:99]
    ds_read_b64_tr_b16 v[146:147], v5 offset:4160
    v_mfma_f32_16x16x32_bf16 v[36:39], v[204:207], v[192:195], v[36:39]
    ds_read_b64_tr_b16 v[148:149], v5 offset:360
    v_mfma_f32_16x16x32_bf16 v[68:71], v[208:211], v[192:195], v[68:71]
    ds_read_b64_tr_b16 v[150:151], v5 offset:4200
    v_mfma_f32_16x16x32_bf16 v[100:103], v[212:215], v[192:195], v[100:103]
    ds_read_b64_tr_b16 v[152:153], v7 offset:0
    v_mfma_f32_16x16x32_bf16 v[40:43], v[204:207], v[196:199], v[40:43]
    ds_read_b64_tr_b16 v[154:155], v7 offset:3840
    v_mfma_f32_16x16x32_bf16 v[72:75], v[208:211], v[196:199], v[72:75]
    v_mfma_f32_16x16x32_bf16 v[104:107], v[212:215], v[196:199], v[104:107]
    v_mfma_f32_16x16x32_bf16 v[116:119], v[216:219], v[196:199], v[116:119]
    v_mfma_f32_16x16x32_bf16 v[44:47], v[204:207], v[200:203], v[44:47]
    v_mfma_f32_16x16x32_bf16 v[76:79], v[208:211], v[200:203], v[76:79]
    v_mfma_f32_16x16x32_bf16 v[108:111], v[212:215], v[200:203], v[108:111]
    v_mfma_f32_16x16x32_bf16 v[120:123], v[216:219], v[200:203], v[120:123]
    s_waitcnt lgkmcnt(0)
    v_mfma_f32_16x16x32_bf16 v[16:19], v[124:127], v[156:159], v[16:19]
    ds_read_b128 v[204:207], v2 offset:0
    v_mfma_f32_16x16x32_bf16 v[48:51], v[124:127], v[160:163], v[48:51]
    ds_read_b128 v[208:211], v2 offset:2048
    v_mfma_f32_16x16x32_bf16 v[80:83], v[124:127], v[164:167], v[80:83]
    ds_read_b128 v[212:215], v2 offset:4096
    v_mfma_f32_16x16x32_bf16 v[20:23], v[128:131], v[156:159], v[20:23]
    ds_read_b64_tr_b16 v[172:173], v5 offset:15360
    v_mfma_f32_16x16x32_bf16 v[52:55], v[128:131], v[160:163], v[52:55]
    ds_read_b64_tr_b16 v[174:175], v5 offset:19200
    v_mfma_f32_16x16x32_bf16 v[84:87], v[128:131], v[164:167], v[84:87]
    ds_read_b64_tr_b16 v[176:177], v5 offset:15400
    v_mfma_f32_16x16x32_bf16 v[24:27], v[132:135], v[156:159], v[24:27]
    ds_read_b64_tr_b16 v[178:179], v5 offset:19240
    v_mfma_f32_16x16x32_bf16 v[56:59], v[132:135], v[160:163], v[56:59]
    ds_read_b64_tr_b16 v[180:181], v5 offset:15520
    v_mfma_f32_16x16x32_bf16 v[88:91], v[132:135], v[164:167], v[88:91]
    ds_read_b64_tr_b16 v[182:183], v5 offset:19360
    v_mfma_f32_16x16x32_bf16 v[28:31], v[136:139], v[156:159], v[28:31]
    ds_read_b128 v[216:219], v4 offset:0
    v_mfma_f32_16x16x32_bf16 v[60:63], v[136:139], v[160:163], v[60:63]
    ds_read_b64_tr_b16 v[184:185], v5 offset:15560
    v_mfma_f32_16x16x32_bf16 v[92:95], v[136:139], v[164:167], v[92:95]
    ds_read_b64_tr_b16 v[186:187], v5 offset:19400
    v_mfma_f32_16x16x32_bf16 v[112:115], v[136:139], v[168:171], v[112:115]
    ds_read_b64_tr_b16 v[188:189], v6 offset:15360
    v_mfma_f32_16x16x32_bf16 v[32:35], v[140:143], v[156:159], v[32:35]
    ds_read_b64_tr_b16 v[190:191], v6 offset:19200
    v_mfma_f32_16x16x32_bf16 v[64:67], v[140:143], v[160:163], v[64:67]
    ds_read_b64_tr_b16 v[192:193], v5 offset:15680
    v_mfma_f32_16x16x32_bf16 v[96:99], v[140:143], v[164:167], v[96:99]
    ds_read_b64_tr_b16 v[194:195], v5 offset:19520
    v_mfma_f32_16x16x32_bf16 v[36:39], v[156:159], v[144:147], v[36:39]
    ds_read_b64_tr_b16 v[196:197], v5 offset:15720
    v_mfma_f32_16x16x32_bf16 v[68:71], v[160:163], v[144:147], v[68:71]
    ds_read_b64_tr_b16 v[198:199], v5 offset:19560
    v_mfma_f32_16x16x32_bf16 v[100:103], v[164:167], v[144:147], v[100:103]
    ds_read_b64_tr_b16 v[200:201], v7 offset:15360
    v_mfma_f32_16x16x32_bf16 v[40:43], v[156:159], v[148:151], v[40:43]
    ds_read_b64_tr_b16 v[202:203], v7 offset:19200
    v_mfma_f32_16x16x32_bf16 v[72:75], v[160:163], v[148:151], v[72:75]
    v_add_u32 v1, s53, v1
    v_mfma_f32_16x16x32_bf16 v[104:107], v[164:167], v[148:151], v[104:107]
    v_add_u32 v2, s53, v2
    v_mfma_f32_16x16x32_bf16 v[116:119], v[168:171], v[148:151], v[116:119]
    v_add_u32 v3, s53, v3
    v_mfma_f32_16x16x32_bf16 v[44:47], v[156:159], v[152:155], v[44:47]
    v_add_u32 v4, s53, v4
    v_mfma_f32_16x16x32_bf16 v[76:79], v[160:163], v[152:155], v[76:79]
    v_add_u32 v5, s53, v5
    v_mfma_f32_16x16x32_bf16 v[108:111], v[164:167], v[152:155], v[108:111]
    v_add_u32 v6, s53, v6
    v_mfma_f32_16x16x32_bf16 v[120:123], v[168:171], v[152:155], v[120:123]
    v_add_u32 v7, s53, v7
    s_waitcnt lgkmcnt(0)
    s_barrier
    v_mfma_f32_16x16x32_bf16 v[16:19], v[172:175], v[204:207], v[16:19]
    ds_read_b128 v[156:159], v1 offset:0
    v_mfma_f32_16x16x32_bf16 v[48:51], v[172:175], v[208:211], v[48:51]
    ds_read_b128 v[160:163], v1 offset:2048
    v_mfma_f32_16x16x32_bf16 v[80:83], v[172:175], v[212:215], v[80:83]
    ds_read_b128 v[164:167], v1 offset:4096
    v_mfma_f32_16x16x32_bf16 v[20:23], v[176:179], v[204:207], v[20:23]
    ds_read_b64_tr_b16 v[124:125], v5 offset:0
    v_mfma_f32_16x16x32_bf16 v[52:55], v[176:179], v[208:211], v[52:55]
    ds_read_b64_tr_b16 v[126:127], v5 offset:3840
    v_mfma_f32_16x16x32_bf16 v[84:87], v[176:179], v[212:215], v[84:87]
    ds_read_b64_tr_b16 v[128:129], v5 offset:40
    v_mfma_f32_16x16x32_bf16 v[24:27], v[180:183], v[204:207], v[24:27]
    ds_read_b64_tr_b16 v[130:131], v5 offset:3880
    v_mfma_f32_16x16x32_bf16 v[56:59], v[180:183], v[208:211], v[56:59]
    ds_read_b64_tr_b16 v[132:133], v5 offset:160
    v_mfma_f32_16x16x32_bf16 v[88:91], v[180:183], v[212:215], v[88:91]
    ds_read_b64_tr_b16 v[134:135], v5 offset:4000
    v_mfma_f32_16x16x32_bf16 v[28:31], v[184:187], v[204:207], v[28:31]
    ds_read_b128 v[168:171], v3 offset:0
    v_mfma_f32_16x16x32_bf16 v[60:63], v[184:187], v[208:211], v[60:63]
    ds_read_b64_tr_b16 v[136:137], v5 offset:200
    v_mfma_f32_16x16x32_bf16 v[92:95], v[184:187], v[212:215], v[92:95]
    ds_read_b64_tr_b16 v[138:139], v5 offset:4040
    v_mfma_f32_16x16x32_bf16 v[112:115], v[184:187], v[216:219], v[112:115]
    ds_read_b64_tr_b16 v[140:141], v6 offset:0
    v_mfma_f32_16x16x32_bf16 v[32:35], v[188:191], v[204:207], v[32:35]
    ds_read_b64_tr_b16 v[142:143], v6 offset:3840
    v_mfma_f32_16x16x32_bf16 v[64:67], v[188:191], v[208:211], v[64:67]
    ds_read_b64_tr_b16 v[144:145], v5 offset:320
    v_mfma_f32_16x16x32_bf16 v[96:99], v[188:191], v[212:215], v[96:99]
    ds_read_b64_tr_b16 v[146:147], v5 offset:4160
    v_mfma_f32_16x16x32_bf16 v[36:39], v[204:207], v[192:195], v[36:39]
    ds_read_b64_tr_b16 v[148:149], v5 offset:360
    v_mfma_f32_16x16x32_bf16 v[68:71], v[208:211], v[192:195], v[68:71]
    ds_read_b64_tr_b16 v[150:151], v5 offset:4200
    v_mfma_f32_16x16x32_bf16 v[100:103], v[212:215], v[192:195], v[100:103]
    ds_read_b64_tr_b16 v[152:153], v7 offset:0
    v_mfma_f32_16x16x32_bf16 v[40:43], v[204:207], v[196:199], v[40:43]
    ds_read_b64_tr_b16 v[154:155], v7 offset:3840
    v_mfma_f32_16x16x32_bf16 v[72:75], v[208:211], v[196:199], v[72:75]
    v_mfma_f32_16x16x32_bf16 v[104:107], v[212:215], v[196:199], v[104:107]
    v_mfma_f32_16x16x32_bf16 v[116:119], v[216:219], v[196:199], v[116:119]
    v_mfma_f32_16x16x32_bf16 v[44:47], v[204:207], v[200:203], v[44:47]
    v_mfma_f32_16x16x32_bf16 v[76:79], v[208:211], v[200:203], v[76:79]
    v_mfma_f32_16x16x32_bf16 v[108:111], v[212:215], v[200:203], v[108:111]
    v_mfma_f32_16x16x32_bf16 v[120:123], v[216:219], v[200:203], v[120:123]
    s_waitcnt lgkmcnt(0)
    v_mfma_f32_16x16x32_bf16 v[16:19], v[124:127], v[156:159], v[16:19]
    ds_read_b128 v[204:207], v2 offset:0
    v_mfma_f32_16x16x32_bf16 v[48:51], v[124:127], v[160:163], v[48:51]
    ds_read_b128 v[208:211], v2 offset:2048
    v_mfma_f32_16x16x32_bf16 v[80:83], v[124:127], v[164:167], v[80:83]
    ds_read_b128 v[212:215], v2 offset:4096
    v_mfma_f32_16x16x32_bf16 v[20:23], v[128:131], v[156:159], v[20:23]
    ds_read_b64_tr_b16 v[172:173], v5 offset:15360
    v_mfma_f32_16x16x32_bf16 v[52:55], v[128:131], v[160:163], v[52:55]
    ds_read_b64_tr_b16 v[174:175], v5 offset:19200
    v_mfma_f32_16x16x32_bf16 v[84:87], v[128:131], v[164:167], v[84:87]
    ds_read_b64_tr_b16 v[176:177], v5 offset:15400
    v_mfma_f32_16x16x32_bf16 v[24:27], v[132:135], v[156:159], v[24:27]
    ds_read_b64_tr_b16 v[178:179], v5 offset:19240
    v_mfma_f32_16x16x32_bf16 v[56:59], v[132:135], v[160:163], v[56:59]
    ds_read_b64_tr_b16 v[180:181], v5 offset:15520
    v_mfma_f32_16x16x32_bf16 v[88:91], v[132:135], v[164:167], v[88:91]
    ds_read_b64_tr_b16 v[182:183], v5 offset:19360
    v_mfma_f32_16x16x32_bf16 v[28:31], v[136:139], v[156:159], v[28:31]
    ds_read_b128 v[216:219], v4 offset:0
    v_mfma_f32_16x16x32_bf16 v[60:63], v[136:139], v[160:163], v[60:63]
    ds_read_b64_tr_b16 v[184:185], v5 offset:15560
    v_mfma_f32_16x16x32_bf16 v[92:95], v[136:139], v[164:167], v[92:95]
    ds_read_b64_tr_b16 v[186:187], v5 offset:19400
    v_mfma_f32_16x16x32_bf16 v[112:115], v[136:139], v[168:171], v[112:115]
    ds_read_b64_tr_b16 v[188:189], v6 offset:15360
    v_mfma_f32_16x16x32_bf16 v[32:35], v[140:143], v[156:159], v[32:35]
    ds_read_b64_tr_b16 v[190:191], v6 offset:19200
    v_mfma_f32_16x16x32_bf16 v[64:67], v[140:143], v[160:163], v[64:67]
    ds_read_b64_tr_b16 v[192:193], v5 offset:15680
    v_mfma_f32_16x16x32_bf16 v[96:99], v[140:143], v[164:167], v[96:99]
    ds_read_b64_tr_b16 v[194:195], v5 offset:19520
    v_mfma_f32_16x16x32_bf16 v[36:39], v[156:159], v[144:147], v[36:39]
    ds_read_b64_tr_b16 v[196:197], v5 offset:15720
    v_mfma_f32_16x16x32_bf16 v[68:71], v[160:163], v[144:147], v[68:71]
    ds_read_b64_tr_b16 v[198:199], v5 offset:19560
    v_mfma_f32_16x16x32_bf16 v[100:103], v[164:167], v[144:147], v[100:103]
    ds_read_b64_tr_b16 v[200:201], v7 offset:15360
    v_mfma_f32_16x16x32_bf16 v[40:43], v[156:159], v[148:151], v[40:43]
    ds_read_b64_tr_b16 v[202:203], v7 offset:19200
    v_mfma_f32_16x16x32_bf16 v[72:75], v[160:163], v[148:151], v[72:75]
    v_add_u32 v1, s52, v1
    v_mfma_f32_16x16x32_bf16 v[104:107], v[164:167], v[148:151], v[104:107]
    v_add_u32 v2, s52, v2
    v_mfma_f32_16x16x32_bf16 v[116:119], v[168:171], v[148:151], v[116:119]
    v_add_u32 v3, s52, v3
    v_mfma_f32_16x16x32_bf16 v[44:47], v[156:159], v[152:155], v[44:47]
    v_add_u32 v4, s52, v4
    v_mfma_f32_16x16x32_bf16 v[76:79], v[160:163], v[152:155], v[76:79]
    v_add_u32 v5, s52, v5
    v_mfma_f32_16x16x32_bf16 v[108:111], v[164:167], v[152:155], v[108:111]
    v_add_u32 v6, s52, v6
    v_mfma_f32_16x16x32_bf16 v[120:123], v[168:171], v[152:155], v[120:123]
    v_add_u32 v7, s52, v7
    s_waitcnt lgkmcnt(0)
    s_barrier
    v_mfma_f32_16x16x32_bf16 v[16:19], v[172:175], v[204:207], v[16:19]
    ds_read_b128 v[156:159], v1 offset:0
    v_mfma_f32_16x16x32_bf16 v[48:51], v[172:175], v[208:211], v[48:51]
    ds_read_b128 v[160:163], v1 offset:2048
    v_mfma_f32_16x16x32_bf16 v[80:83], v[172:175], v[212:215], v[80:83]
    ds_read_b128 v[164:167], v1 offset:4096
    v_mfma_f32_16x16x32_bf16 v[20:23], v[176:179], v[204:207], v[20:23]
    ds_read_b64_tr_b16 v[124:125], v5 offset:0
    v_mfma_f32_16x16x32_bf16 v[52:55], v[176:179], v[208:211], v[52:55]
    ds_read_b64_tr_b16 v[126:127], v5 offset:3840
    v_mfma_f32_16x16x32_bf16 v[84:87], v[176:179], v[212:215], v[84:87]
    ds_read_b64_tr_b16 v[128:129], v5 offset:40
    v_mfma_f32_16x16x32_bf16 v[24:27], v[180:183], v[204:207], v[24:27]
    ds_read_b64_tr_b16 v[130:131], v5 offset:3880
    v_mfma_f32_16x16x32_bf16 v[56:59], v[180:183], v[208:211], v[56:59]
    ds_read_b64_tr_b16 v[132:133], v5 offset:160
    v_mfma_f32_16x16x32_bf16 v[88:91], v[180:183], v[212:215], v[88:91]
    ds_read_b64_tr_b16 v[134:135], v5 offset:4000
    v_mfma_f32_16x16x32_bf16 v[28:31], v[184:187], v[204:207], v[28:31]
    ds_read_b128 v[168:171], v3 offset:0
    v_mfma_f32_16x16x32_bf16 v[60:63], v[184:187], v[208:211], v[60:63]
    ds_read_b64_tr_b16 v[136:137], v5 offset:200
    v_mfma_f32_16x16x32_bf16 v[92:95], v[184:187], v[212:215], v[92:95]
    ds_read_b64_tr_b16 v[138:139], v5 offset:4040
    v_mfma_f32_16x16x32_bf16 v[112:115], v[184:187], v[216:219], v[112:115]
    ds_read_b64_tr_b16 v[140:141], v6 offset:0
    v_mfma_f32_16x16x32_bf16 v[32:35], v[188:191], v[204:207], v[32:35]
    ds_read_b64_tr_b16 v[142:143], v6 offset:3840
    v_mfma_f32_16x16x32_bf16 v[64:67], v[188:191], v[208:211], v[64:67]
    ds_read_b64_tr_b16 v[144:145], v5 offset:320
    v_mfma_f32_16x16x32_bf16 v[96:99], v[188:191], v[212:215], v[96:99]
    ds_read_b64_tr_b16 v[146:147], v5 offset:4160
    v_mfma_f32_16x16x32_bf16 v[36:39], v[204:207], v[192:195], v[36:39]
    ds_read_b64_tr_b16 v[148:149], v5 offset:360
    v_mfma_f32_16x16x32_bf16 v[68:71], v[208:211], v[192:195], v[68:71]
    ds_read_b64_tr_b16 v[150:151], v5 offset:4200
    v_mfma_f32_16x16x32_bf16 v[100:103], v[212:215], v[192:195], v[100:103]
    ds_read_b64_tr_b16 v[152:153], v7 offset:0
    v_mfma_f32_16x16x32_bf16 v[40:43], v[204:207], v[196:199], v[40:43]
    ds_read_b64_tr_b16 v[154:155], v7 offset:3840
    v_mfma_f32_16x16x32_bf16 v[72:75], v[208:211], v[196:199], v[72:75]
    v_mfma_f32_16x16x32_bf16 v[104:107], v[212:215], v[196:199], v[104:107]
    v_mfma_f32_16x16x32_bf16 v[116:119], v[216:219], v[196:199], v[116:119]
    v_mfma_f32_16x16x32_bf16 v[44:47], v[204:207], v[200:203], v[44:47]
    v_mfma_f32_16x16x32_bf16 v[76:79], v[208:211], v[200:203], v[76:79]
    v_mfma_f32_16x16x32_bf16 v[108:111], v[212:215], v[200:203], v[108:111]
    v_mfma_f32_16x16x32_bf16 v[120:123], v[216:219], v[200:203], v[120:123]
    s_waitcnt lgkmcnt(0)
    v_mfma_f32_16x16x32_bf16 v[16:19], v[124:127], v[156:159], v[16:19]
    ds_read_b128 v[204:207], v2 offset:0
    v_mfma_f32_16x16x32_bf16 v[48:51], v[124:127], v[160:163], v[48:51]
    ds_read_b128 v[208:211], v2 offset:2048
    v_mfma_f32_16x16x32_bf16 v[80:83], v[124:127], v[164:167], v[80:83]
    ds_read_b128 v[212:215], v2 offset:4096
    v_mfma_f32_16x16x32_bf16 v[20:23], v[128:131], v[156:159], v[20:23]
    ds_read_b64_tr_b16 v[172:173], v5 offset:15360
    v_mfma_f32_16x16x32_bf16 v[52:55], v[128:131], v[160:163], v[52:55]
    ds_read_b64_tr_b16 v[174:175], v5 offset:19200
    v_mfma_f32_16x16x32_bf16 v[84:87], v[128:131], v[164:167], v[84:87]
    ds_read_b64_tr_b16 v[176:177], v5 offset:15400
    v_mfma_f32_16x16x32_bf16 v[24:27], v[132:135], v[156:159], v[24:27]
    ds_read_b64_tr_b16 v[178:179], v5 offset:19240
    v_mfma_f32_16x16x32_bf16 v[56:59], v[132:135], v[160:163], v[56:59]
    ds_read_b64_tr_b16 v[180:181], v5 offset:15520
    v_mfma_f32_16x16x32_bf16 v[88:91], v[132:135], v[164:167], v[88:91]
    ds_read_b64_tr_b16 v[182:183], v5 offset:19360
    v_mfma_f32_16x16x32_bf16 v[28:31], v[136:139], v[156:159], v[28:31]
    ds_read_b128 v[216:219], v4 offset:0
    v_mfma_f32_16x16x32_bf16 v[60:63], v[136:139], v[160:163], v[60:63]
    ds_read_b64_tr_b16 v[184:185], v5 offset:15560
    v_mfma_f32_16x16x32_bf16 v[92:95], v[136:139], v[164:167], v[92:95]
    ds_read_b64_tr_b16 v[186:187], v5 offset:19400
    v_mfma_f32_16x16x32_bf16 v[112:115], v[136:139], v[168:171], v[112:115]
    ds_read_b64_tr_b16 v[188:189], v6 offset:15360
    v_mfma_f32_16x16x32_bf16 v[32:35], v[140:143], v[156:159], v[32:35]
    ds_read_b64_tr_b16 v[190:191], v6 offset:19200
    v_mfma_f32_16x16x32_bf16 v[64:67], v[140:143], v[160:163], v[64:67]
    ds_read_b64_tr_b16 v[192:193], v5 offset:15680
    v_mfma_f32_16x16x32_bf16 v[96:99], v[140:143], v[164:167], v[96:99]
    ds_read_b64_tr_b16 v[194:195], v5 offset:19520
    v_mfma_f32_16x16x32_bf16 v[36:39], v[156:159], v[144:147], v[36:39]
    ds_read_b64_tr_b16 v[196:197], v5 offset:15720
    v_mfma_f32_16x16x32_bf16 v[68:71], v[160:163], v[144:147], v[68:71]
    ds_read_b64_tr_b16 v[198:199], v5 offset:19560
    v_mfma_f32_16x16x32_bf16 v[100:103], v[164:167], v[144:147], v[100:103]
    ds_read_b64_tr_b16 v[200:201], v7 offset:15360
    v_mfma_f32_16x16x32_bf16 v[40:43], v[156:159], v[148:151], v[40:43]
    ds_read_b64_tr_b16 v[202:203], v7 offset:19200
    v_mfma_f32_16x16x32_bf16 v[72:75], v[160:163], v[148:151], v[72:75]
    v_add_u32 v1, s52, v1
    v_mfma_f32_16x16x32_bf16 v[104:107], v[164:167], v[148:151], v[104:107]
    v_add_u32 v2, s52, v2
    v_mfma_f32_16x16x32_bf16 v[116:119], v[168:171], v[148:151], v[116:119]
    v_add_u32 v3, s52, v3
    v_mfma_f32_16x16x32_bf16 v[44:47], v[156:159], v[152:155], v[44:47]
    v_add_u32 v4, s52, v4
    v_mfma_f32_16x16x32_bf16 v[76:79], v[160:163], v[152:155], v[76:79]
    v_add_u32 v5, s52, v5
    v_mfma_f32_16x16x32_bf16 v[108:111], v[164:167], v[152:155], v[108:111]
    v_add_u32 v6, s52, v6
    v_mfma_f32_16x16x32_bf16 v[120:123], v[168:171], v[152:155], v[120:123]
    v_add_u32 v7, s52, v7
    s_waitcnt lgkmcnt(0)
    s_barrier
    v_mfma_f32_16x16x32_bf16 v[16:19], v[172:175], v[204:207], v[16:19]
    ds_read_b128 v[156:159], v1 offset:0
    v_mfma_f32_16x16x32_bf16 v[48:51], v[172:175], v[208:211], v[48:51]
    ds_read_b128 v[160:163], v1 offset:2048
    v_mfma_f32_16x16x32_bf16 v[80:83], v[172:175], v[212:215], v[80:83]
    ds_read_b128 v[164:167], v1 offset:4096
    v_mfma_f32_16x16x32_bf16 v[20:23], v[176:179], v[204:207], v[20:23]
    ds_read_b64_tr_b16 v[124:125], v5 offset:0
    v_mfma_f32_16x16x32_bf16 v[52:55], v[176:179], v[208:211], v[52:55]
    ds_read_b64_tr_b16 v[126:127], v5 offset:3840
    v_mfma_f32_16x16x32_bf16 v[84:87], v[176:179], v[212:215], v[84:87]
    ds_read_b64_tr_b16 v[128:129], v5 offset:40
    v_mfma_f32_16x16x32_bf16 v[24:27], v[180:183], v[204:207], v[24:27]
    ds_read_b64_tr_b16 v[130:131], v5 offset:3880
    v_mfma_f32_16x16x32_bf16 v[56:59], v[180:183], v[208:211], v[56:59]
    ds_read_b64_tr_b16 v[132:133], v5 offset:160
    v_mfma_f32_16x16x32_bf16 v[88:91], v[180:183], v[212:215], v[88:91]
    ds_read_b64_tr_b16 v[134:135], v5 offset:4000
    v_mfma_f32_16x16x32_bf16 v[28:31], v[184:187], v[204:207], v[28:31]
    ds_read_b128 v[168:171], v3 offset:0
    v_mfma_f32_16x16x32_bf16 v[60:63], v[184:187], v[208:211], v[60:63]
    ds_read_b64_tr_b16 v[136:137], v5 offset:200
    v_mfma_f32_16x16x32_bf16 v[92:95], v[184:187], v[212:215], v[92:95]
    ds_read_b64_tr_b16 v[138:139], v5 offset:4040
    v_mfma_f32_16x16x32_bf16 v[112:115], v[184:187], v[216:219], v[112:115]
    ds_read_b64_tr_b16 v[140:141], v6 offset:0
    v_mfma_f32_16x16x32_bf16 v[32:35], v[188:191], v[204:207], v[32:35]
    ds_read_b64_tr_b16 v[142:143], v6 offset:3840
    v_mfma_f32_16x16x32_bf16 v[64:67], v[188:191], v[208:211], v[64:67]
    ds_read_b64_tr_b16 v[144:145], v5 offset:320
    v_mfma_f32_16x16x32_bf16 v[96:99], v[188:191], v[212:215], v[96:99]
    ds_read_b64_tr_b16 v[146:147], v5 offset:4160
    v_mfma_f32_16x16x32_bf16 v[36:39], v[204:207], v[192:195], v[36:39]
    ds_read_b64_tr_b16 v[148:149], v5 offset:360
    v_mfma_f32_16x16x32_bf16 v[68:71], v[208:211], v[192:195], v[68:71]
    ds_read_b64_tr_b16 v[150:151], v5 offset:4200
    v_mfma_f32_16x16x32_bf16 v[100:103], v[212:215], v[192:195], v[100:103]
    ds_read_b64_tr_b16 v[152:153], v7 offset:0
    v_mfma_f32_16x16x32_bf16 v[40:43], v[204:207], v[196:199], v[40:43]
    ds_read_b64_tr_b16 v[154:155], v7 offset:3840
    v_mfma_f32_16x16x32_bf16 v[72:75], v[208:211], v[196:199], v[72:75]
    v_mfma_f32_16x16x32_bf16 v[104:107], v[212:215], v[196:199], v[104:107]
    v_mfma_f32_16x16x32_bf16 v[116:119], v[216:219], v[196:199], v[116:119]
    v_mfma_f32_16x16x32_bf16 v[44:47], v[204:207], v[200:203], v[44:47]
    v_mfma_f32_16x16x32_bf16 v[76:79], v[208:211], v[200:203], v[76:79]
    v_mfma_f32_16x16x32_bf16 v[108:111], v[212:215], v[200:203], v[108:111]
    v_mfma_f32_16x16x32_bf16 v[120:123], v[216:219], v[200:203], v[120:123]
    s_waitcnt lgkmcnt(0)
    v_mfma_f32_16x16x32_bf16 v[16:19], v[124:127], v[156:159], v[16:19]
    ds_read_b128 v[204:207], v2 offset:0
    v_mfma_f32_16x16x32_bf16 v[48:51], v[124:127], v[160:163], v[48:51]
    ds_read_b128 v[208:211], v2 offset:2048
    v_mfma_f32_16x16x32_bf16 v[80:83], v[124:127], v[164:167], v[80:83]
    ds_read_b128 v[212:215], v2 offset:4096
    v_mfma_f32_16x16x32_bf16 v[20:23], v[128:131], v[156:159], v[20:23]
    ds_read_b64_tr_b16 v[172:173], v5 offset:15360
    v_mfma_f32_16x16x32_bf16 v[52:55], v[128:131], v[160:163], v[52:55]
    ds_read_b64_tr_b16 v[174:175], v5 offset:19200
    v_mfma_f32_16x16x32_bf16 v[84:87], v[128:131], v[164:167], v[84:87]
    ds_read_b64_tr_b16 v[176:177], v5 offset:15400
    v_mfma_f32_16x16x32_bf16 v[24:27], v[132:135], v[156:159], v[24:27]
    ds_read_b64_tr_b16 v[178:179], v5 offset:19240
    v_mfma_f32_16x16x32_bf16 v[56:59], v[132:135], v[160:163], v[56:59]
    ds_read_b64_tr_b16 v[180:181], v5 offset:15520
    v_mfma_f32_16x16x32_bf16 v[88:91], v[132:135], v[164:167], v[88:91]
    ds_read_b64_tr_b16 v[182:183], v5 offset:19360
    v_mfma_f32_16x16x32_bf16 v[28:31], v[136:139], v[156:159], v[28:31]
    ds_read_b128 v[216:219], v4 offset:0
    v_mfma_f32_16x16x32_bf16 v[60:63], v[136:139], v[160:163], v[60:63]
    ds_read_b64_tr_b16 v[184:185], v5 offset:15560
    v_mfma_f32_16x16x32_bf16 v[92:95], v[136:139], v[164:167], v[92:95]
    ds_read_b64_tr_b16 v[186:187], v5 offset:19400
    v_mfma_f32_16x16x32_bf16 v[112:115], v[136:139], v[168:171], v[112:115]
    ds_read_b64_tr_b16 v[188:189], v6 offset:15360
    v_mfma_f32_16x16x32_bf16 v[32:35], v[140:143], v[156:159], v[32:35]
    ds_read_b64_tr_b16 v[190:191], v6 offset:19200
    v_mfma_f32_16x16x32_bf16 v[64:67], v[140:143], v[160:163], v[64:67]
    ds_read_b64_tr_b16 v[192:193], v5 offset:15680
    v_mfma_f32_16x16x32_bf16 v[96:99], v[140:143], v[164:167], v[96:99]
    ds_read_b64_tr_b16 v[194:195], v5 offset:19520
    v_mfma_f32_16x16x32_bf16 v[36:39], v[156:159], v[144:147], v[36:39]
    ds_read_b64_tr_b16 v[196:197], v5 offset:15720
    v_mfma_f32_16x16x32_bf16 v[68:71], v[160:163], v[144:147], v[68:71]
    ds_read_b64_tr_b16 v[198:199], v5 offset:19560
    v_mfma_f32_16x16x32_bf16 v[100:103], v[164:167], v[144:147], v[100:103]
    ds_read_b64_tr_b16 v[200:201], v7 offset:15360
    v_mfma_f32_16x16x32_bf16 v[40:43], v[156:159], v[148:151], v[40:43]
    ds_read_b64_tr_b16 v[202:203], v7 offset:19200
    v_mfma_f32_16x16x32_bf16 v[72:75], v[160:163], v[148:151], v[72:75]
    v_add_u32 v1, s53, v1
    v_mfma_f32_16x16x32_bf16 v[104:107], v[164:167], v[148:151], v[104:107]
    v_add_u32 v2, s53, v2
    v_mfma_f32_16x16x32_bf16 v[116:119], v[168:171], v[148:151], v[116:119]
    v_add_u32 v3, s53, v3
    v_mfma_f32_16x16x32_bf16 v[44:47], v[156:159], v[152:155], v[44:47]
    v_add_u32 v4, s53, v4
    v_mfma_f32_16x16x32_bf16 v[76:79], v[160:163], v[152:155], v[76:79]
    v_add_u32 v5, s53, v5
    v_mfma_f32_16x16x32_bf16 v[108:111], v[164:167], v[152:155], v[108:111]
    v_add_u32 v6, s53, v6
    v_mfma_f32_16x16x32_bf16 v[120:123], v[168:171], v[152:155], v[120:123]
    v_add_u32 v7, s53, v7
    s_waitcnt lgkmcnt(0)
    s_barrier
    v_mfma_f32_16x16x32_bf16 v[16:19], v[172:175], v[204:207], v[16:19]
    ds_read_b128 v[156:159], v1 offset:0
    v_mfma_f32_16x16x32_bf16 v[48:51], v[172:175], v[208:211], v[48:51]
    ds_read_b128 v[160:163], v1 offset:2048
    v_mfma_f32_16x16x32_bf16 v[80:83], v[172:175], v[212:215], v[80:83]
    ds_read_b128 v[164:167], v1 offset:4096
    v_mfma_f32_16x16x32_bf16 v[20:23], v[176:179], v[204:207], v[20:23]
    ds_read_b64_tr_b16 v[124:125], v5 offset:0
    v_mfma_f32_16x16x32_bf16 v[52:55], v[176:179], v[208:211], v[52:55]
    ds_read_b64_tr_b16 v[126:127], v5 offset:3840
    v_mfma_f32_16x16x32_bf16 v[84:87], v[176:179], v[212:215], v[84:87]
    ds_read_b64_tr_b16 v[128:129], v5 offset:40
    v_mfma_f32_16x16x32_bf16 v[24:27], v[180:183], v[204:207], v[24:27]
    ds_read_b64_tr_b16 v[130:131], v5 offset:3880
    v_mfma_f32_16x16x32_bf16 v[56:59], v[180:183], v[208:211], v[56:59]
    ds_read_b64_tr_b16 v[132:133], v5 offset:160
    v_mfma_f32_16x16x32_bf16 v[88:91], v[180:183], v[212:215], v[88:91]
    ds_read_b64_tr_b16 v[134:135], v5 offset:4000
    v_mfma_f32_16x16x32_bf16 v[28:31], v[184:187], v[204:207], v[28:31]
    ds_read_b128 v[168:171], v3 offset:0
    v_mfma_f32_16x16x32_bf16 v[60:63], v[184:187], v[208:211], v[60:63]
    ds_read_b64_tr_b16 v[136:137], v5 offset:200
    v_mfma_f32_16x16x32_bf16 v[92:95], v[184:187], v[212:215], v[92:95]
    ds_read_b64_tr_b16 v[138:139], v5 offset:4040
    v_mfma_f32_16x16x32_bf16 v[112:115], v[184:187], v[216:219], v[112:115]
    ds_read_b64_tr_b16 v[140:141], v6 offset:0
    v_mfma_f32_16x16x32_bf16 v[32:35], v[188:191], v[204:207], v[32:35]
    ds_read_b64_tr_b16 v[142:143], v6 offset:3840
    v_mfma_f32_16x16x32_bf16 v[64:67], v[188:191], v[208:211], v[64:67]
    ds_read_b64_tr_b16 v[144:145], v5 offset:320
    v_mfma_f32_16x16x32_bf16 v[96:99], v[188:191], v[212:215], v[96:99]
    ds_read_b64_tr_b16 v[146:147], v5 offset:4160
    v_mfma_f32_16x16x32_bf16 v[36:39], v[204:207], v[192:195], v[36:39]
    ds_read_b64_tr_b16 v[148:149], v5 offset:360
    v_mfma_f32_16x16x32_bf16 v[68:71], v[208:211], v[192:195], v[68:71]
    ds_read_b64_tr_b16 v[150:151], v5 offset:4200
    v_mfma_f32_16x16x32_bf16 v[100:103], v[212:215], v[192:195], v[100:103]
    ds_read_b64_tr_b16 v[152:153], v7 offset:0
    v_mfma_f32_16x16x32_bf16 v[40:43], v[204:207], v[196:199], v[40:43]
    ds_read_b64_tr_b16 v[154:155], v7 offset:3840
    v_mfma_f32_16x16x32_bf16 v[72:75], v[208:211], v[196:199], v[72:75]
    v_mfma_f32_16x16x32_bf16 v[104:107], v[212:215], v[196:199], v[104:107]
    v_mfma_f32_16x16x32_bf16 v[116:119], v[216:219], v[196:199], v[116:119]
    v_mfma_f32_16x16x32_bf16 v[44:47], v[204:207], v[200:203], v[44:47]
    v_mfma_f32_16x16x32_bf16 v[76:79], v[208:211], v[200:203], v[76:79]
    v_mfma_f32_16x16x32_bf16 v[108:111], v[212:215], v[200:203], v[108:111]
    v_mfma_f32_16x16x32_bf16 v[120:123], v[216:219], v[200:203], v[120:123]
    s_waitcnt lgkmcnt(0)
    v_mfma_f32_16x16x32_bf16 v[16:19], v[124:127], v[156:159], v[16:19]
    ds_read_b128 v[204:207], v2 offset:0
    v_mfma_f32_16x16x32_bf16 v[48:51], v[124:127], v[160:163], v[48:51]
    ds_read_b128 v[208:211], v2 offset:2048
    v_mfma_f32_16x16x32_bf16 v[80:83], v[124:127], v[164:167], v[80:83]
    ds_read_b128 v[212:215], v2 offset:4096
    v_mfma_f32_16x16x32_bf16 v[20:23], v[128:131], v[156:159], v[20:23]
    ds_read_b64_tr_b16 v[172:173], v5 offset:15360
    v_mfma_f32_16x16x32_bf16 v[52:55], v[128:131], v[160:163], v[52:55]
    ds_read_b64_tr_b16 v[174:175], v5 offset:19200
    v_mfma_f32_16x16x32_bf16 v[84:87], v[128:131], v[164:167], v[84:87]
    ds_read_b64_tr_b16 v[176:177], v5 offset:15400
    v_mfma_f32_16x16x32_bf16 v[24:27], v[132:135], v[156:159], v[24:27]
    ds_read_b64_tr_b16 v[178:179], v5 offset:19240
    v_mfma_f32_16x16x32_bf16 v[56:59], v[132:135], v[160:163], v[56:59]
    ds_read_b64_tr_b16 v[180:181], v5 offset:15520
    v_mfma_f32_16x16x32_bf16 v[88:91], v[132:135], v[164:167], v[88:91]
    ds_read_b64_tr_b16 v[182:183], v5 offset:19360
    v_mfma_f32_16x16x32_bf16 v[28:31], v[136:139], v[156:159], v[28:31]
    ds_read_b128 v[216:219], v4 offset:0
    v_mfma_f32_16x16x32_bf16 v[60:63], v[136:139], v[160:163], v[60:63]
    ds_read_b64_tr_b16 v[184:185], v5 offset:15560
    v_mfma_f32_16x16x32_bf16 v[92:95], v[136:139], v[164:167], v[92:95]
    ds_read_b64_tr_b16 v[186:187], v5 offset:19400
    v_mfma_f32_16x16x32_bf16 v[112:115], v[136:139], v[168:171], v[112:115]
    ds_read_b64_tr_b16 v[188:189], v6 offset:15360
    v_mfma_f32_16x16x32_bf16 v[32:35], v[140:143], v[156:159], v[32:35]
    ds_read_b64_tr_b16 v[190:191], v6 offset:19200
    v_mfma_f32_16x16x32_bf16 v[64:67], v[140:143], v[160:163], v[64:67]
    ds_read_b64_tr_b16 v[192:193], v5 offset:15680
    v_mfma_f32_16x16x32_bf16 v[96:99], v[140:143], v[164:167], v[96:99]
    ds_read_b64_tr_b16 v[194:195], v5 offset:19520
    v_mfma_f32_16x16x32_bf16 v[36:39], v[156:159], v[144:147], v[36:39]
    ds_read_b64_tr_b16 v[196:197], v5 offset:15720
    v_mfma_f32_16x16x32_bf16 v[68:71], v[160:163], v[144:147], v[68:71]
    ds_read_b64_tr_b16 v[198:199], v5 offset:19560
    v_mfma_f32_16x16x32_bf16 v[100:103], v[164:167], v[144:147], v[100:103]
    ds_read_b64_tr_b16 v[200:201], v7 offset:15360
    v_mfma_f32_16x16x32_bf16 v[40:43], v[156:159], v[148:151], v[40:43]
    ds_read_b64_tr_b16 v[202:203], v7 offset:19200
    v_mfma_f32_16x16x32_bf16 v[72:75], v[160:163], v[148:151], v[72:75]
    v_add_u32 v1, s52, v1
    v_mfma_f32_16x16x32_bf16 v[104:107], v[164:167], v[148:151], v[104:107]
    v_add_u32 v2, s52, v2
    v_mfma_f32_16x16x32_bf16 v[116:119], v[168:171], v[148:151], v[116:119]
    v_add_u32 v3, s52, v3
    v_mfma_f32_16x16x32_bf16 v[44:47], v[156:159], v[152:155], v[44:47]
    v_add_u32 v4, s52, v4
    v_mfma_f32_16x16x32_bf16 v[76:79], v[160:163], v[152:155], v[76:79]
    v_add_u32 v5, s52, v5
    v_mfma_f32_16x16x32_bf16 v[108:111], v[164:167], v[152:155], v[108:111]
    v_add_u32 v6, s52, v6
    v_mfma_f32_16x16x32_bf16 v[120:123], v[168:171], v[152:155], v[120:123]
    v_add_u32 v7, s52, v7
    s_waitcnt lgkmcnt(0)
    s_barrier
    v_mfma_f32_16x16x32_bf16 v[16:19], v[172:175], v[204:207], v[16:19]
    ds_read_b128 v[156:159], v1 offset:0
    v_mfma_f32_16x16x32_bf16 v[48:51], v[172:175], v[208:211], v[48:51]
    ds_read_b128 v[160:163], v1 offset:2048
    v_mfma_f32_16x16x32_bf16 v[80:83], v[172:175], v[212:215], v[80:83]
    ds_read_b128 v[164:167], v1 offset:4096
    v_mfma_f32_16x16x32_bf16 v[20:23], v[176:179], v[204:207], v[20:23]
    ds_read_b64_tr_b16 v[124:125], v5 offset:0
    v_mfma_f32_16x16x32_bf16 v[52:55], v[176:179], v[208:211], v[52:55]
    ds_read_b64_tr_b16 v[126:127], v5 offset:3840
    v_mfma_f32_16x16x32_bf16 v[84:87], v[176:179], v[212:215], v[84:87]
    ds_read_b64_tr_b16 v[128:129], v5 offset:40
    v_mfma_f32_16x16x32_bf16 v[24:27], v[180:183], v[204:207], v[24:27]
    ds_read_b64_tr_b16 v[130:131], v5 offset:3880
    v_mfma_f32_16x16x32_bf16 v[56:59], v[180:183], v[208:211], v[56:59]
    ds_read_b64_tr_b16 v[132:133], v5 offset:160
    v_mfma_f32_16x16x32_bf16 v[88:91], v[180:183], v[212:215], v[88:91]
    ds_read_b64_tr_b16 v[134:135], v5 offset:4000
    v_mfma_f32_16x16x32_bf16 v[28:31], v[184:187], v[204:207], v[28:31]
    ds_read_b128 v[168:171], v3 offset:0
    v_mfma_f32_16x16x32_bf16 v[60:63], v[184:187], v[208:211], v[60:63]
    ds_read_b64_tr_b16 v[136:137], v5 offset:200
    v_mfma_f32_16x16x32_bf16 v[92:95], v[184:187], v[212:215], v[92:95]
    ds_read_b64_tr_b16 v[138:139], v5 offset:4040
    v_mfma_f32_16x16x32_bf16 v[112:115], v[184:187], v[216:219], v[112:115]
    ds_read_b64_tr_b16 v[140:141], v6 offset:0
    v_mfma_f32_16x16x32_bf16 v[32:35], v[188:191], v[204:207], v[32:35]
    ds_read_b64_tr_b16 v[142:143], v6 offset:3840
    v_mfma_f32_16x16x32_bf16 v[64:67], v[188:191], v[208:211], v[64:67]
    ds_read_b64_tr_b16 v[144:145], v5 offset:320
    v_mfma_f32_16x16x32_bf16 v[96:99], v[188:191], v[212:215], v[96:99]
    ds_read_b64_tr_b16 v[146:147], v5 offset:4160
    v_mfma_f32_16x16x32_bf16 v[36:39], v[204:207], v[192:195], v[36:39]
    ds_read_b64_tr_b16 v[148:149], v5 offset:360
    v_mfma_f32_16x16x32_bf16 v[68:71], v[208:211], v[192:195], v[68:71]
    ds_read_b64_tr_b16 v[150:151], v5 offset:4200
    v_mfma_f32_16x16x32_bf16 v[100:103], v[212:215], v[192:195], v[100:103]
    ds_read_b64_tr_b16 v[152:153], v7 offset:0
    v_mfma_f32_16x16x32_bf16 v[40:43], v[204:207], v[196:199], v[40:43]
    ds_read_b64_tr_b16 v[154:155], v7 offset:3840
    v_mfma_f32_16x16x32_bf16 v[72:75], v[208:211], v[196:199], v[72:75]
    v_mfma_f32_16x16x32_bf16 v[104:107], v[212:215], v[196:199], v[104:107]
    v_mfma_f32_16x16x32_bf16 v[116:119], v[216:219], v[196:199], v[116:119]
    v_mfma_f32_16x16x32_bf16 v[44:47], v[204:207], v[200:203], v[44:47]
    v_mfma_f32_16x16x32_bf16 v[76:79], v[208:211], v[200:203], v[76:79]
    v_mfma_f32_16x16x32_bf16 v[108:111], v[212:215], v[200:203], v[108:111]
    v_mfma_f32_16x16x32_bf16 v[120:123], v[216:219], v[200:203], v[120:123]
    s_waitcnt lgkmcnt(0)
    v_mfma_f32_16x16x32_bf16 v[16:19], v[124:127], v[156:159], v[16:19]
    ds_read_b128 v[204:207], v2 offset:0
    v_mfma_f32_16x16x32_bf16 v[48:51], v[124:127], v[160:163], v[48:51]
    ds_read_b128 v[208:211], v2 offset:2048
    v_mfma_f32_16x16x32_bf16 v[80:83], v[124:127], v[164:167], v[80:83]
    ds_read_b128 v[212:215], v2 offset:4096
    v_mfma_f32_16x16x32_bf16 v[20:23], v[128:131], v[156:159], v[20:23]
    ds_read_b64_tr_b16 v[172:173], v5 offset:15360
    v_mfma_f32_16x16x32_bf16 v[52:55], v[128:131], v[160:163], v[52:55]
    ds_read_b64_tr_b16 v[174:175], v5 offset:19200
    v_mfma_f32_16x16x32_bf16 v[84:87], v[128:131], v[164:167], v[84:87]
    ds_read_b64_tr_b16 v[176:177], v5 offset:15400
    v_mfma_f32_16x16x32_bf16 v[24:27], v[132:135], v[156:159], v[24:27]
    ds_read_b64_tr_b16 v[178:179], v5 offset:19240
    v_mfma_f32_16x16x32_bf16 v[56:59], v[132:135], v[160:163], v[56:59]
    ds_read_b64_tr_b16 v[180:181], v5 offset:15520
    v_mfma_f32_16x16x32_bf16 v[88:91], v[132:135], v[164:167], v[88:91]
    ds_read_b64_tr_b16 v[182:183], v5 offset:19360
    v_mfma_f32_16x16x32_bf16 v[28:31], v[136:139], v[156:159], v[28:31]
    ds_read_b128 v[216:219], v4 offset:0
    v_mfma_f32_16x16x32_bf16 v[60:63], v[136:139], v[160:163], v[60:63]
    ds_read_b64_tr_b16 v[184:185], v5 offset:15560
    v_mfma_f32_16x16x32_bf16 v[92:95], v[136:139], v[164:167], v[92:95]
    ds_read_b64_tr_b16 v[186:187], v5 offset:19400
    v_mfma_f32_16x16x32_bf16 v[112:115], v[136:139], v[168:171], v[112:115]
    ds_read_b64_tr_b16 v[188:189], v6 offset:15360
    v_mfma_f32_16x16x32_bf16 v[32:35], v[140:143], v[156:159], v[32:35]
    ds_read_b64_tr_b16 v[190:191], v6 offset:19200
    v_mfma_f32_16x16x32_bf16 v[64:67], v[140:143], v[160:163], v[64:67]
    ds_read_b64_tr_b16 v[192:193], v5 offset:15680
    v_mfma_f32_16x16x32_bf16 v[96:99], v[140:143], v[164:167], v[96:99]
    ds_read_b64_tr_b16 v[194:195], v5 offset:19520
    v_mfma_f32_16x16x32_bf16 v[36:39], v[156:159], v[144:147], v[36:39]
    ds_read_b64_tr_b16 v[196:197], v5 offset:15720
    v_mfma_f32_16x16x32_bf16 v[68:71], v[160:163], v[144:147], v[68:71]
    ds_read_b64_tr_b16 v[198:199], v5 offset:19560
    v_mfma_f32_16x16x32_bf16 v[100:103], v[164:167], v[144:147], v[100:103]
    ds_read_b64_tr_b16 v[200:201], v7 offset:15360
    v_mfma_f32_16x16x32_bf16 v[40:43], v[156:159], v[148:151], v[40:43]
    ds_read_b64_tr_b16 v[202:203], v7 offset:19200
    v_mfma_f32_16x16x32_bf16 v[72:75], v[160:163], v[148:151], v[72:75]
    v_add_u32 v1, s52, v1
    v_mfma_f32_16x16x32_bf16 v[104:107], v[164:167], v[148:151], v[104:107]
    v_add_u32 v2, s52, v2
    v_mfma_f32_16x16x32_bf16 v[116:119], v[168:171], v[148:151], v[116:119]
    v_add_u32 v3, s52, v3
    v_mfma_f32_16x16x32_bf16 v[44:47], v[156:159], v[152:155], v[44:47]
    v_add_u32 v4, s52, v4
    v_mfma_f32_16x16x32_bf16 v[76:79], v[160:163], v[152:155], v[76:79]
    v_add_u32 v5, s52, v5
    v_mfma_f32_16x16x32_bf16 v[108:111], v[164:167], v[152:155], v[108:111]
    v_add_u32 v6, s52, v6
    v_mfma_f32_16x16x32_bf16 v[120:123], v[168:171], v[152:155], v[120:123]
    v_add_u32 v7, s52, v7
    s_waitcnt lgkmcnt(0)
    s_barrier
    v_mfma_f32_16x16x32_bf16 v[16:19], v[172:175], v[204:207], v[16:19]
    ds_read_b128 v[156:159], v1 offset:0
    v_mfma_f32_16x16x32_bf16 v[48:51], v[172:175], v[208:211], v[48:51]
    ds_read_b128 v[160:163], v1 offset:2048
    v_mfma_f32_16x16x32_bf16 v[80:83], v[172:175], v[212:215], v[80:83]
    ds_read_b128 v[164:167], v1 offset:4096
    v_mfma_f32_16x16x32_bf16 v[20:23], v[176:179], v[204:207], v[20:23]
    ds_read_b64_tr_b16 v[124:125], v5 offset:0
    v_mfma_f32_16x16x32_bf16 v[52:55], v[176:179], v[208:211], v[52:55]
    ds_read_b64_tr_b16 v[126:127], v5 offset:3840
    v_mfma_f32_16x16x32_bf16 v[84:87], v[176:179], v[212:215], v[84:87]
    ds_read_b64_tr_b16 v[128:129], v5 offset:40
    v_mfma_f32_16x16x32_bf16 v[24:27], v[180:183], v[204:207], v[24:27]
    ds_read_b64_tr_b16 v[130:131], v5 offset:3880
    v_mfma_f32_16x16x32_bf16 v[56:59], v[180:183], v[208:211], v[56:59]
    ds_read_b64_tr_b16 v[132:133], v5 offset:160
    v_mfma_f32_16x16x32_bf16 v[88:91], v[180:183], v[212:215], v[88:91]
    ds_read_b64_tr_b16 v[134:135], v5 offset:4000
    v_mfma_f32_16x16x32_bf16 v[28:31], v[184:187], v[204:207], v[28:31]
    ds_read_b128 v[168:171], v3 offset:0
    v_mfma_f32_16x16x32_bf16 v[60:63], v[184:187], v[208:211], v[60:63]
    ds_read_b64_tr_b16 v[136:137], v5 offset:200
    v_mfma_f32_16x16x32_bf16 v[92:95], v[184:187], v[212:215], v[92:95]
    ds_read_b64_tr_b16 v[138:139], v5 offset:4040
    v_mfma_f32_16x16x32_bf16 v[112:115], v[184:187], v[216:219], v[112:115]
    ds_read_b64_tr_b16 v[140:141], v6 offset:0
    v_mfma_f32_16x16x32_bf16 v[32:35], v[188:191], v[204:207], v[32:35]
    ds_read_b64_tr_b16 v[142:143], v6 offset:3840
    v_mfma_f32_16x16x32_bf16 v[64:67], v[188:191], v[208:211], v[64:67]
    ds_read_b64_tr_b16 v[144:145], v5 offset:320
    v_mfma_f32_16x16x32_bf16 v[96:99], v[188:191], v[212:215], v[96:99]
    ds_read_b64_tr_b16 v[146:147], v5 offset:4160
    v_mfma_f32_16x16x32_bf16 v[36:39], v[204:207], v[192:195], v[36:39]
    ds_read_b64_tr_b16 v[148:149], v5 offset:360
    v_mfma_f32_16x16x32_bf16 v[68:71], v[208:211], v[192:195], v[68:71]
    ds_read_b64_tr_b16 v[150:151], v5 offset:4200
    v_mfma_f32_16x16x32_bf16 v[100:103], v[212:215], v[192:195], v[100:103]
    ds_read_b64_tr_b16 v[152:153], v7 offset:0
    v_mfma_f32_16x16x32_bf16 v[40:43], v[204:207], v[196:199], v[40:43]
    ds_read_b64_tr_b16 v[154:155], v7 offset:3840
    v_mfma_f32_16x16x32_bf16 v[72:75], v[208:211], v[196:199], v[72:75]
    v_mfma_f32_16x16x32_bf16 v[104:107], v[212:215], v[196:199], v[104:107]
    v_mfma_f32_16x16x32_bf16 v[116:119], v[216:219], v[196:199], v[116:119]
    v_mfma_f32_16x16x32_bf16 v[44:47], v[204:207], v[200:203], v[44:47]
    v_mfma_f32_16x16x32_bf16 v[76:79], v[208:211], v[200:203], v[76:79]
    v_mfma_f32_16x16x32_bf16 v[108:111], v[212:215], v[200:203], v[108:111]
    v_mfma_f32_16x16x32_bf16 v[120:123], v[216:219], v[200:203], v[120:123]
    s_waitcnt lgkmcnt(0)
    v_mfma_f32_16x16x32_bf16 v[16:19], v[124:127], v[156:159], v[16:19]
    ds_read_b128 v[204:207], v2 offset:0
    v_mfma_f32_16x16x32_bf16 v[48:51], v[124:127], v[160:163], v[48:51]
    ds_read_b128 v[208:211], v2 offset:2048
    v_mfma_f32_16x16x32_bf16 v[80:83], v[124:127], v[164:167], v[80:83]
    ds_read_b128 v[212:215], v2 offset:4096
    v_mfma_f32_16x16x32_bf16 v[20:23], v[128:131], v[156:159], v[20:23]
    ds_read_b64_tr_b16 v[172:173], v5 offset:15360
    v_mfma_f32_16x16x32_bf16 v[52:55], v[128:131], v[160:163], v[52:55]
    ds_read_b64_tr_b16 v[174:175], v5 offset:19200
    v_mfma_f32_16x16x32_bf16 v[84:87], v[128:131], v[164:167], v[84:87]
    ds_read_b64_tr_b16 v[176:177], v5 offset:15400
    v_mfma_f32_16x16x32_bf16 v[24:27], v[132:135], v[156:159], v[24:27]
    ds_read_b64_tr_b16 v[178:179], v5 offset:19240
    v_mfma_f32_16x16x32_bf16 v[56:59], v[132:135], v[160:163], v[56:59]
    ds_read_b64_tr_b16 v[180:181], v5 offset:15520
    v_mfma_f32_16x16x32_bf16 v[88:91], v[132:135], v[164:167], v[88:91]
    ds_read_b64_tr_b16 v[182:183], v5 offset:19360
    v_mfma_f32_16x16x32_bf16 v[28:31], v[136:139], v[156:159], v[28:31]
    ds_read_b128 v[216:219], v4 offset:0
    v_mfma_f32_16x16x32_bf16 v[60:63], v[136:139], v[160:163], v[60:63]
    ds_read_b64_tr_b16 v[184:185], v5 offset:15560
    v_mfma_f32_16x16x32_bf16 v[92:95], v[136:139], v[164:167], v[92:95]
    ds_read_b64_tr_b16 v[186:187], v5 offset:19400
    v_mfma_f32_16x16x32_bf16 v[112:115], v[136:139], v[168:171], v[112:115]
    ds_read_b64_tr_b16 v[188:189], v6 offset:15360
    v_mfma_f32_16x16x32_bf16 v[32:35], v[140:143], v[156:159], v[32:35]
    ds_read_b64_tr_b16 v[190:191], v6 offset:19200
    v_mfma_f32_16x16x32_bf16 v[64:67], v[140:143], v[160:163], v[64:67]
    ds_read_b64_tr_b16 v[192:193], v5 offset:15680
    v_mfma_f32_16x16x32_bf16 v[96:99], v[140:143], v[164:167], v[96:99]
    ds_read_b64_tr_b16 v[194:195], v5 offset:19520
    v_mfma_f32_16x16x32_bf16 v[36:39], v[156:159], v[144:147], v[36:39]
    ds_read_b64_tr_b16 v[196:197], v5 offset:15720
    v_mfma_f32_16x16x32_bf16 v[68:71], v[160:163], v[144:147], v[68:71]
    ds_read_b64_tr_b16 v[198:199], v5 offset:19560
    v_mfma_f32_16x16x32_bf16 v[100:103], v[164:167], v[144:147], v[100:103]
    ds_read_b64_tr_b16 v[200:201], v7 offset:15360
    v_mfma_f32_16x16x32_bf16 v[40:43], v[156:159], v[148:151], v[40:43]
    ds_read_b64_tr_b16 v[202:203], v7 offset:19200
    v_mfma_f32_16x16x32_bf16 v[72:75], v[160:163], v[148:151], v[72:75]
    v_add_u32 v1, s53, v1
    v_mfma_f32_16x16x32_bf16 v[104:107], v[164:167], v[148:151], v[104:107]
    v_add_u32 v2, s53, v2
    v_mfma_f32_16x16x32_bf16 v[116:119], v[168:171], v[148:151], v[116:119]
    v_add_u32 v3, s53, v3
    v_mfma_f32_16x16x32_bf16 v[44:47], v[156:159], v[152:155], v[44:47]
    v_add_u32 v4, s53, v4
    v_mfma_f32_16x16x32_bf16 v[76:79], v[160:163], v[152:155], v[76:79]
    v_add_u32 v5, s53, v5
    v_mfma_f32_16x16x32_bf16 v[108:111], v[164:167], v[152:155], v[108:111]
    v_add_u32 v6, s53, v6
    v_mfma_f32_16x16x32_bf16 v[120:123], v[168:171], v[152:155], v[120:123]
    v_add_u32 v7, s53, v7
    s_waitcnt lgkmcnt(0)
    s_barrier
    v_mfma_f32_16x16x32_bf16 v[16:19], v[172:175], v[204:207], v[16:19]
    ds_read_b128 v[156:159], v1 offset:0
    v_mfma_f32_16x16x32_bf16 v[48:51], v[172:175], v[208:211], v[48:51]
    ds_read_b128 v[160:163], v1 offset:2048
    v_mfma_f32_16x16x32_bf16 v[80:83], v[172:175], v[212:215], v[80:83]
    ds_read_b128 v[164:167], v1 offset:4096
    v_mfma_f32_16x16x32_bf16 v[20:23], v[176:179], v[204:207], v[20:23]
    ds_read_b64_tr_b16 v[124:125], v5 offset:0
    v_mfma_f32_16x16x32_bf16 v[52:55], v[176:179], v[208:211], v[52:55]
    ds_read_b64_tr_b16 v[126:127], v5 offset:3840
    v_mfma_f32_16x16x32_bf16 v[84:87], v[176:179], v[212:215], v[84:87]
    ds_read_b64_tr_b16 v[128:129], v5 offset:40
    v_mfma_f32_16x16x32_bf16 v[24:27], v[180:183], v[204:207], v[24:27]
    ds_read_b64_tr_b16 v[130:131], v5 offset:3880
    v_mfma_f32_16x16x32_bf16 v[56:59], v[180:183], v[208:211], v[56:59]
    ds_read_b64_tr_b16 v[132:133], v5 offset:160
    v_mfma_f32_16x16x32_bf16 v[88:91], v[180:183], v[212:215], v[88:91]
    ds_read_b64_tr_b16 v[134:135], v5 offset:4000
    v_mfma_f32_16x16x32_bf16 v[28:31], v[184:187], v[204:207], v[28:31]
    ds_read_b128 v[168:171], v3 offset:0
    v_mfma_f32_16x16x32_bf16 v[60:63], v[184:187], v[208:211], v[60:63]
    ds_read_b64_tr_b16 v[136:137], v5 offset:200
    v_mfma_f32_16x16x32_bf16 v[92:95], v[184:187], v[212:215], v[92:95]
    ds_read_b64_tr_b16 v[138:139], v5 offset:4040
    v_mfma_f32_16x16x32_bf16 v[112:115], v[184:187], v[216:219], v[112:115]
    ds_read_b64_tr_b16 v[140:141], v6 offset:0
    v_mfma_f32_16x16x32_bf16 v[32:35], v[188:191], v[204:207], v[32:35]
    ds_read_b64_tr_b16 v[142:143], v6 offset:3840
    v_mfma_f32_16x16x32_bf16 v[64:67], v[188:191], v[208:211], v[64:67]
    ds_read_b64_tr_b16 v[144:145], v5 offset:320
    v_mfma_f32_16x16x32_bf16 v[96:99], v[188:191], v[212:215], v[96:99]
    ds_read_b64_tr_b16 v[146:147], v5 offset:4160
    v_mfma_f32_16x16x32_bf16 v[36:39], v[204:207], v[192:195], v[36:39]
    ds_read_b64_tr_b16 v[148:149], v5 offset:360
    v_mfma_f32_16x16x32_bf16 v[68:71], v[208:211], v[192:195], v[68:71]
    ds_read_b64_tr_b16 v[150:151], v5 offset:4200
    v_mfma_f32_16x16x32_bf16 v[100:103], v[212:215], v[192:195], v[100:103]
    ds_read_b64_tr_b16 v[152:153], v7 offset:0
    v_mfma_f32_16x16x32_bf16 v[40:43], v[204:207], v[196:199], v[40:43]
    ds_read_b64_tr_b16 v[154:155], v7 offset:3840
    v_mfma_f32_16x16x32_bf16 v[72:75], v[208:211], v[196:199], v[72:75]
    v_mfma_f32_16x16x32_bf16 v[104:107], v[212:215], v[196:199], v[104:107]
    v_mfma_f32_16x16x32_bf16 v[116:119], v[216:219], v[196:199], v[116:119]
    v_mfma_f32_16x16x32_bf16 v[44:47], v[204:207], v[200:203], v[44:47]
    v_mfma_f32_16x16x32_bf16 v[76:79], v[208:211], v[200:203], v[76:79]
    v_mfma_f32_16x16x32_bf16 v[108:111], v[212:215], v[200:203], v[108:111]
    v_mfma_f32_16x16x32_bf16 v[120:123], v[216:219], v[200:203], v[120:123]
    s_waitcnt lgkmcnt(0)
    v_mfma_f32_16x16x32_bf16 v[16:19], v[124:127], v[156:159], v[16:19]
    ds_read_b128 v[204:207], v2 offset:0
    v_mfma_f32_16x16x32_bf16 v[48:51], v[124:127], v[160:163], v[48:51]
    ds_read_b128 v[208:211], v2 offset:2048
    v_mfma_f32_16x16x32_bf16 v[80:83], v[124:127], v[164:167], v[80:83]
    ds_read_b128 v[212:215], v2 offset:4096
    v_mfma_f32_16x16x32_bf16 v[20:23], v[128:131], v[156:159], v[20:23]
    ds_read_b64_tr_b16 v[172:173], v5 offset:15360
    v_mfma_f32_16x16x32_bf16 v[52:55], v[128:131], v[160:163], v[52:55]
    ds_read_b64_tr_b16 v[174:175], v5 offset:19200
    v_mfma_f32_16x16x32_bf16 v[84:87], v[128:131], v[164:167], v[84:87]
    ds_read_b64_tr_b16 v[176:177], v5 offset:15400
    v_mfma_f32_16x16x32_bf16 v[24:27], v[132:135], v[156:159], v[24:27]
    ds_read_b64_tr_b16 v[178:179], v5 offset:19240
    v_mfma_f32_16x16x32_bf16 v[56:59], v[132:135], v[160:163], v[56:59]
    ds_read_b64_tr_b16 v[180:181], v5 offset:15520
    v_mfma_f32_16x16x32_bf16 v[88:91], v[132:135], v[164:167], v[88:91]
    ds_read_b64_tr_b16 v[182:183], v5 offset:19360
    v_mfma_f32_16x16x32_bf16 v[28:31], v[136:139], v[156:159], v[28:31]
    ds_read_b128 v[216:219], v4 offset:0
    v_mfma_f32_16x16x32_bf16 v[60:63], v[136:139], v[160:163], v[60:63]
    ds_read_b64_tr_b16 v[184:185], v5 offset:15560
    v_mfma_f32_16x16x32_bf16 v[92:95], v[136:139], v[164:167], v[92:95]
    ds_read_b64_tr_b16 v[186:187], v5 offset:19400
    v_mfma_f32_16x16x32_bf16 v[112:115], v[136:139], v[168:171], v[112:115]
    ds_read_b64_tr_b16 v[188:189], v6 offset:15360
    v_mfma_f32_16x16x32_bf16 v[32:35], v[140:143], v[156:159], v[32:35]
    ds_read_b64_tr_b16 v[190:191], v6 offset:19200
    v_mfma_f32_16x16x32_bf16 v[64:67], v[140:143], v[160:163], v[64:67]
    ds_read_b64_tr_b16 v[192:193], v5 offset:15680
    v_mfma_f32_16x16x32_bf16 v[96:99], v[140:143], v[164:167], v[96:99]
    ds_read_b64_tr_b16 v[194:195], v5 offset:19520
    v_mfma_f32_16x16x32_bf16 v[36:39], v[156:159], v[144:147], v[36:39]
    ds_read_b64_tr_b16 v[196:197], v5 offset:15720
    v_mfma_f32_16x16x32_bf16 v[68:71], v[160:163], v[144:147], v[68:71]
    ds_read_b64_tr_b16 v[198:199], v5 offset:19560
    v_mfma_f32_16x16x32_bf16 v[100:103], v[164:167], v[144:147], v[100:103]
    ds_read_b64_tr_b16 v[200:201], v7 offset:15360
    v_mfma_f32_16x16x32_bf16 v[40:43], v[156:159], v[148:151], v[40:43]
    ds_read_b64_tr_b16 v[202:203], v7 offset:19200
    v_mfma_f32_16x16x32_bf16 v[72:75], v[160:163], v[148:151], v[72:75]
    v_mfma_f32_16x16x32_bf16 v[104:107], v[164:167], v[148:151], v[104:107]
    v_mfma_f32_16x16x32_bf16 v[116:119], v[168:171], v[148:151], v[116:119]
    v_mfma_f32_16x16x32_bf16 v[44:47], v[156:159], v[152:155], v[44:47]
    v_mfma_f32_16x16x32_bf16 v[76:79], v[160:163], v[152:155], v[76:79]
    v_mfma_f32_16x16x32_bf16 v[108:111], v[164:167], v[152:155], v[108:111]
    v_mfma_f32_16x16x32_bf16 v[120:123], v[168:171], v[152:155], v[120:123]
    s_waitcnt lgkmcnt(0)
    s_barrier
    v_mfma_f32_16x16x32_bf16 v[16:19], v[172:175], v[204:207], v[16:19]
    v_mfma_f32_16x16x32_bf16 v[48:51], v[172:175], v[208:211], v[48:51]
    v_mfma_f32_16x16x32_bf16 v[80:83], v[172:175], v[212:215], v[80:83]
    v_mfma_f32_16x16x32_bf16 v[20:23], v[176:179], v[204:207], v[20:23]
    v_mfma_f32_16x16x32_bf16 v[52:55], v[176:179], v[208:211], v[52:55]
    v_mfma_f32_16x16x32_bf16 v[84:87], v[176:179], v[212:215], v[84:87]
    v_mfma_f32_16x16x32_bf16 v[24:27], v[180:183], v[204:207], v[24:27]
    v_mfma_f32_16x16x32_bf16 v[56:59], v[180:183], v[208:211], v[56:59]
    v_mfma_f32_16x16x32_bf16 v[88:91], v[180:183], v[212:215], v[88:91]
    v_mfma_f32_16x16x32_bf16 v[28:31], v[184:187], v[204:207], v[28:31]
    v_mfma_f32_16x16x32_bf16 v[60:63], v[184:187], v[208:211], v[60:63]
    v_mfma_f32_16x16x32_bf16 v[92:95], v[184:187], v[212:215], v[92:95]
    v_mfma_f32_16x16x32_bf16 v[112:115], v[184:187], v[216:219], v[112:115]
    v_mfma_f32_16x16x32_bf16 v[32:35], v[188:191], v[204:207], v[32:35]
    v_mfma_f32_16x16x32_bf16 v[64:67], v[188:191], v[208:211], v[64:67]
    v_mfma_f32_16x16x32_bf16 v[96:99], v[188:191], v[212:215], v[96:99]
    v_mfma_f32_16x16x32_bf16 v[36:39], v[204:207], v[192:195], v[36:39]
    v_mfma_f32_16x16x32_bf16 v[68:71], v[208:211], v[192:195], v[68:71]
    v_mfma_f32_16x16x32_bf16 v[100:103], v[212:215], v[192:195], v[100:103]
    v_mfma_f32_16x16x32_bf16 v[40:43], v[204:207], v[196:199], v[40:43]
    v_mfma_f32_16x16x32_bf16 v[72:75], v[208:211], v[196:199], v[72:75]
    v_mfma_f32_16x16x32_bf16 v[104:107], v[212:215], v[196:199], v[104:107]
    v_mfma_f32_16x16x32_bf16 v[116:119], v[216:219], v[196:199], v[116:119]
    v_mfma_f32_16x16x32_bf16 v[44:47], v[204:207], v[200:203], v[44:47]
    v_mfma_f32_16x16x32_bf16 v[76:79], v[208:211], v[200:203], v[76:79]
    v_mfma_f32_16x16x32_bf16 v[108:111], v[212:215], v[200:203], v[108:111]
    v_mfma_f32_16x16x32_bf16 v[120:123], v[216:219], v[200:203], v[120:123]
    s_nop 5
    v_cvt_pk_bf16_f32 v214, v112, v113
    v_cvt_pk_bf16_f32 v215, v114, v115
    v_cvt_pk_bf16_f32 v216, v116, v117
    v_cvt_pk_bf16_f32 v217, v118, v119
    v_cvt_pk_bf16_f32 v218, v120, v121
    v_cvt_pk_bf16_f32 v219, v122, v123
    ds_write_b64 v12, v[214:215] offset:1024
    ds_write_b64 v12, v[216:217] offset:2048
    ds_write_b64 v12, v[218:219] offset:2560
    v_add_u32 v12, 3072, v12
    v_cvt_pk_bf16_f32 v132, v24, v25
    v_cvt_pk_bf16_f32 v133, v26, v27
    v_cvt_pk_bf16_f32 v136, v28, v29
    v_cvt_pk_bf16_f32 v137, v30, v31
    v_cvt_pk_bf16_f32 v158, v36, v37
    v_cvt_pk_bf16_f32 v159, v38, v39
    v_cvt_pk_bf16_f32 v166, v40, v41
    v_cvt_pk_bf16_f32 v167, v42, v43
    v_cvt_pk_bf16_f32 v174, v44, v45
    v_cvt_pk_bf16_f32 v175, v46, v47
    v_cvt_pk_bf16_f32 v208, v32, v33
    v_cvt_pk_bf16_f32 v209, v34, v35
    v_mov_b32 v134, 0
    v_mov_b32 v135, 0
    v_cvt_pk_bf16_f32 v140, v56, v57
    v_cvt_pk_bf16_f32 v141, v58, v59
    v_cvt_pk_bf16_f32 v144, v60, v61
    v_cvt_pk_bf16_f32 v145, v62, v63
    v_cvt_pk_bf16_f32 v160, v68, v69
    v_cvt_pk_bf16_f32 v161, v70, v71
    v_cvt_pk_bf16_f32 v168, v72, v73
    v_cvt_pk_bf16_f32 v169, v74, v75
    v_cvt_pk_bf16_f32 v176, v76, v77
    v_cvt_pk_bf16_f32 v177, v78, v79
    v_cvt_pk_bf16_f32 v210, v64, v65
    v_cvt_pk_bf16_f32 v211, v66, v67
    v_mov_b32 v142, 0
    v_mov_b32 v143, 0
    v_cvt_pk_bf16_f32 v148, v88, v89
    v_cvt_pk_bf16_f32 v149, v90, v91
    v_cvt_pk_bf16_f32 v152, v92, v93
    v_cvt_pk_bf16_f32 v153, v94, v95
    v_cvt_pk_bf16_f32 v162, v100, v101
    v_cvt_pk_bf16_f32 v163, v102, v103
    v_cvt_pk_bf16_f32 v170, v104, v105
    v_cvt_pk_bf16_f32 v171, v106, v107
    v_cvt_pk_bf16_f32 v178, v108, v109
    v_cvt_pk_bf16_f32 v179, v110, v111
    v_cvt_pk_bf16_f32 v212, v96, v97
    v_cvt_pk_bf16_f32 v213, v98, v99
    v_mov_b32 v150, 0
    v_mov_b32 v151, 0
    v_cvt_pk_bf16_f32 v180, v16, v17
    v_cvt_pk_bf16_f32 v181, v18, v19
    v_cvt_pk_bf16_f32 v186, v20, v21
    v_cvt_pk_bf16_f32 v187, v22, v23
    v_cvt_pk_bf16_f32 v188, v48, v49
    v_cvt_pk_bf16_f32 v189, v50, v51
    v_cvt_pk_bf16_f32 v194, v52, v53
    v_cvt_pk_bf16_f32 v195, v54, v55
    v_cvt_pk_bf16_f32 v196, v80, v81
    v_cvt_pk_bf16_f32 v197, v82, v83
    v_cvt_pk_bf16_f32 v202, v84, v85
    v_cvt_pk_bf16_f32 v203, v86, v87
    v_permlane32_swap_b32 v208, v134
    v_permlane32_swap_b32 v209, v135
    v_permlane32_swap_b32 v210, v142
    v_permlane32_swap_b32 v211, v143
    v_permlane32_swap_b32 v212, v150
    v_permlane32_swap_b32 v213, v151
AC_ATT_1:
    s_mov_b64 s[58:59], 0xffff
    s_mov_b32 s60, 0xffff0000
    s_mov_b32 s61, 0
    v_cndmask_b32 v182, 0, v208, s[58:59]
    v_cndmask_b32 v184, 0, v208, s[60:61]
    v_cndmask_b32 v183, 0, v209, s[58:59]
    v_cndmask_b32 v185, 0, v209, s[60:61]
    v_cndmask_b32 v190, 0, v210, s[58:59]
    v_cndmask_b32 v192, 0, v210, s[60:61]
    v_cndmask_b32 v191, 0, v211, s[58:59]
    v_cndmask_b32 v193, 0, v211, s[60:61]
    v_cndmask_b32 v198, 0, v212, s[58:59]
    v_cndmask_b32 v200, 0, v212, s[60:61]
    v_cndmask_b32 v199, 0, v213, s[58:59]
    v_cndmask_b32 v201, 0, v213, s[60:61]
    s_waitcnt lgkmcnt(0)
    s_barrier
    ds_read_b64 v[124:125], v12 offset:0
    ds_read_b64 v[126:127], v12 offset:512
    ds_read_b64 v[128:129], v12 offset:1024
    ds_read_b64 v[156:157], v12 offset:1536
    ds_read_b64 v[164:165], v12 offset:2048
    ds_read_b64 v[172:173], v12 offset:2560
    v_mfma_f32_16x16x32_bf16 v[20:23], v[132:135], v[180:183], v[228:231]
    v_mfma_f32_16x16x32_bf16 v[28:31], v[134:137], v[184:187], v[228:231]
    v_mfma_f32_16x16x32_bf16 v[36:39], v[140:143], v[188:191], v[228:231]
    v_mfma_f32_16x16x32_bf16 v[44:47], v[142:145], v[192:195], v[228:231]
    v_mfma_f32_16x16x32_bf16 v[52:55], v[148:151], v[196:199], v[228:231]
    v_mfma_f32_16x16x32_bf16 v[60:63], v[150:153], v[200:203], v[228:231]
    v_mfma_f32_16x16x32_bf16 v[32:35], v[132:135], v[188:191], v[224:227]
    v_mfma_f32_16x16x32_bf16 v[40:43], v[134:137], v[192:195], v[224:227]
    v_mfma_f32_16x16x32_bf16 v[48:51], v[140:143], v[196:199], v[224:227]
    v_mfma_f32_16x16x32_bf16 v[56:59], v[142:145], v[200:203], v[224:227]
    s_waitcnt lgkmcnt(0)
    v_mfma_f32_16x16x32_bf16 v[16:19], v[124:127], v[180:183], v[220:223]
    v_mfma_f32_16x16x32_bf16 v[24:27], v[126:129], v[184:187], v[220:223]
    s_nop 1
    v_max3_f32 v92, v36, v37, v38
    v_max3_f32 v93, v39, v32, v33
    v_max3_f32 v94, v44, v45, v46
    v_max3_f32 v95, v47, v40, v41
    v_max3_f32 v96, v52, v53, v54
    v_max3_f32 v97, v55, v48, v49
    v_max3_f32 v98, v60, v61, v62
    v_max3_f32 v99, v63, v56, v57
    v_max3_f32 v88, v20, v21, v22
    v_max3_f32 v89, v23, v16, v17
    v_max3_f32 v90, v28, v29, v30
    v_max3_f32 v91, v31, v24, v25
    v_max3_f32 v92, v92, v34, v35
    v_max3_f32 v94, v94, v42, v43
    v_max3_f32 v96, v96, v50, v51
    v_max3_f32 v98, v98, v58, v59
    v_max3_f32 v88, v88, v18, v19
    v_max3_f32 v90, v90, v26, v27
    v_max_f32 v92, v92, v93
    v_max_f32 v94, v94, v95
    v_max_f32 v96, v96, v97
    v_max_f32 v98, v98, v99
    v_max_f32 v88, v88, v89
    v_max_f32 v90, v90, v91
    v_mov_b32 v93, v92
    v_mov_b32 v95, v94
    v_mov_b32 v97, v96
    v_mov_b32 v99, v98
    v_mov_b32 v89, v88
    v_mov_b32 v91, v90
    v_permlane32_swap_b32 v92, v93
    v_permlane32_swap_b32 v94, v95
    v_permlane32_swap_b32 v96, v97
    v_permlane32_swap_b32 v98, v99
    v_permlane32_swap_b32 v88, v89
    v_permlane32_swap_b32 v90, v91
    v_max_f32 v92, v92, v93
    v_max_f32 v94, v94, v95
    v_max_f32 v96, v96, v97
    v_max_f32 v98, v98, v99
    v_max_f32 v88, v88, v89
    v_max_f32 v90, v90, v91
    v_mov_b32 v93, v92
    v_mov_b32 v95, v94
    v_mov_b32 v97, v96
    v_mov_b32 v99, v98
    v_mov_b32 v89, v88
    v_mov_b32 v91, v90
    v_permlane16_swap_b32 v92, v93
    v_permlane16_swap_b32 v94, v95
    v_permlane16_swap_b32 v96, v97
    v_permlane16_swap_b32 v98, v99
    v_permlane16_swap_b32 v88, v89
    v_permlane16_swap_b32 v90, v91
    v_max_f32 v92, v92, v93
    v_max_f32 v94, v94, v95
    v_max_f32 v96, v96, v97
    v_max_f32 v98, v98, v99
    v_max_f32 v88, v88, v89
    v_max_f32 v90, v90, v91
    s_mov_b32 s52, 0x3ea52b5c
    v_mul_f32 v92, s52, v92
    v_mul_f32 v94, s52, v94
    v_mul_f32 v96, s52, v96
    v_mul_f32 v98, s52, v98
    v_mul_f32 v88, s52, v88
    v_mul_f32 v90, s52, v90
    v_pk_fma_f32 v[32:33], v[32:33], s[52:53], v[92:93] op_sel_hi:[1,0,0] neg_lo:[0,0,1] neg_hi:[0,0,1]
    v_pk_fma_f32 v[34:35], v[34:35], s[52:53], v[92:93] op_sel_hi:[1,0,0] neg_lo:[0,0,1] neg_hi:[0,0,1]
    v_pk_fma_f32 v[36:37], v[36:37], s[52:53], v[92:93] op_sel_hi:[1,0,0] neg_lo:[0,0,1] neg_hi:[0,0,1]
    v_pk_fma_f32 v[38:39], v[38:39], s[52:53], v[92:93] op_sel_hi:[1,0,0] neg_lo:[0,0,1] neg_hi:[0,0,1]
    v_exp_f32 v32, v32
    v_exp_f32 v33, v33
    v_exp_f32 v34, v34
    v_exp_f32 v35, v35
    v_exp_f32 v36, v36
    v_exp_f32 v37, v37
    v_exp_f32 v38, v38
    v_exp_f32 v39, v39
    v_pk_fma_f32 v[40:41], v[40:41], s[52:53], v[94:95] op_sel_hi:[1,0,0] neg_lo:[0,0,1] neg_hi:[0,0,1]
    v_pk_fma_f32 v[42:43], v[42:43], s[52:53], v[94:95] op_sel_hi:[1,0,0] neg_lo:[0,0,1] neg_hi:[0,0,1]
    v_pk_fma_f32 v[44:45], v[44:45], s[52:53], v[94:95] op_sel_hi:[1,0,0] neg_lo:[0,0,1] neg_hi:[0,0,1]
    v_pk_fma_f32 v[46:47], v[46:47], s[52:53], v[94:95] op_sel_hi:[1,0,0] neg_lo:[0,0,1] neg_hi:[0,0,1]
    v_exp_f32 v40, v40
    v_exp_f32 v41, v41
    v_exp_f32 v42, v42
    v_exp_f32 v43, v43
    v_exp_f32 v44, v44
    v_exp_f32 v45, v45
    v_exp_f32 v46, v46
    v_exp_f32 v47, v47
    v_pk_fma_f32 v[48:49], v[48:49], s[52:53], v[96:97] op_sel_hi:[1,0,0] neg_lo:[0,0,1] neg_hi:[0,0,1]
    v_pk_fma_f32 v[50:51], v[50:51], s[52:53], v[96:97] op_sel_hi:[1,0,0] neg_lo:[0,0,1] neg_hi:[0,0,1]
    v_pk_fma_f32 v[52:53], v[52:53], s[52:53], v[96:97] op_sel_hi:[1,0,0] neg_lo:[0,0,1] neg_hi:[0,0,1]
    v_pk_fma_f32 v[54:55], v[54:55], s[52:53], v[96:97] op_sel_hi:[1,0,0] neg_lo:[0,0,1] neg_hi:[0,0,1]
    v_exp_f32 v48, v48
    v_exp_f32 v49, v49
    v_exp_f32 v50, v50
    v_exp_f32 v51, v51
    v_exp_f32 v52, v52
    v_exp_f32 v53, v53
    v_exp_f32 v54, v54
    v_exp_f32 v55, v55
    v_pk_fma_f32 v[56:57], v[56:57], s[52:53], v[98:99] op_sel_hi:[1,0,0] neg_lo:[0,0,1] neg_hi:[0,0,1]
    v_pk_fma_f32 v[58:59], v[58:59], s[52:53], v[98:99] op_sel_hi:[1,0,0] neg_lo:[0,0,1] neg_hi:[0,0,1]
    v_pk_fma_f32 v[60:61], v[60:61], s[52:53], v[98:99] op_sel_hi:[1,0,0] neg_lo:[0,0,1] neg_hi:[0,0,1]
    v_pk_fma_f32 v[62:63], v[62:63], s[52:53], v[98:99] op_sel_hi:[1,0,0] neg_lo:[0,0,1] neg_hi:[0,0,1]
    v_exp_f32 v56, v56
    v_exp_f32 v57, v57
    v_exp_f32 v58, v58
    v_exp_f32 v59, v59
    v_exp_f32 v60, v60
    v_exp_f32 v61, v61
    v_exp_f32 v62, v62
    v_exp_f32 v63, v63
    v_pk_fma_f32 v[16:17], v[16:17], s[52:53], v[88:89] op_sel_hi:[1,0,0] neg_lo:[0,0,1] neg_hi:[0,0,1]
    v_pk_fma_f32 v[18:19], v[18:19], s[52:53], v[88:89] op_sel_hi:[1,0,0] neg_lo:[0,0,1] neg_hi:[0,0,1]
    v_pk_fma_f32 v[20:21], v[20:21], s[52:53], v[88:89] op_sel_hi:[1,0,0] neg_lo:[0,0,1] neg_hi:[0,0,1]
    v_pk_fma_f32 v[22:23], v[22:23], s[52:53], v[88:89] op_sel_hi:[1,0,0] neg_lo:[0,0,1] neg_hi:[0,0,1]
    v_exp_f32 v16, v16
    v_exp_f32 v17, v17
    v_exp_f32 v18, v18
    v_exp_f32 v19, v19
    v_exp_f32 v20, v20
    v_exp_f32 v21, v21
    v_exp_f32 v22, v22
    v_exp_f32 v23, v23
    v_pk_fma_f32 v[24:25], v[24:25], s[52:53], v[90:91] op_sel_hi:[1,0,0] neg_lo:[0,0,1] neg_hi:[0,0,1]
    v_pk_fma_f32 v[26:27], v[26:27], s[52:53], v[90:91] op_sel_hi:[1,0,0] neg_lo:[0,0,1] neg_hi:[0,0,1]
    v_pk_fma_f32 v[28:29], v[28:29], s[52:53], v[90:91] op_sel_hi:[1,0,0] neg_lo:[0,0,1] neg_hi:[0,0,1]
    v_pk_fma_f32 v[30:31], v[30:31], s[52:53], v[90:91] op_sel_hi:[1,0,0] neg_lo:[0,0,1] neg_hi:[0,0,1]
    v_exp_f32 v24, v24
    v_exp_f32 v25, v25
    v_exp_f32 v26, v26
    v_exp_f32 v27, v27
    v_exp_f32 v28, v28
    v_exp_f32 v29, v29
    v_exp_f32 v30, v30
    v_exp_f32 v31, v31
    v_cvt_pk_bf16_f32 v188, v32, v33
    v_cvt_pk_bf16_f32 v189, v34, v35
    v_cvt_pk_bf16_f32 v190, v36, v37
    v_cvt_pk_bf16_f32 v191, v38, v39
    v_cvt_pk_bf16_f32 v192, v40, v41
    v_cvt_pk_bf16_f32 v193, v42, v43
    v_cvt_pk_bf16_f32 v194, v44, v45
    v_cvt_pk_bf16_f32 v195, v46, v47
    v_cvt_pk_bf16_f32 v196, v48, v49
    v_cvt_pk_bf16_f32 v197, v50, v51
    v_cvt_pk_bf16_f32 v198, v52, v53
    v_cvt_pk_bf16_f32 v199, v54, v55
    v_cvt_pk_bf16_f32 v200, v56, v57
    v_cvt_pk_bf16_f32 v201, v58, v59
    v_cvt_pk_bf16_f32 v202, v60, v61
    v_cvt_pk_bf16_f32 v203, v62, v63
    v_cvt_pk_bf16_f32 v180, v16, v17
    v_cvt_pk_bf16_f32 v181, v18, v19
    v_cvt_pk_bf16_f32 v182, v20, v21
    v_cvt_pk_bf16_f32 v183, v22, v23
    v_cvt_pk_bf16_f32 v184, v24, v25
    v_cvt_pk_bf16_f32 v185, v26, v27
    v_cvt_pk_bf16_f32 v186, v28, v29
    v_cvt_pk_bf16_f32 v187, v30, v31
    s_nop 0
    v_mfma_f32_16x16x32_bf16 v[24:27], v[232:235], v[180:183], 0
    v_mfma_f32_16x16x32_bf16 v[16:19], v[156:159], v[180:183], 0
    v_mfma_f32_16x16x32_bf16 v[20:23], v[172:175], v[180:183], 0
    v_mfma_f32_16x16x32_bf16 v[36:39], v[232:235], v[184:187], 0
    v_mfma_f32_16x16x32_bf16 v[28:31], v[164:167], v[184:187], 0
    v_mfma_f32_16x16x32_bf16 v[32:35], v[172:175], v[184:187], 0
    v_mfma_f32_16x16x32_bf16 v[48:51], v[232:235], v[188:191], 0
    v_mfma_f32_16x16x32_bf16 v[40:43], v[158:161], v[188:191], 0
    v_mfma_f32_16x16x32_bf16 v[44:47], v[174:177], v[188:191], 0
    v_mfma_f32_16x16x32_bf16 v[60:63], v[232:235], v[192:195], 0
    v_mfma_f32_16x16x32_bf16 v[52:55], v[166:169], v[192:195], 0
    v_mfma_f32_16x16x32_bf16 v[56:59], v[174:177], v[192:195], 0
    v_mfma_f32_16x16x32_bf16 v[72:75], v[232:235], v[196:199], 0
    v_mfma_f32_16x16x32_bf16 v[64:67], v[160:163], v[196:199], 0
    v_mfma_f32_16x16x32_bf16 v[68:71], v[176:179], v[196:199], 0
    v_mfma_f32_16x16x32_bf16 v[84:87], v[232:235], v[200:203], 0
    v_mfma_f32_16x16x32_bf16 v[76:79], v[168:171], v[200:203], 0
    v_mfma_f32_16x16x32_bf16 v[80:83], v[176:179], v[200:203], 0
    s_nop 4
    v_rcp_f32 v24, v24
    v_rcp_f32 v36, v36
    v_rcp_f32 v48, v48
    v_rcp_f32 v60, v60
    v_rcp_f32 v72, v72
    v_rcp_f32 v84, v84
    v_pk_mul_f32 v[16:17], v[16:17], v[24:25] op_sel_hi:[1,0]
    v_pk_mul_f32 v[18:19], v[18:19], v[24:25] op_sel_hi:[1,0]
    v_pk_mul_f32 v[20:21], v[20:21], v[24:25] op_sel_hi:[1,0]
    v_pk_mul_f32 v[22:23], v[22:23], v[24:25] op_sel_hi:[1,0]
    v_cvt_pk_bf16_f32 v180, v16, v17
    v_cvt_pk_bf16_f32 v181, v18, v19
    v_cvt_pk_bf16_f32 v182, v20, v21
    v_cvt_pk_bf16_f32 v183, v22, v23
    v_pk_mul_f32 v[28:29], v[28:29], v[36:37] op_sel_hi:[1,0]
    v_pk_mul_f32 v[30:31], v[30:31], v[36:37] op_sel_hi:[1,0]
    v_pk_mul_f32 v[32:33], v[32:33], v[36:37] op_sel_hi:[1,0]
    v_pk_mul_f32 v[34:35], v[34:35], v[36:37] op_sel_hi:[1,0]
    v_cvt_pk_bf16_f32 v184, v28, v29
    v_cvt_pk_bf16_f32 v185, v30, v31
    v_cvt_pk_bf16_f32 v186, v32, v33
    v_cvt_pk_bf16_f32 v187, v34, v35
    v_pk_mul_f32 v[40:41], v[40:41], v[48:49] op_sel_hi:[1,0]
    v_pk_mul_f32 v[42:43], v[42:43], v[48:49] op_sel_hi:[1,0]
    v_pk_mul_f32 v[44:45], v[44:45], v[48:49] op_sel_hi:[1,0]
    v_pk_mul_f32 v[46:47], v[46:47], v[48:49] op_sel_hi:[1,0]
    v_cvt_pk_bf16_f32 v188, v40, v41
    v_cvt_pk_bf16_f32 v189, v42, v43
    v_cvt_pk_bf16_f32 v190, v44, v45
    v_cvt_pk_bf16_f32 v191, v46, v47
    v_pk_mul_f32 v[52:53], v[52:53], v[60:61] op_sel_hi:[1,0]
    v_pk_mul_f32 v[54:55], v[54:55], v[60:61] op_sel_hi:[1,0]
    v_pk_mul_f32 v[56:57], v[56:57], v[60:61] op_sel_hi:[1,0]
    v_pk_mul_f32 v[58:59], v[58:59], v[60:61] op_sel_hi:[1,0]
    v_cvt_pk_bf16_f32 v192, v52, v53
    v_cvt_pk_bf16_f32 v193, v54, v55
    v_cvt_pk_bf16_f32 v194, v56, v57
    v_cvt_pk_bf16_f32 v195, v58, v59
    v_pk_mul_f32 v[64:65], v[64:65], v[72:73] op_sel_hi:[1,0]
    v_pk_mul_f32 v[66:67], v[66:67], v[72:73] op_sel_hi:[1,0]
    v_pk_mul_f32 v[68:69], v[68:69], v[72:73] op_sel_hi:[1,0]
    v_pk_mul_f32 v[70:71], v[70:71], v[72:73] op_sel_hi:[1,0]
    v_cvt_pk_bf16_f32 v196, v64, v65
    v_cvt_pk_bf16_f32 v197, v66, v67
    v_cvt_pk_bf16_f32 v198, v68, v69
    v_cvt_pk_bf16_f32 v199, v70, v71
    v_pk_mul_f32 v[76:77], v[76:77], v[84:85] op_sel_hi:[1,0]
    v_pk_mul_f32 v[78:79], v[78:79], v[84:85] op_sel_hi:[1,0]
    v_pk_mul_f32 v[80:81], v[80:81], v[84:85] op_sel_hi:[1,0]
    v_pk_mul_f32 v[82:83], v[82:83], v[84:85] op_sel_hi:[1,0]
    v_cvt_pk_bf16_f32 v200, v76, v77
    v_cvt_pk_bf16_f32 v201, v78, v79
    v_cvt_pk_bf16_f32 v202, v80, v81
    v_cvt_pk_bf16_f32 v203, v82, v83
    ds_write_b64 v8, v[180:181] offset:0
    ds_write_b64 v9, v[184:185] offset:0
    ds_write_b64 v8, v[188:189] offset:1280
    ds_write_b64 v9, v[192:193] offset:1280
    ds_write_b64 v8, v[196:197] offset:2560
    ds_write_b64 v9, v[200:201] offset:2560
    v_cndmask_b32 v208, v186, v182, s[58:59]
    v_cndmask_b32 v209, v187, v183, s[58:59]
    v_cndmask_b32 v210, v194, v190, s[58:59]
    v_cndmask_b32 v211, v195, v191, s[58:59]
    v_cndmask_b32 v212, v202, v198, s[58:59]
    v_cndmask_b32 v213, v203, v199, s[58:59]
    s_mov_b32 exec_hi, 0
    ds_write_b64 v11, v[208:209] offset:0
    ds_write_b64 v11, v[210:211] offset:1280
    ds_write_b64 v11, v[212:213] offset:2560
    s_mov_b64 exec, -1
    s_mov_b32 s40, s26
    s_mov_b32 s41, s27
    s_and_b32 s41, s41, 0xffff
    s_mov_b32 s42, 0x280000
    s_mov_b32 s43, 0x20000
    s_waitcnt lgkmcnt(0)
    ds_read_b128 v[124:127], v13 offset:0
    ds_read_b128 v[128:131], v13 offset:1024
    ds_read_b128 v[132:135], v13 offset:2048
    ds_read_b128 v[136:139], v13 offset:3072
    s_waitcnt lgkmcnt(3)
    buffer_store_dwordx4 v[124:127], v236, s[40:43], 0 offen sc1
    s_waitcnt lgkmcnt(2)
    buffer_store_dwordx4 v[128:131], v237, s[40:43], 0 offen sc1
    s_waitcnt lgkmcnt(1)
    buffer_store_dwordx4 v[132:135], v238, s[40:43], 0 offen sc1
    s_waitcnt lgkmcnt(0)
    buffer_store_dwordx4 v[136:139], v239, s[40:43], 0 offen sc1
    s_waitcnt vmcnt(0)
    s_barrier
    s_cmp_ge_u32 s64, 10
    s_cbranch_scc1 A_END
    s_mov_b32 s40, s26
    s_mov_b32 s41, s27
    s_and_b32 s41, s41, 0xffff
    s_mov_b32 s42, 0x280000
    s_mov_b32 s43, 0x20000
    s_lshl_b32 s52, s63, 3
    s_lshl_b32 s53, s28, 1
    s_add_u32 s52, s52, s53
    s_mul_i32 s52, s52, 20480
    v_lshlrev_b32 v1, 4, v10
    v_add_u32 v1, s52, v1
    v_add_u32 v2, 20480, v1
    v_lshrrev_b32 v11, 4, v10
    v_bfe_u32 v12, v10, 2, 2
    v_lshl_add_u32 v13, v11, 3, v12
    v_lshlrev_b32 v13, 7, v13
    v_lshrrev_b32 v14, 1, v12
    v_and_b32 v15, 1, v11
    v_lshl_add_u32 v14, v15, 1, v14
    v_lshlrev_b32 v14, 1, v14
    v_bfe_u32 v15, v10, 1, 1
    v_lshl_add_u32 v13, v15, 4, v13
    v_and_b32 v15, 1, v10
    v_lshl_add_u32 v13, v15, 3, v13
    v_xor_b32 v15, 0, v14
    v_lshl_add_u32 v3, v15, 4, v13
    v_xor_b32 v15, 2, v14
    v_lshl_add_u32 v4, v15, 4, v13
    v_xor_b32 v15, 4, v14
    v_lshl_add_u32 v5, v15, 4, v13
    v_xor_b32 v15, 6, v14
    v_lshl_add_u32 v6, v15, 4, v13
    s_mov_b32 s44, s22
    s_mov_b32 s45, s23
    s_and_b32 s45, s45, 0xffff
    s_mov_b32 s46, 0x500000
    s_mov_b32 s47, 0x20000
    s_lshl_b32 s52, s63, 7
    s_lshl_b32 s53, s28, 5
    s_add_u32 s52, s52, s53
    v_and_b32 v12, 15, v10
    v_add_u32 v12, s52, v12
    v_mul_u32_u24 v12, 2560, v12
    v_and_b32 v13, 1, v11
    v_lshlrev_b32 v13, 5, v13
    v_lshrrev_b32 v14, 1, v11
    v_lshl_add_u32 v13, v14, 4, v13
    s_lshl_b32 s52, s64, 7
    v_add3_u32 v7, v12, v13, s52
    v_add_u32 v8, 40960, v7
    s_mov_b32 s53, 40960
    s_barrier
    s_mov_b32 s54, 0
    buffer_load_dwordx4 v[16:19], v1, s[40:43], s54 offen offset:0 sc1
    buffer_load_dwordx4 v[20:23], v2, s[40:43], s54 offen offset:0 sc1
    buffer_load_dwordx4 v[24:27], v1, s[40:43], s54 offen offset:1024 sc1
    buffer_load_dwordx4 v[28:31], v2, s[40:43], s54 offen offset:1024 sc1
    buffer_load_dwordx4 v[32:35], v1, s[40:43], s54 offen offset:2048 sc1
    buffer_load_dwordx4 v[36:39], v2, s[40:43], s54 offen offset:2048 sc1
    buffer_load_dwordx4 v[40:43], v1, s[40:43], s54 offen offset:3072 sc1
    buffer_load_dwordx4 v[44:47], v2, s[40:43], s54 offen offset:3072 sc1
    s_mov_b32 s54, 4096
    buffer_load_dwordx4 v[48:51], v1, s[40:43], s54 offen offset:0 sc1
    buffer_load_dwordx4 v[52:55], v2, s[40:43], s54 offen offset:0 sc1
    buffer_load_dwordx4 v[56:59], v1, s[40:43], s54 offen offset:1024 sc1
    buffer_load_dwordx4 v[60:63], v2, s[40:43], s54 offen offset:1024 sc1
    buffer_load_dwordx4 v[64:67], v1, s[40:43], s54 offen offset:2048 sc1
    buffer_load_dwordx4 v[68:71], v2, s[40:43], s54 offen offset:2048 sc1
    buffer_load_dwordx4 v[72:75], v1, s[40:43], s54 offen offset:3072 sc1
    buffer_load_dwordx4 v[76:79], v2, s[40:43], s54 offen offset:3072 sc1
    ds_read_b64_tr_b16 v[208:209], v3 offset:0
    ds_read_b64_tr_b16 v[210:211], v3 offset:512
    ds_read_b64_tr_b16 v[212:213], v4 offset:0
    ds_read_b64_tr_b16 v[214:215], v4 offset:512
    ds_read_b64_tr_b16 v[216:217], v5 offset:0
    ds_read_b64_tr_b16 v[218:219], v5 offset:512
    ds_read_b64_tr_b16 v[220:221], v6 offset:0
    ds_read_b64_tr_b16 v[222:223], v6 offset:512
    s_waitcnt vmcnt(14) lgkmcnt(0)
    ds_read_b64_tr_b16 v[224:225], v3 offset:4096
    ds_read_b64_tr_b16 v[226:227], v3 offset:4608
    ds_read_b64_tr_b16 v[228:229], v4 offset:4096
    ds_read_b64_tr_b16 v[230:231], v4 offset:4608
    v_mfma_f32_16x16x32_bf16 v[176:179], v[208:211], v[16:19], 0
    ds_read_b64_tr_b16 v[232:233], v5 offset:4096
    ds_read_b64_tr_b16 v[234:235], v5 offset:4608
    v_mfma_f32_16x16x32_bf16 v[192:195], v[208:211], v[20:23], 0
    ds_read_b64_tr_b16 v[236:237], v6 offset:4096
    ds_read_b64_tr_b16 v[238:239], v6 offset:4608
    v_mfma_f32_16x16x32_bf16 v[180:183], v[212:215], v[16:19], 0
    s_mov_b32 s54, 8192
    buffer_load_dwordx4 v[80:83], v1, s[40:43], s54 offen offset:0 sc1
    v_mfma_f32_16x16x32_bf16 v[196:199], v[212:215], v[20:23], 0
    buffer_load_dwordx4 v[84:87], v2, s[40:43], s54 offen offset:0 sc1
    v_mfma_f32_16x16x32_bf16 v[184:187], v[216:219], v[16:19], 0
    v_mfma_f32_16x16x32_bf16 v[200:203], v[216:219], v[20:23], 0
    v_mfma_f32_16x16x32_bf16 v[188:191], v[220:223], v[16:19], 0
    v_mfma_f32_16x16x32_bf16 v[204:207], v[220:223], v[20:23], 0
    s_waitcnt vmcnt(14) lgkmcnt(0)
    ds_read_b64_tr_b16 v[208:209], v3 offset:8192
    ds_read_b64_tr_b16 v[210:211], v3 offset:8704
    ds_read_b64_tr_b16 v[212:213], v4 offset:8192
    ds_read_b64_tr_b16 v[214:215], v4 offset:8704
    v_mfma_f32_16x16x32_bf16 v[176:179], v[224:227], v[24:27], v[176:179]
    ds_read_b64_tr_b16 v[216:217], v5 offset:8192
    ds_read_b64_tr_b16 v[218:219], v5 offset:8704
    v_mfma_f32_16x16x32_bf16 v[192:195], v[224:227], v[28:31], v[192:195]
    ds_read_b64_tr_b16 v[220:221], v6 offset:8192
    ds_read_b64_tr_b16 v[222:223], v6 offset:8704
    v_mfma_f32_16x16x32_bf16 v[180:183], v[228:231], v[24:27], v[180:183]
    buffer_load_dwordx4 v[88:91], v1, s[40:43], s54 offen offset:1024 sc1
    buffer_load_dwordx4 v[92:95], v2, s[40:43], s54 offen offset:1024 sc1
    v_mfma_f32_16x16x32_bf16 v[196:199], v[228:231], v[28:31], v[196:199]
    v_mfma_f32_16x16x32_bf16 v[184:187], v[232:235], v[24:27], v[184:187]
    v_mfma_f32_16x16x32_bf16 v[200:203], v[232:235], v[28:31], v[200:203]
    v_mfma_f32_16x16x32_bf16 v[188:191], v[236:239], v[24:27], v[188:191]
    v_mfma_f32_16x16x32_bf16 v[204:207], v[236:239], v[28:31], v[204:207]
    s_waitcnt vmcnt(14) lgkmcnt(0)
    ds_read_b64_tr_b16 v[224:225], v3 offset:12288
    ds_read_b64_tr_b16 v[226:227], v3 offset:12800
    ds_read_b64_tr_b16 v[228:229], v4 offset:12288
    ds_read_b64_tr_b16 v[230:231], v4 offset:12800
    v_mfma_f32_16x16x32_bf16 v[176:179], v[208:211], v[32:35], v[176:179]
    ds_read_b64_tr_b16 v[232:233], v5 offset:12288
    ds_read_b64_tr_b16 v[234:235], v5 offset:12800
    v_mfma_f32_16x16x32_bf16 v[192:195], v[208:211], v[36:39], v[192:195]
    ds_read_b64_tr_b16 v[236:237], v6 offset:12288
    ds_read_b64_tr_b16 v[238:239], v6 offset:12800
    v_mfma_f32_16x16x32_bf16 v[180:183], v[212:215], v[32:35], v[180:183]
    buffer_load_dwordx4 v[96:99], v1, s[40:43], s54 offen offset:2048 sc1
    buffer_load_dwordx4 v[100:103], v2, s[40:43], s54 offen offset:2048 sc1
    v_mfma_f32_16x16x32_bf16 v[196:199], v[212:215], v[36:39], v[196:199]
    v_mfma_f32_16x16x32_bf16 v[184:187], v[216:219], v[32:35], v[184:187]
    v_mfma_f32_16x16x32_bf16 v[200:203], v[216:219], v[36:39], v[200:203]
    v_mfma_f32_16x16x32_bf16 v[188:191], v[220:223], v[32:35], v[188:191]
    v_mfma_f32_16x16x32_bf16 v[204:207], v[220:223], v[36:39], v[204:207]
    s_waitcnt vmcnt(14) lgkmcnt(0)
    ds_read_b64_tr_b16 v[208:209], v3 offset:16384
    ds_read_b64_tr_b16 v[210:211], v3 offset:16896
    ds_read_b64_tr_b16 v[212:213], v4 offset:16384
    ds_read_b64_tr_b16 v[214:215], v4 offset:16896
    v_mfma_f32_16x16x32_bf16 v[176:179], v[224:227], v[40:43], v[176:179]
    ds_read_b64_tr_b16 v[216:217], v5 offset:16384
    ds_read_b64_tr_b16 v[218:219], v5 offset:16896
    v_mfma_f32_16x16x32_bf16 v[192:195], v[224:227], v[44:47], v[192:195]
    ds_read_b64_tr_b16 v[220:221], v6 offset:16384
    ds_read_b64_tr_b16 v[222:223], v6 offset:16896
    v_mfma_f32_16x16x32_bf16 v[180:183], v[228:231], v[40:43], v[180:183]
    buffer_load_dwordx4 v[104:107], v1, s[40:43], s54 offen offset:3072 sc1
    buffer_load_dwordx4 v[108:111], v2, s[40:43], s54 offen offset:3072 sc1
    v_mfma_f32_16x16x32_bf16 v[196:199], v[228:231], v[44:47], v[196:199]
    v_mfma_f32_16x16x32_bf16 v[184:187], v[232:235], v[40:43], v[184:187]
    v_mfma_f32_16x16x32_bf16 v[200:203], v[232:235], v[44:47], v[200:203]
    v_mfma_f32_16x16x32_bf16 v[188:191], v[236:239], v[40:43], v[188:191]
    v_mfma_f32_16x16x32_bf16 v[204:207], v[236:239], v[44:47], v[204:207]
    s_waitcnt vmcnt(14) lgkmcnt(0)
    ds_read_b64_tr_b16 v[224:225], v3 offset:20480
    ds_read_b64_tr_b16 v[226:227], v3 offset:20992
    ds_read_b64_tr_b16 v[228:229], v4 offset:20480
    ds_read_b64_tr_b16 v[230:231], v4 offset:20992
    v_mfma_f32_16x16x32_bf16 v[176:179], v[208:211], v[48:51], v[176:179]
    ds_read_b64_tr_b16 v[232:233], v5 offset:20480
    ds_read_b64_tr_b16 v[234:235], v5 offset:20992
    v_mfma_f32_16x16x32_bf16 v[192:195], v[208:211], v[52:55], v[192:195]
    ds_read_b64_tr_b16 v[236:237], v6 offset:20480
    ds_read_b64_tr_b16 v[238:239], v6 offset:20992
    v_mfma_f32_16x16x32_bf16 v[180:183], v[212:215], v[48:51], v[180:183]
    s_mov_b32 s54, 12288
    buffer_load_dwordx4 v[112:115], v1, s[40:43], s54 offen offset:0 sc1
    v_mfma_f32_16x16x32_bf16 v[196:199], v[212:215], v[52:55], v[196:199]
    buffer_load_dwordx4 v[116:119], v2, s[40:43], s54 offen offset:0 sc1
    v_mfma_f32_16x16x32_bf16 v[184:187], v[216:219], v[48:51], v[184:187]
    v_mfma_f32_16x16x32_bf16 v[200:203], v[216:219], v[52:55], v[200:203]
    v_mfma_f32_16x16x32_bf16 v[188:191], v[220:223], v[48:51], v[188:191]
    v_mfma_f32_16x16x32_bf16 v[204:207], v[220:223], v[52:55], v[204:207]
    s_waitcnt vmcnt(14) lgkmcnt(0)
    ds_read_b64_tr_b16 v[208:209], v3 offset:24576
    ds_read_b64_tr_b16 v[210:211], v3 offset:25088
    ds_read_b64_tr_b16 v[212:213], v4 offset:24576
    ds_read_b64_tr_b16 v[214:215], v4 offset:25088
    v_mfma_f32_16x16x32_bf16 v[176:179], v[224:227], v[56:59], v[176:179]
    ds_read_b64_tr_b16 v[216:217], v5 offset:24576
    ds_read_b64_tr_b16 v[218:219], v5 offset:25088
    v_mfma_f32_16x16x32_bf16 v[192:195], v[224:227], v[60:63], v[192:195]
    ds_read_b64_tr_b16 v[220:221], v6 offset:24576
    ds_read_b64_tr_b16 v[222:223], v6 offset:25088
    v_mfma_f32_16x16x32_bf16 v[180:183], v[228:231], v[56:59], v[180:183]
    buffer_load_dwordx4 v[120:123], v1, s[40:43], s54 offen offset:1024 sc1
    buffer_load_dwordx4 v[124:127], v2, s[40:43], s54 offen offset:1024 sc1
    v_mfma_f32_16x16x32_bf16 v[196:199], v[228:231], v[60:63], v[196:199]
    v_mfma_f32_16x16x32_bf16 v[184:187], v[232:235], v[56:59], v[184:187]
    v_mfma_f32_16x16x32_bf16 v[200:203], v[232:235], v[60:63], v[200:203]
    v_mfma_f32_16x16x32_bf16 v[188:191], v[236:239], v[56:59], v[188:191]
    v_mfma_f32_16x16x32_bf16 v[204:207], v[236:239], v[60:63], v[204:207]
    s_waitcnt vmcnt(14) lgkmcnt(0)
    ds_read_b64_tr_b16 v[224:225], v3 offset:28672
    ds_read_b64_tr_b16 v[226:227], v3 offset:29184
    ds_read_b64_tr_b16 v[228:229], v4 offset:28672
    ds_read_b64_tr_b16 v[230:231], v4 offset:29184
    v_mfma_f32_16x16x32_bf16 v[176:179], v[208:211], v[64:67], v[176:179]
    ds_read_b64_tr_b16 v[232:233], v5 offset:28672
    ds_read_b64_tr_b16 v[234:235], v5 offset:29184
    v_mfma_f32_16x16x32_bf16 v[192:195], v[208:211], v[68:71], v[192:195]
    ds_read_b64_tr_b16 v[236:237], v6 offset:28672
    ds_read_b64_tr_b16 v[238:239], v6 offset:29184
    v_mfma_f32_16x16x32_bf16 v[180:183], v[212:215], v[64:67], v[180:183]
    buffer_load_dwordx4 v[128:131], v1, s[40:43], s54 offen offset:2048 sc1
    buffer_load_dwordx4 v[132:135], v2, s[40:43], s54 offen offset:2048 sc1
    v_mfma_f32_16x16x32_bf16 v[196:199], v[212:215], v[68:71], v[196:199]
    v_mfma_f32_16x16x32_bf16 v[184:187], v[216:219], v[64:67], v[184:187]
    v_mfma_f32_16x16x32_bf16 v[200:203], v[216:219], v[68:71], v[200:203]
    v_mfma_f32_16x16x32_bf16 v[188:191], v[220:223], v[64:67], v[188:191]
    v_mfma_f32_16x16x32_bf16 v[204:207], v[220:223], v[68:71], v[204:207]
    s_waitcnt vmcnt(14) lgkmcnt(0)
    ds_read_b64_tr_b16 v[208:209], v3 offset:32768
    ds_read_b64_tr_b16 v[210:211], v3 offset:33280
    ds_read_b64_tr_b16 v[212:213], v4 offset:32768
    ds_read_b64_tr_b16 v[214:215], v4 offset:33280
    v_mfma_f32_16x16x32_bf16 v[176:179], v[224:227], v[72:75], v[176:179]
    ds_read_b64_tr_b16 v[216:217], v5 offset:32768
    ds_read_b64_tr_b16 v[218:219], v5 offset:33280
    v_mfma_f32_16x16x32_bf16 v[192:195], v[224:227], v[76:79], v[192:195]
    ds_read_b64_tr_b16 v[220:221], v6 offset:32768
    ds_read_b64_tr_b16 v[222:223], v6 offset:33280
    v_mfma_f32_16x16x32_bf16 v[180:183], v[228:231], v[72:75], v[180:183]
    buffer_load_dwordx4 v[136:139], v1, s[40:43], s54 offen offset:3072 sc1
    buffer_load_dwordx4 v[140:143], v2, s[40:43], s54 offen offset:3072 sc1
    v_mfma_f32_16x16x32_bf16 v[196:199], v[228:231], v[76:79], v[196:199]
    v_mfma_f32_16x16x32_bf16 v[184:187], v[232:235], v[72:75], v[184:187]
    v_mfma_f32_16x16x32_bf16 v[200:203], v[232:235], v[76:79], v[200:203]
    v_mfma_f32_16x16x32_bf16 v[188:191], v[236:239], v[72:75], v[188:191]
    v_mfma_f32_16x16x32_bf16 v[204:207], v[236:239], v[76:79], v[204:207]
    s_waitcnt vmcnt(14) lgkmcnt(0)
    ds_read_b64_tr_b16 v[224:225], v3 offset:36864
    ds_read_b64_tr_b16 v[226:227], v3 offset:37376
    ds_read_b64_tr_b16 v[228:229], v4 offset:36864
    ds_read_b64_tr_b16 v[230:231], v4 offset:37376
    v_mfma_f32_16x16x32_bf16 v[176:179], v[208:211], v[80:83], v[176:179]
    ds_read_b64_tr_b16 v[232:233], v5 offset:36864
    ds_read_b64_tr_b16 v[234:235], v5 offset:37376
    v_mfma_f32_16x16x32_bf16 v[192:195], v[208:211], v[84:87], v[192:195]
    ds_read_b64_tr_b16 v[236:237], v6 offset:36864
    ds_read_b64_tr_b16 v[238:239], v6 offset:37376
    v_mfma_f32_16x16x32_bf16 v[180:183], v[212:215], v[80:83], v[180:183]
    s_mov_b32 s54, 16384
    buffer_load_dwordx4 v[144:147], v1, s[40:43], s54 offen offset:0 sc1
    v_mfma_f32_16x16x32_bf16 v[196:199], v[212:215], v[84:87], v[196:199]
    buffer_load_dwordx4 v[148:151], v2, s[40:43], s54 offen offset:0 sc1
    v_mfma_f32_16x16x32_bf16 v[184:187], v[216:219], v[80:83], v[184:187]
    v_mfma_f32_16x16x32_bf16 v[200:203], v[216:219], v[84:87], v[200:203]
    v_mfma_f32_16x16x32_bf16 v[188:191], v[220:223], v[80:83], v[188:191]
    v_mfma_f32_16x16x32_bf16 v[204:207], v[220:223], v[84:87], v[204:207]
    s_waitcnt vmcnt(14) lgkmcnt(0)
    v_add_u32 v3, s53, v3
    v_add_u32 v4, s53, v4
    v_add_u32 v5, s53, v5
    v_add_u32 v6, s53, v6
    ds_read_b64_tr_b16 v[208:209], v3 offset:0
    ds_read_b64_tr_b16 v[210:211], v3 offset:512
    ds_read_b64_tr_b16 v[212:213], v4 offset:0
    ds_read_b64_tr_b16 v[214:215], v4 offset:512
    v_mfma_f32_16x16x32_bf16 v[176:179], v[224:227], v[88:91], v[176:179]
    ds_read_b64_tr_b16 v[216:217], v5 offset:0
    ds_read_b64_tr_b16 v[218:219], v5 offset:512
    v_mfma_f32_16x16x32_bf16 v[192:195], v[224:227], v[92:95], v[192:195]
    ds_read_b64_tr_b16 v[220:221], v6 offset:0
    ds_read_b64_tr_b16 v[222:223], v6 offset:512
    v_mfma_f32_16x16x32_bf16 v[180:183], v[228:231], v[88:91], v[180:183]
    buffer_load_dwordx4 v[152:155], v1, s[40:43], s54 offen offset:1024 sc1
    buffer_load_dwordx4 v[156:159], v2, s[40:43], s54 offen offset:1024 sc1
    v_mfma_f32_16x16x32_bf16 v[196:199], v[228:231], v[92:95], v[196:199]
    v_mfma_f32_16x16x32_bf16 v[184:187], v[232:235], v[88:91], v[184:187]
    v_mfma_f32_16x16x32_bf16 v[200:203], v[232:235], v[92:95], v[200:203]
    v_mfma_f32_16x16x32_bf16 v[188:191], v[236:239], v[88:91], v[188:191]
    v_mfma_f32_16x16x32_bf16 v[204:207], v[236:239], v[92:95], v[204:207]
    s_waitcnt vmcnt(14) lgkmcnt(0)
    ds_read_b64_tr_b16 v[224:225], v3 offset:4096
    ds_read_b64_tr_b16 v[226:227], v3 offset:4608
    ds_read_b64_tr_b16 v[228:229], v4 offset:4096
    ds_read_b64_tr_b16 v[230:231], v4 offset:4608
    v_mfma_f32_16x16x32_bf16 v[176:179], v[208:211], v[96:99], v[176:179]
    ds_read_b64_tr_b16 v[232:233], v5 offset:4096
    ds_read_b64_tr_b16 v[234:235], v5 offset:4608
    v_mfma_f32_16x16x32_bf16 v[192:195], v[208:211], v[100:103], v[192:195]
    ds_read_b64_tr_b16 v[236:237], v6 offset:4096
    ds_read_b64_tr_b16 v[238:239], v6 offset:4608
    v_mfma_f32_16x16x32_bf16 v[180:183], v[212:215], v[96:99], v[180:183]
    buffer_load_dwordx4 v[160:163], v1, s[40:43], s54 offen offset:2048 sc1
    buffer_load_dwordx4 v[164:167], v2, s[40:43], s54 offen offset:2048 sc1
    v_mfma_f32_16x16x32_bf16 v[196:199], v[212:215], v[100:103], v[196:199]
    v_mfma_f32_16x16x32_bf16 v[184:187], v[216:219], v[96:99], v[184:187]
    v_mfma_f32_16x16x32_bf16 v[200:203], v[216:219], v[100:103], v[200:203]
    v_mfma_f32_16x16x32_bf16 v[188:191], v[220:223], v[96:99], v[188:191]
    v_mfma_f32_16x16x32_bf16 v[204:207], v[220:223], v[100:103], v[204:207]
    s_waitcnt vmcnt(14) lgkmcnt(0)
    ds_read_b64_tr_b16 v[208:209], v3 offset:8192
    ds_read_b64_tr_b16 v[210:211], v3 offset:8704
    ds_read_b64_tr_b16 v[212:213], v4 offset:8192
    ds_read_b64_tr_b16 v[214:215], v4 offset:8704
    v_mfma_f32_16x16x32_bf16 v[176:179], v[224:227], v[104:107], v[176:179]
    ds_read_b64_tr_b16 v[216:217], v5 offset:8192
    ds_read_b64_tr_b16 v[218:219], v5 offset:8704
    v_mfma_f32_16x16x32_bf16 v[192:195], v[224:227], v[108:111], v[192:195]
    ds_read_b64_tr_b16 v[220:221], v6 offset:8192
    ds_read_b64_tr_b16 v[222:223], v6 offset:8704
    v_mfma_f32_16x16x32_bf16 v[180:183], v[228:231], v[104:107], v[180:183]
    buffer_load_dwordx4 v[168:171], v1, s[40:43], s54 offen offset:3072 sc1
    buffer_load_dwordx4 v[172:175], v2, s[40:43], s54 offen offset:3072 sc1
    v_mfma_f32_16x16x32_bf16 v[196:199], v[228:231], v[108:111], v[196:199]
    v_mfma_f32_16x16x32_bf16 v[184:187], v[232:235], v[104:107], v[184:187]
    v_mfma_f32_16x16x32_bf16 v[200:203], v[232:235], v[108:111], v[200:203]
    v_mfma_f32_16x16x32_bf16 v[188:191], v[236:239], v[104:107], v[188:191]
    v_mfma_f32_16x16x32_bf16 v[204:207], v[236:239], v[108:111], v[204:207]
    s_waitcnt vmcnt(14) lgkmcnt(0)
    ds_read_b64_tr_b16 v[224:225], v3 offset:12288
    ds_read_b64_tr_b16 v[226:227], v3 offset:12800
    ds_read_b64_tr_b16 v[228:229], v4 offset:12288
    ds_read_b64_tr_b16 v[230:231], v4 offset:12800
    v_mfma_f32_16x16x32_bf16 v[176:179], v[208:211], v[112:115], v[176:179]
    ds_read_b64_tr_b16 v[232:233], v5 offset:12288
    ds_read_b64_tr_b16 v[234:235], v5 offset:12800
    v_mfma_f32_16x16x32_bf16 v[192:195], v[208:211], v[116:119], v[192:195]
    ds_read_b64_tr_b16 v[236:237], v6 offset:12288
    ds_read_b64_tr_b16 v[238:239], v6 offset:12800
    v_mfma_f32_16x16x32_bf16 v[180:183], v[212:215], v[112:115], v[180:183]
    v_mfma_f32_16x16x32_bf16 v[196:199], v[212:215], v[116:119], v[196:199]
    v_mfma_f32_16x16x32_bf16 v[184:187], v[216:219], v[112:115], v[184:187]
    v_mfma_f32_16x16x32_bf16 v[200:203], v[216:219], v[116:119], v[200:203]
    v_mfma_f32_16x16x32_bf16 v[188:191], v[220:223], v[112:115], v[188:191]
    v_mfma_f32_16x16x32_bf16 v[204:207], v[220:223], v[116:119], v[204:207]
    s_waitcnt vmcnt(12) lgkmcnt(0)
    ds_read_b64_tr_b16 v[208:209], v3 offset:16384
    ds_read_b64_tr_b16 v[210:211], v3 offset:16896
    ds_read_b64_tr_b16 v[212:213], v4 offset:16384
    ds_read_b64_tr_b16 v[214:215], v4 offset:16896
    v_mfma_f32_16x16x32_bf16 v[176:179], v[224:227], v[120:123], v[176:179]
    ds_read_b64_tr_b16 v[216:217], v5 offset:16384
    ds_read_b64_tr_b16 v[218:219], v5 offset:16896
    v_mfma_f32_16x16x32_bf16 v[192:195], v[224:227], v[124:127], v[192:195]
    ds_read_b64_tr_b16 v[220:221], v6 offset:16384
    ds_read_b64_tr_b16 v[222:223], v6 offset:16896
    v_mfma_f32_16x16x32_bf16 v[180:183], v[228:231], v[120:123], v[180:183]
    v_mfma_f32_16x16x32_bf16 v[196:199], v[228:231], v[124:127], v[196:199]
    v_mfma_f32_16x16x32_bf16 v[184:187], v[232:235], v[120:123], v[184:187]
    v_mfma_f32_16x16x32_bf16 v[200:203], v[232:235], v[124:127], v[200:203]
    v_mfma_f32_16x16x32_bf16 v[188:191], v[236:239], v[120:123], v[188:191]
    v_mfma_f32_16x16x32_bf16 v[204:207], v[236:239], v[124:127], v[204:207]
    s_waitcnt vmcnt(10) lgkmcnt(0)
    ds_read_b64_tr_b16 v[224:225], v3 offset:20480
    ds_read_b64_tr_b16 v[226:227], v3 offset:20992
    ds_read_b64_tr_b16 v[228:229], v4 offset:20480
    ds_read_b64_tr_b16 v[230:231], v4 offset:20992
    v_mfma_f32_16x16x32_bf16 v[176:179], v[208:211], v[128:131], v[176:179]
    ds_read_b64_tr_b16 v[232:233], v5 offset:20480
    ds_read_b64_tr_b16 v[234:235], v5 offset:20992
    v_mfma_f32_16x16x32_bf16 v[192:195], v[208:211], v[132:135], v[192:195]
    ds_read_b64_tr_b16 v[236:237], v6 offset:20480
    ds_read_b64_tr_b16 v[238:239], v6 offset:20992
    v_mfma_f32_16x16x32_bf16 v[180:183], v[212:215], v[128:131], v[180:183]
    v_mfma_f32_16x16x32_bf16 v[196:199], v[212:215], v[132:135], v[196:199]
    v_mfma_f32_16x16x32_bf16 v[184:187], v[216:219], v[128:131], v[184:187]
    v_mfma_f32_16x16x32_bf16 v[200:203], v[216:219], v[132:135], v[200:203]
    v_mfma_f32_16x16x32_bf16 v[188:191], v[220:223], v[128:131], v[188:191]
    v_mfma_f32_16x16x32_bf16 v[204:207], v[220:223], v[132:135], v[204:207]
    s_waitcnt vmcnt(8) lgkmcnt(0)
    ds_read_b64_tr_b16 v[208:209], v3 offset:24576
    ds_read_b64_tr_b16 v[210:211], v3 offset:25088
    ds_read_b64_tr_b16 v[212:213], v4 offset:24576
    ds_read_b64_tr_b16 v[214:215], v4 offset:25088
    v_mfma_f32_16x16x32_bf16 v[176:179], v[224:227], v[136:139], v[176:179]
    ds_read_b64_tr_b16 v[216:217], v5 offset:24576
    ds_read_b64_tr_b16 v[218:219], v5 offset:25088
    v_mfma_f32_16x16x32_bf16 v[192:195], v[224:227], v[140:143], v[192:195]
    ds_read_b64_tr_b16 v[220:221], v6 offset:24576
    ds_read_b64_tr_b16 v[222:223], v6 offset:25088
    v_mfma_f32_16x16x32_bf16 v[180:183], v[228:231], v[136:139], v[180:183]
    v_mfma_f32_16x16x32_bf16 v[196:199], v[228:231], v[140:143], v[196:199]
    v_mfma_f32_16x16x32_bf16 v[184:187], v[232:235], v[136:139], v[184:187]
    v_mfma_f32_16x16x32_bf16 v[200:203], v[232:235], v[140:143], v[200:203]
    v_mfma_f32_16x16x32_bf16 v[188:191], v[236:239], v[136:139], v[188:191]
    v_mfma_f32_16x16x32_bf16 v[204:207], v[236:239], v[140:143], v[204:207]
    s_waitcnt vmcnt(6) lgkmcnt(0)
    ds_read_b64_tr_b16 v[224:225], v3 offset:28672
    ds_read_b64_tr_b16 v[226:227], v3 offset:29184
    ds_read_b64_tr_b16 v[228:229], v4 offset:28672
    ds_read_b64_tr_b16 v[230:231], v4 offset:29184
    v_mfma_f32_16x16x32_bf16 v[176:179], v[208:211], v[144:147], v[176:179]
    ds_read_b64_tr_b16 v[232:233], v5 offset:28672
    ds_read_b64_tr_b16 v[234:235], v5 offset:29184
    v_mfma_f32_16x16x32_bf16 v[192:195], v[208:211], v[148:151], v[192:195]
    ds_read_b64_tr_b16 v[236:237], v6 offset:28672
    ds_read_b64_tr_b16 v[238:239], v6 offset:29184
    v_mfma_f32_16x16x32_bf16 v[180:183], v[212:215], v[144:147], v[180:183]
    v_mfma_f32_16x16x32_bf16 v[196:199], v[212:215], v[148:151], v[196:199]
    v_mfma_f32_16x16x32_bf16 v[184:187], v[216:219], v[144:147], v[184:187]
    v_mfma_f32_16x16x32_bf16 v[200:203], v[216:219], v[148:151], v[200:203]
    v_mfma_f32_16x16x32_bf16 v[188:191], v[220:223], v[144:147], v[188:191]
    v_mfma_f32_16x16x32_bf16 v[204:207], v[220:223], v[148:151], v[204:207]
    s_waitcnt vmcnt(4) lgkmcnt(0)
    ds_read_b64_tr_b16 v[208:209], v3 offset:32768
    ds_read_b64_tr_b16 v[210:211], v3 offset:33280
    ds_read_b64_tr_b16 v[212:213], v4 offset:32768
    ds_read_b64_tr_b16 v[214:215], v4 offset:33280
    v_mfma_f32_16x16x32_bf16 v[176:179], v[224:227], v[152:155], v[176:179]
    ds_read_b64_tr_b16 v[216:217], v5 offset:32768
    ds_read_b64_tr_b16 v[218:219], v5 offset:33280
    v_mfma_f32_16x16x32_bf16 v[192:195], v[224:227], v[156:159], v[192:195]
    ds_read_b64_tr_b16 v[220:221], v6 offset:32768
    ds_read_b64_tr_b16 v[222:223], v6 offset:33280
    v_mfma_f32_16x16x32_bf16 v[180:183], v[228:231], v[152:155], v[180:183]
    v_mfma_f32_16x16x32_bf16 v[196:199], v[228:231], v[156:159], v[196:199]
    v_mfma_f32_16x16x32_bf16 v[184:187], v[232:235], v[152:155], v[184:187]
    v_mfma_f32_16x16x32_bf16 v[200:203], v[232:235], v[156:159], v[200:203]
    v_mfma_f32_16x16x32_bf16 v[188:191], v[236:239], v[152:155], v[188:191]
    v_mfma_f32_16x16x32_bf16 v[204:207], v[236:239], v[156:159], v[204:207]
    s_waitcnt vmcnt(2) lgkmcnt(0)
    ds_read_b64_tr_b16 v[224:225], v3 offset:36864
    ds_read_b64_tr_b16 v[226:227], v3 offset:37376
    ds_read_b64_tr_b16 v[228:229], v4 offset:36864
    ds_read_b64_tr_b16 v[230:231], v4 offset:37376
    v_mfma_f32_16x16x32_bf16 v[176:179], v[208:211], v[160:163], v[176:179]
    ds_read_b64_tr_b16 v[232:233], v5 offset:36864
    ds_read_b64_tr_b16 v[234:235], v5 offset:37376
    v_mfma_f32_16x16x32_bf16 v[192:195], v[208:211], v[164:167], v[192:195]
    ds_read_b64_tr_b16 v[236:237], v6 offset:36864
    ds_read_b64_tr_b16 v[238:239], v6 offset:37376
    v_mfma_f32_16x16x32_bf16 v[180:183], v[212:215], v[160:163], v[180:183]
    v_mfma_f32_16x16x32_bf16 v[196:199], v[212:215], v[164:167], v[196:199]
    v_mfma_f32_16x16x32_bf16 v[184:187], v[216:219], v[160:163], v[184:187]
    v_mfma_f32_16x16x32_bf16 v[200:203], v[216:219], v[164:167], v[200:203]
    v_mfma_f32_16x16x32_bf16 v[188:191], v[220:223], v[160:163], v[188:191]
    v_mfma_f32_16x16x32_bf16 v[204:207], v[220:223], v[164:167], v[204:207]
    s_waitcnt vmcnt(0) lgkmcnt(0)
    v_mfma_f32_16x16x32_bf16 v[176:179], v[224:227], v[168:171], v[176:179]
    v_mfma_f32_16x16x32_bf16 v[192:195], v[224:227], v[172:175], v[192:195]
    v_mfma_f32_16x16x32_bf16 v[180:183], v[228:231], v[168:171], v[180:183]
    v_mfma_f32_16x16x32_bf16 v[196:199], v[228:231], v[172:175], v[196:199]
    v_mfma_f32_16x16x32_bf16 v[184:187], v[232:235], v[168:171], v[184:187]
    v_mfma_f32_16x16x32_bf16 v[200:203], v[232:235], v[172:175], v[200:203]
    v_mfma_f32_16x16x32_bf16 v[188:191], v[236:239], v[168:171], v[188:191]
    v_mfma_f32_16x16x32_bf16 v[204:207], v[236:239], v[172:175], v[204:207]
    s_nop 6
    v_cvt_pk_bf16_f32 v16, v176, v177
    v_cvt_pk_bf16_f32 v17, v178, v179
    v_cvt_pk_bf16_f32 v18, v180, v181
    v_cvt_pk_bf16_f32 v19, v182, v183
    v_cvt_pk_bf16_f32 v20, v184, v185
    v_cvt_pk_bf16_f32 v21, v186, v187
    v_cvt_pk_bf16_f32 v22, v188, v189
    v_cvt_pk_bf16_f32 v23, v190, v191
    v_cvt_pk_bf16_f32 v24, v192, v193
    v_cvt_pk_bf16_f32 v25, v194, v195
    v_cvt_pk_bf16_f32 v26, v196, v197
    v_cvt_pk_bf16_f32 v27, v198, v199
    v_cvt_pk_bf16_f32 v28, v200, v201
    v_cvt_pk_bf16_f32 v29, v202, v203
    v_cvt_pk_bf16_f32 v30, v204, v205
    v_cvt_pk_bf16_f32 v31, v206, v207
    s_nop 0
    v_permlane16_swap_b32 v16, v18
    v_permlane16_swap_b32 v17, v19
    v_permlane16_swap_b32 v20, v22
    v_permlane16_swap_b32 v21, v23
    v_permlane16_swap_b32 v24, v26
    v_permlane16_swap_b32 v25, v27
    v_permlane16_swap_b32 v28, v30
    v_permlane16_swap_b32 v29, v31
    buffer_store_dwordx4 v[16:19], v7, s[44:47], 0 offen offset:0
    buffer_store_dwordx4 v[20:23], v7, s[44:47], 0 offen offset:64
    buffer_store_dwordx4 v[24:27], v8, s[44:47], 0 offen offset:0
    buffer_store_dwordx4 v[28:31], v8, s[44:47], 0 offen offset:64
A_END:
    s_endpgm
CODE_END:
    s_endpgm
.section .rodata,"a"
.p2align 6
.amdhsa_kernel concat_heads__sliding_local_dilated__ssm_conv_h3__prompt_kernel
  .amdhsa_next_free_vgpr 256
  .amdhsa_next_free_sgpr 102
  .amdhsa_accum_offset 256
  .amdhsa_group_segment_fixed_size 0
  .amdhsa_kernarg_size 96
  .amdhsa_user_sgpr_count 2
  .amdhsa_user_sgpr_kernarg_segment_ptr 1
  .amdhsa_system_sgpr_workgroup_id_x 1
  .amdhsa_float_denorm_mode_32 3
.end_amdhsa_kernel
```
